```python
import torch

def _softmax(x, axis=-1):
    return torch.softmax(x, dim=axis)
def _gelu(x):
    return torch.nn.functional.gelu(x, approximate="tanh")
def _silu(x):
    return torch.nn.functional.silu(x)
def _sigmoid(x):
    return torch.sigmoid(x)
def _layernorm(x, axis=-1, eps=1e-5):
    m = x.mean(dim=axis, keepdim=True)
    v = x.var(dim=axis, keepdim=True, unbiased=False)
    return (x - m) / torch.sqrt(v + eps)
def _scatter_add(tgt, idx, src, axis=0):
    return tgt.clone().index_add_(axis, idx, src)
def _segment_sum(src, seg, n):
    out = torch.zeros((n,) + src.shape[1:], dtype=src.dtype)
    return out.index_add_(0, seg, src)
def _pad(x, pw):
    flat = tuple(v for pair in reversed(pw) for v in pair)
    return torch.nn.functional.pad(x, flat)

kernel_name = 'parallel_sum__spectral_gfnet__glu_gated_reglu__prompt'

def setup_inputs():

    _w = (lambda a: (lambda t: t.to(torch.bfloat16) if t.is_floating_point() else t)(torch.as_tensor(a)))
    def _A_setup():
        B, S, D = 1, 2048, 640
        Df = D // 2 + 1
        return {
            "x": _w((lambda *s: torch.randn(*s, dtype=torch.bfloat16) * 0.05)(B, S, D)),
            "w_r": _w((lambda *s: torch.randn(*s, dtype=torch.bfloat16) * 0.4)(S, Df) * 0.02),
            "w_i": _w((lambda *s: torch.randn(*s, dtype=torch.bfloat16) * 0.4)(S, Df) * 0.02),
        }
    _A_in = _A_setup()

    def _B_setup():
        B, S, D, F = 1, 2048, 640, 1536
        return {
            "x": _w((lambda *s: torch.randn(*s, dtype=torch.bfloat16) * 0.05)(B, S, D)),
            "W_gate": _w((lambda *s: torch.randn(*s, dtype=torch.bfloat16) * 0.2)(D, F) * (2.0 / D) ** 0.5),
            "W_up": _w((lambda *s: torch.randn(*s, dtype=torch.bfloat16) * 0.2)(D, F) * (2.0 / D) ** 0.5),
            "W_down": _w((lambda *s: torch.randn(*s, dtype=torch.bfloat16) * 0.2)(F, D) * (1.0 / F) ** 0.5),
        }
    _B_in = _B_setup()

    return {
        "A_x": _A_in["x"],
        "A_w_r": _A_in["w_r"],
        "A_w_i": _A_in["w_i"],
        "B_x": _B_in["x"],
        "B_W_gate": _B_in["W_gate"],
        "B_W_up": _B_in["W_up"],
        "B_W_down": _B_in["W_down"],
    }

def reference(A_x, A_w_r, A_w_i, B_x, B_W_gate, B_W_up, B_W_down):
    def _A_ref(x, w_r, w_i):
        B, S, D = x.shape
        X = (lambda x, axes=(-2,-1): torch.fft.rfft2(x.float(), dim=axes))(x, axes=(-2, -1))
        W = w_r + 1j * w_i
        X = X * W
        y = (lambda x, s, axes=(-2,-1): torch.fft.irfft2(x, s=s, dim=axes).to(torch.bfloat16))(X, (S, D), axes=(-2, -1))
        return y

    def _B_ref(x, W_gate, W_up, W_down):
        gate = torch.einsum("bsd,df->bsf", x, W_gate)
        up = torch.einsum("bsd,df->bsf", x, W_up)
        gate = gate * (lambda x, dt: x.to(dt))(gate > 0, gate.dtype)
        h = gate * up
        return torch.einsum("bsf,fd->bsd", h, W_down)

    x = A_x
    xn = _layernorm(x, axis=-1)
    return x + _A_ref(xn, A_w_r, A_w_i) + _B_ref(xn, B_W_gate, B_W_up, B_W_down)
```

```asm
; @launch grid=(256,1,1) block=(512,1,1) lds=161920
.amdgcn_target "amdgcn-amd-amdhsa--gfx950"
.text
.globl parallel_sum__spectral_gfnet__glu_gated_reglu__prompt_kernel
.p2align 8
.type parallel_sum__spectral_gfnet__glu_gated_reglu__prompt_kernel,@function
parallel_sum__spectral_gfnet__glu_gated_reglu__prompt_kernel:
    s_cmp_ge_u32 s2, 256
    s_cbranch_scc1 L_end
    s_load_dwordx16 s[64:79], s[0:1], 0
    s_load_dwordx4 s[80:83], s[0:1], 64
    v_lshrrev_b32 v1, 6, v0
    v_and_b32 v0, 63, v0
    v_readfirstlane_b32 s44, v1
    s_cmp_lg_u32 s44, 0
    s_cbranch_scc1 L_noct
    s_getpc_b64 s[4:5]
L_ct_1:
    s_sub_u32 s4, s4, L_ct_1 - parallel_sum__spectral_gfnet__glu_gated_reglu__prompt_kernel
    s_subb_u32 s5, s5, 0
    s_mov_b32 s12, s4
    s_and_b32 s13, s5, 0xffff
    s_mov_b32 s14, L_code_end - parallel_sum__spectral_gfnet__glu_gated_reglu__prompt_kernel
    s_mov_b32 s15, 0x00020000
    s_lshr_b32 s48, s2, 3
    s_lshl_b32 s48, s48, 11
    v_and_b32 v5, 15, v0
    v_lshlrev_b32 v5, 7, v5
    buffer_load_dword v15, v5, s[12:15], s48 offen
L_noct:
    s_and_b32 s3, s2, 1
    s_lshl_b32 s45, s3, 3
    s_bfe_u32 s3, s2, 0x30003
    s_add_u32 s45, s45, s3
    s_lshr_b32 s49, s2, 6
    s_bfe_u32 s3, s2, 0x20001
    s_mul_i32 s46, s3, 3
    s_add_u32 s46, s46, s49
    s_and_b32 s47, s44, 3
    s_cmp_eq_u32 s49, 3
    s_cbranch_scc1 L_dft
    s_cmp_ge_u32 s44, 4
    s_cbranch_scc0 L_ffn_c
    v_lshrrev_b32 v6, 3, v0
    v_mul_u32_u24 v6, 81920, v6
    v_and_b32 v7, 7, v0
    v_lshrrev_b32 v8, 4, v0
    v_xor_b32 v7, v7, v8
    v_lshl_add_u32 v2, v7, 4, v6
    v_xor_b32 v3, 64, v2
    v_mul_u32_u24 v6, 3072, v8
    v_and_b32 v7, 15, v0
    v_lshlrev_b32 v8, 2, v8
    v_xor_b32 v7, v7, v8
    v_lshl_add_u32 v4, v7, 4, v6
    v_xor_b32 v1, 32, v4
    s_lshl_b32 s54, s45, 2
    s_add_u32 s54, s54, s47
    s_mul_i32 s54, s54, 1280
    s_mul_i32 s55, s47, 49152
    s_lshl_b32 s48, s46, 8
    s_add_u32 s55, s55, s48
    s_lshl_b32 s56, s47, 12
    s_and_b32 s61, s2, 1
    s_mul_i32 s61, s61, 5
    s_bfe_u32 s48, s2, 0x10003
    s_mul_i32 s48, s48, 3
    s_add_u32 s61, s61, s48
    s_getpc_b64 s[4:5]
    s_add_u32 s4, s4, dft_tables@rel32@lo+4
    s_addc_u32 s5, s5, dft_tables@rel32@hi+12
    s_mov_b32 s24, s4
    s_and_b32 s25, s5, 0xffff
    s_mov_b32 s26, 0x66000
    s_mov_b32 s27, 0x00020000
    s_waitcnt lgkmcnt(0)
    s_mov_b32 s8, s64
    s_and_b32 s9, s65, 0xffff
    s_mov_b32 s10, 0x280000
    s_mov_b32 s11, 0x00020000
    s_mov_b32 s12, s72
    s_and_b32 s13, s73, 0xffff
    s_mov_b32 s14, 0x1e0000
    s_mov_b32 s15, 0x00020000
    s_mov_b32 s16, s74
    s_and_b32 s17, s75, 0xffff
    s_mov_b32 s18, 0x1e0000
    s_mov_b32 s19, 0x00020000
    s_add_u32 s48, s61, 0
    s_lshl_b32 s57, s48, 7
    s_add_u32 s57, s57, s54
    s_mul_i32 s58, s48, 196608
    s_add_u32 s58, s58, s55
    s_add_u32 s61, s61, 1
    s_cmp_eq_u32 s61, 10
    s_cselect_b32 s61, 0, s61
    s_add_u32 m0, s56, 0
    s_add_u32 s48, s57, 0
    buffer_load_dwordx4 v2, s[8:11], s48 offen lds
    s_add_u32 m0, s56, 1024
    s_add_u32 s48, s57, 655360
    buffer_load_dwordx4 v3, s[8:11], s48 offen lds
    s_add_u32 m0, s56, 2048
    s_add_u32 s48, s57, 1310720
    buffer_load_dwordx4 v2, s[8:11], s48 offen lds
    s_add_u32 m0, s56, 3072
    s_add_u32 s48, s57, 1966080
    buffer_load_dwordx4 v3, s[8:11], s48 offen lds
    s_add_u32 m0, s56, 16384
    s_add_u32 s48, s58, 0
    buffer_load_dwordx4 v4, s[12:15], s48 offen lds
    s_add_u32 m0, s56, 17408
    s_add_u32 s48, s58, 12288
    buffer_load_dwordx4 v4, s[12:15], s48 offen lds
    s_add_u32 m0, s56, 18432
    s_add_u32 s48, s58, 24576
    buffer_load_dwordx4 v1, s[12:15], s48 offen lds
    s_add_u32 m0, s56, 19456
    s_add_u32 s48, s58, 36864
    buffer_load_dwordx4 v1, s[12:15], s48 offen lds
    s_add_u32 m0, s56, 32768
    s_add_u32 s48, s58, 0
    buffer_load_dwordx4 v4, s[16:19], s48 offen lds
    s_add_u32 m0, s56, 33792
    s_add_u32 s48, s58, 12288
    buffer_load_dwordx4 v4, s[16:19], s48 offen lds
    s_add_u32 m0, s56, 34816
    s_add_u32 s48, s58, 24576
    buffer_load_dwordx4 v1, s[16:19], s48 offen lds
    s_add_u32 m0, s56, 35840
    s_add_u32 s48, s58, 36864
    buffer_load_dwordx4 v1, s[16:19], s48 offen lds
    v_mov_b32 v12, 149504
    v_mov_b32 v13, 0
    ds_write_b32 v12, v13
    ds_write_b32 v12, v13 offset:4
    ds_write_b32 v12, v13 offset:8
    ds_write_b32 v12, v13 offset:12
    ds_write_b32 v12, v13 offset:36
    ds_write_b32 v12, v13 offset:16
    ds_write_b32 v12, v13 offset:20
    ds_write_b32 v12, v13 offset:24
    ds_write_b32 v12, v13 offset:28
    s_load_dword s62, s[82:83], 0x0
    s_mov_b32 s20, s82
    s_and_b32 s21, s83, 0xffff
    s_mov_b32 s22, 0x10000000
    s_mov_b32 s23, 0x00020000
    s_mov_b32 s36, s76
    s_and_b32 s37, s77, 0xffff
    s_mov_b32 s38, 0x1e0000
    s_mov_b32 s39, 0x00020000
    s_mov_b32 s28, s66
    s_and_b32 s29, s67, 0xffff
    s_mov_b32 s30, 0x141000
    s_mov_b32 s31, 0x00020000
    s_mov_b32 s32, s68
    s_and_b32 s33, s69, 0xffff
    s_mov_b32 s34, 0x141000
    s_mov_b32 s35, 0x00020000
    s_and_b32 s3, s2, 7
    s_lshr_b32 s48, s2, 3
    s_lshr_b32 s64, s3, 1
    s_lshl_b32 s64, s64, 3
    s_and_b32 s49, s48, 7
    s_add_u32 s64, s64, s49
    s_and_b32 s3, s3, 1
    s_lshl_b32 s3, s3, 2
    s_lshr_b32 s48, s48, 3
    s_add_u32 s65, s3, s48
    s_mul_i32 s70, s47, 16384
    s_lshl_b32 s68, s64, 7
    s_lshl_b32 s48, s47, 12
    s_add_u32 s68, s68, s48
    s_add_u32 s68, s68, 0x910000
    s_mul_i32 s69, s65, 21
    s_add_u32 s69, s69, s47
    s_mul_i32 s69, s69, 3072
    s_add_u32 s69, s69, 409600
    s_lshl_b32 s78, s64, 1
    v_lshlrev_b32 v5, 4, v0
    s_lshl_b32 s48, s47, 6
    v_add_u32 v10, s48, v0
    v_min_u32 v10, 159, v10
    v_lshlrev_b32 v10, 7, v10
    s_lshl_b32 s48, s45, 2
    s_add_u32 s48, s48, s47
    s_lshl_b32 s48, s48, 1
    v_and_b32 v6, 1, v0
    v_add_u32 v6, s48, v6
    s_and_b32 s48, s2, 0xc6
    s_add_u32 s48, s48, 128
    v_and_b32 v7, 7, v0
    v_bfe_u32 v12, v0, 3, 1
    v_min_u32 v7, 4, v7
    v_lshlrev_b32 v7, 3, v7
    v_add3_u32 v7, v7, v12, s48
    v_cmp_gt_u32 vcc, 16, v0
    s_nop 1
    v_cndmask_b32 v6, v7, v6, vcc
    v_lshlrev_b32 v15, 7, v6
    v_and_b32 v36, 31, v0
    v_lshrrev_b32 v37, 5, v0
    v_lshlrev_b32 v36, 2, v36
    v_lshl_add_u32 v36, v37, 9, v36
    s_lshl_b32 s48, s47, 7
    v_add_u32 v36, s48, v36
    v_lshrrev_b32 v37, 4, v0
    v_mul_u32_u24 v37, 12288, v37
    v_and_b32 v39, 15, v0
    v_lshl_add_u32 v37, v39, 4, v37
    s_lshl_b32 s48, s47, 8
    s_lshl_b32 s49, s46, 10
    s_add_u32 s48, s48, s49
    v_add_u32 v37, s48, v37
    v_lshrrev_b32 v52, 5, v0
    v_lshl_add_u32 v52, v52, 29, v37
    s_add_u32 s48, s61, 0
    s_lshl_b32 s57, s48, 7
    s_add_u32 s57, s57, s54
    s_mul_i32 s58, s48, 196608
    s_add_u32 s58, s58, s55
    s_add_u32 s61, s61, 1
    s_cmp_eq_u32 s61, 10
    s_cselect_b32 s61, 0, s61
    s_add_u32 m0, s56, 49152
    s_add_u32 s48, s57, 0
    buffer_load_dwordx4 v2, s[8:11], s48 offen lds
    v_and_b32 v56, 15, v0
    v_lshlrev_b32 v56, 6, v56
    v_add_u32 v56, s78, v56
    v_cvt_f32_u32 v56, v56
    v_mul_f32 v56, 0x3a000000, v56
    v_lshrrev_b32 v57, 5, v0
    v_lshlrev_b32 v57, 3, v57
    v_cvt_f32_u32 v57, v57
    v_bfe_u32 v58, v0, 4, 1
    v_cvt_f32_u32 v58, v58
    v_mul_f32 v58, 0x3e800000, v58
    v_fma_f32 v59, v57, v56, v58
    v_mov_b32 v60, v59
    v_cos_f32 v61, v60
    v_add_f32 v60, v60, v56
    v_cos_f32 v62, v60
    v_add_f32 v60, v60, v56
    v_cvt_pk_bf16_f32 v160, v61, v62
    v_xor_b32 v168, 0x80000000, v160
    s_add_u32 m0, s56, 50176
    s_add_u32 s48, s57, 655360
    buffer_load_dwordx4 v3, s[8:11], s48 offen lds
    v_cos_f32 v61, v60
    v_add_f32 v60, v60, v56
    v_cos_f32 v62, v60
    v_add_f32 v60, v60, v56
    v_cvt_pk_bf16_f32 v161, v61, v62
    v_xor_b32 v169, 0x80000000, v161
    v_cos_f32 v61, v60
    v_add_f32 v60, v60, v56
    v_cos_f32 v62, v60
    v_add_f32 v60, v60, v56
    v_cvt_pk_bf16_f32 v162, v61, v62
    v_xor_b32 v170, 0x80000000, v162
    v_cos_f32 v61, v60
    v_add_f32 v60, v60, v56
    v_cos_f32 v62, v60
    v_add_f32 v60, v60, v56
    v_cvt_pk_bf16_f32 v163, v61, v62
    v_xor_b32 v171, 0x80000000, v163
    s_add_u32 m0, s56, 51200
    s_add_u32 s48, s57, 1310720
    buffer_load_dwordx4 v2, s[8:11], s48 offen lds
    v_add_f32 v60, 0xbe800000, v59
    v_cos_f32 v61, v60
    v_add_f32 v60, v60, v56
    v_cos_f32 v62, v60
    v_add_f32 v60, v60, v56
    v_cvt_pk_bf16_f32 v176, v61, v62
    v_xor_b32 v184, 0x80000000, v176
    v_cos_f32 v61, v60
    v_add_f32 v60, v60, v56
    v_cos_f32 v62, v60
    v_add_f32 v60, v60, v56
    v_cvt_pk_bf16_f32 v177, v61, v62
    v_xor_b32 v185, 0x80000000, v177
    v_cos_f32 v61, v60
    v_add_f32 v60, v60, v56
    v_cos_f32 v62, v60
    v_add_f32 v60, v60, v56
    v_cvt_pk_bf16_f32 v178, v61, v62
    s_add_u32 m0, s56, 52224
    s_add_u32 s48, s57, 1966080
    buffer_load_dwordx4 v3, s[8:11], s48 offen lds
    v_xor_b32 v186, 0x80000000, v178
    v_cos_f32 v61, v60
    v_add_f32 v60, v60, v56
    v_cos_f32 v62, v60
    v_add_f32 v60, v60, v56
    v_cvt_pk_bf16_f32 v179, v61, v62
    v_xor_b32 v187, 0x80000000, v179
    v_add_f32 v59, 0x41800000, v57
    v_fma_f32 v59, v59, v56, v58
    v_mov_b32 v60, v59
    v_cos_f32 v61, v60
    v_add_f32 v60, v60, v56
    v_cos_f32 v62, v60
    v_add_f32 v60, v60, v56
    v_cvt_pk_bf16_f32 v164, v61, v62
    v_xor_b32 v172, 0x80000000, v164
    v_cos_f32 v61, v60
    v_add_f32 v60, v60, v56
    s_add_u32 m0, s56, 65536
    s_add_u32 s48, s58, 0
    buffer_load_dwordx4 v4, s[12:15], s48 offen lds
    v_cos_f32 v62, v60
    v_add_f32 v60, v60, v56
    v_cvt_pk_bf16_f32 v165, v61, v62
    v_xor_b32 v173, 0x80000000, v165
    v_cos_f32 v61, v60
    v_add_f32 v60, v60, v56
    v_cos_f32 v62, v60
    v_add_f32 v60, v60, v56
    v_cvt_pk_bf16_f32 v166, v61, v62
    v_xor_b32 v174, 0x80000000, v166
    v_cos_f32 v61, v60
    v_add_f32 v60, v60, v56
    v_cos_f32 v62, v60
    v_add_f32 v60, v60, v56
    v_cvt_pk_bf16_f32 v167, v61, v62
    v_xor_b32 v175, 0x80000000, v167
    v_add_f32 v60, 0xbe800000, v59
    v_cos_f32 v61, v60
    s_add_u32 m0, s56, 66560
    s_add_u32 s48, s58, 12288
    buffer_load_dwordx4 v4, s[12:15], s48 offen lds
    v_add_f32 v60, v60, v56
    v_cos_f32 v62, v60
    v_add_f32 v60, v60, v56
    v_cvt_pk_bf16_f32 v180, v61, v62
    v_xor_b32 v188, 0x80000000, v180
    v_cos_f32 v61, v60
    v_add_f32 v60, v60, v56
    v_cos_f32 v62, v60
    v_add_f32 v60, v60, v56
    v_cvt_pk_bf16_f32 v181, v61, v62
    v_xor_b32 v189, 0x80000000, v181
    v_cos_f32 v61, v60
    v_add_f32 v60, v60, v56
    v_cos_f32 v62, v60
    v_add_f32 v60, v60, v56
    v_cvt_pk_bf16_f32 v182, v61, v62
    v_xor_b32 v190, 0x80000000, v182
    v_cos_f32 v61, v60
    s_add_u32 m0, s56, 67584
    s_add_u32 s48, s58, 24576
    buffer_load_dwordx4 v1, s[12:15], s48 offen lds
    v_add_f32 v60, v60, v56
    v_cos_f32 v62, v60
    v_add_f32 v60, v60, v56
    v_cvt_pk_bf16_f32 v183, v61, v62
    v_xor_b32 v191, 0x80000000, v183
    v_add_f32 v56, 0x3a000000, v56
    v_fma_f32 v59, v57, v56, v58
    v_mov_b32 v60, v59
    v_cos_f32 v61, v60
    v_add_f32 v60, v60, v56
    v_cos_f32 v62, v60
    v_add_f32 v60, v60, v56
    v_cvt_pk_bf16_f32 v224, v61, v62
    v_xor_b32 v232, 0x80000000, v224
    v_cos_f32 v61, v60
    v_add_f32 v60, v60, v56
    v_cos_f32 v62, v60
    v_add_f32 v60, v60, v56
    v_cvt_pk_bf16_f32 v225, v61, v62
    s_add_u32 m0, s56, 68608
    s_add_u32 s48, s58, 36864
    buffer_load_dwordx4 v1, s[12:15], s48 offen lds
    v_xor_b32 v233, 0x80000000, v225
    v_cos_f32 v61, v60
    v_add_f32 v60, v60, v56
    v_cos_f32 v62, v60
    v_add_f32 v60, v60, v56
    v_cvt_pk_bf16_f32 v226, v61, v62
    v_xor_b32 v234, 0x80000000, v226
    v_cos_f32 v61, v60
    v_add_f32 v60, v60, v56
    v_cos_f32 v62, v60
    v_add_f32 v60, v60, v56
    v_cvt_pk_bf16_f32 v227, v61, v62
    v_xor_b32 v235, 0x80000000, v227
    v_add_f32 v60, 0xbe800000, v59
    v_cos_f32 v61, v60
    v_add_f32 v60, v60, v56
    v_cos_f32 v62, v60
    v_add_f32 v60, v60, v56
    s_add_u32 m0, s56, 81920
    s_add_u32 s48, s58, 0
    buffer_load_dwordx4 v4, s[16:19], s48 offen lds
    v_cvt_pk_bf16_f32 v240, v61, v62
    v_xor_b32 v248, 0x80000000, v240
    v_cos_f32 v61, v60
    v_add_f32 v60, v60, v56
    v_cos_f32 v62, v60
    v_add_f32 v60, v60, v56
    v_cvt_pk_bf16_f32 v241, v61, v62
    v_xor_b32 v249, 0x80000000, v241
    v_cos_f32 v61, v60
    v_add_f32 v60, v60, v56
    v_cos_f32 v62, v60
    v_add_f32 v60, v60, v56
    v_cvt_pk_bf16_f32 v242, v61, v62
    v_xor_b32 v250, 0x80000000, v242
    v_cos_f32 v61, v60
    v_add_f32 v60, v60, v56
    v_cos_f32 v62, v60
    v_add_f32 v60, v60, v56
    s_add_u32 m0, s56, 82944
    s_add_u32 s48, s58, 12288
    buffer_load_dwordx4 v4, s[16:19], s48 offen lds
    v_cvt_pk_bf16_f32 v243, v61, v62
    v_xor_b32 v251, 0x80000000, v243
    v_add_f32 v59, 0x41800000, v57
    v_fma_f32 v59, v59, v56, v58
    v_mov_b32 v60, v59
    v_cos_f32 v61, v60
    v_add_f32 v60, v60, v56
    v_cos_f32 v62, v60
    v_add_f32 v60, v60, v56
    v_cvt_pk_bf16_f32 v228, v61, v62
    v_xor_b32 v236, 0x80000000, v228
    v_cos_f32 v61, v60
    v_add_f32 v60, v60, v56
    v_cos_f32 v62, v60
    v_add_f32 v60, v60, v56
    v_cvt_pk_bf16_f32 v229, v61, v62
    v_xor_b32 v237, 0x80000000, v229
    v_cos_f32 v61, v60
    s_add_u32 m0, s56, 83968
    s_add_u32 s48, s58, 24576
    buffer_load_dwordx4 v1, s[16:19], s48 offen lds
    v_add_f32 v60, v60, v56
    v_cos_f32 v62, v60
    v_add_f32 v60, v60, v56
    v_cvt_pk_bf16_f32 v230, v61, v62
    v_xor_b32 v238, 0x80000000, v230
    v_cos_f32 v61, v60
    v_add_f32 v60, v60, v56
    v_cos_f32 v62, v60
    v_add_f32 v60, v60, v56
    v_cvt_pk_bf16_f32 v231, v61, v62
    v_xor_b32 v239, 0x80000000, v231
    v_add_f32 v60, 0xbe800000, v59
    v_cos_f32 v61, v60
    v_add_f32 v60, v60, v56
    v_cos_f32 v62, v60
    v_add_f32 v60, v60, v56
    v_cvt_pk_bf16_f32 v244, v61, v62
    v_xor_b32 v252, 0x80000000, v244
    s_add_u32 m0, s56, 84992
    s_add_u32 s48, s58, 36864
    buffer_load_dwordx4 v1, s[16:19], s48 offen lds
    v_cos_f32 v61, v60
    v_add_f32 v60, v60, v56
    v_cos_f32 v62, v60
    v_add_f32 v60, v60, v56
    v_cvt_pk_bf16_f32 v245, v61, v62
    v_xor_b32 v253, 0x80000000, v245
    v_cos_f32 v61, v60
    v_add_f32 v60, v60, v56
    v_cos_f32 v62, v60
    v_add_f32 v60, v60, v56
    v_cvt_pk_bf16_f32 v246, v61, v62
    v_xor_b32 v254, 0x80000000, v246
    v_cos_f32 v61, v60
    v_add_f32 v60, v60, v56
    v_cos_f32 v62, v60
    v_add_f32 v60, v60, v56
    v_cvt_pk_bf16_f32 v247, v61, v62
    v_xor_b32 v255, 0x80000000, v247
    s_bfe_u32 s48, s2, 0x20001
    s_lshl_b32 s48, s48, 2
    s_lshr_b32 s48, 0x9f51, s48
    s_and_b32 s79, s48, 15
    s_cmp_gt_u32 s46, s79
    s_cselect_b32 s48, 1, 0
    s_lshr_b32 s50, s2, 6
    s_sub_u32 s50, s50, s48
    s_lshl_b32 s50, s50, 3
    s_bfe_u32 s48, s2, 0x30003
    s_add_u32 s50, s50, s48
    s_lshl_b32 s50, s50, 2
    s_add_u32 s50, s50, s47
    s_mul_i32 s50, s50, 6
    s_and_b32 s48, s2, 1
    s_mul_i32 s48, s48, 320
    s_add_u32 s50, s50, s48
    s_add_u32 s50, s50, 256
    v_min_u32 v61, 11, v0
    v_lshrrev_b32 v60, 1, v61
    v_add_u32 v60, s50, v60
    v_subrev_u32 v62, 640, v60
    v_min_u32 v60, v60, v62
    v_mul_u32_u24 v60, 3072, v60
    v_and_b32 v61, 1, v61
    v_lshl_add_u32 v60, v61, 7, v60
    s_lshl_b32 s48, s79, 8
    s_cmp_eq_u32 s46, s79
    s_cselect_b32 s48, 0x20000000, s48
    s_cmp_eq_u32 s79, 15
    s_cselect_b32 s48, 0x20000000, s48
    v_add_u32 v60, s48, v60
    buffer_load_dword v62, v60, s[12:15], 0 offen
    buffer_load_dword v62, v60, s[16:19], 0 offen
    s_waitcnt vmcnt(14) lgkmcnt(0)
    s_barrier
    s_mul_i32 s62, s62, 0x9E3779B1
    s_add_u32 s62, s62, 0x7F4A7C15
    s_add_u32 s48, s61, 0
    s_lshl_b32 s57, s48, 7
    s_add_u32 s57, s57, s54
    s_mul_i32 s58, s48, 196608
    s_add_u32 s58, s58, s55
    s_add_u32 s61, s61, 1
    s_cmp_eq_u32 s61, 10
    s_cselect_b32 s61, 0, s61
    s_add_u32 m0, s56, 98304
    s_add_u32 s48, s57, 0
    buffer_load_dwordx4 v2, s[8:11], s48 offen lds
    s_add_u32 m0, s56, 99328
    s_add_u32 s48, s57, 655360
    buffer_load_dwordx4 v3, s[8:11], s48 offen lds
    s_add_u32 m0, s56, 100352
    s_add_u32 s48, s57, 1310720
    buffer_load_dwordx4 v2, s[8:11], s48 offen lds
    s_add_u32 m0, s56, 101376
    s_add_u32 s48, s57, 1966080
    buffer_load_dwordx4 v3, s[8:11], s48 offen lds
    s_add_u32 m0, s56, 114688
    s_add_u32 s48, s58, 0
    buffer_load_dwordx4 v4, s[12:15], s48 offen lds
    s_add_u32 m0, s56, 115712
    s_add_u32 s48, s58, 12288
    buffer_load_dwordx4 v4, s[12:15], s48 offen lds
    s_add_u32 m0, s56, 116736
    s_add_u32 s48, s58, 24576
    buffer_load_dwordx4 v1, s[12:15], s48 offen lds
    s_add_u32 m0, s56, 117760
    s_add_u32 s48, s58, 36864
    buffer_load_dwordx4 v1, s[12:15], s48 offen lds
    s_add_u32 m0, s56, 131072
    s_add_u32 s48, s58, 0
    buffer_load_dwordx4 v4, s[16:19], s48 offen lds
    s_add_u32 m0, s56, 132096
    s_add_u32 s48, s58, 12288
    buffer_load_dwordx4 v4, s[16:19], s48 offen lds
    s_add_u32 m0, s56, 133120
    s_add_u32 s48, s58, 24576
    buffer_load_dwordx4 v1, s[16:19], s48 offen lds
    s_add_u32 m0, s56, 134144
    s_add_u32 s48, s58, 36864
    buffer_load_dwordx4 v1, s[16:19], s48 offen lds
    v_lshrrev_b32 v12, 3, v0
    v_mul_u32_u24 v13, 1280, v12
    v_bfe_u32 v14, v0, 4, 2
    v_lshlrev_b32 v14, 1, v14
    v_and_b32 v12, 7, v0
    v_xor_b32 v12, v12, v14
    v_lshl_add_u32 v12, v12, 4, v13
    s_mov_b32 s77, s2
    s_bfe_u32 s48, s2, 0x20001
    s_lshl_b32 s48, s48, 3
    s_lshr_b32 s48, 0x5a3c0082, s48
    s_and_b32 s48, s48, 255
    s_add_u32 s48, s48, s2
    s_sub_u32 s48, s48, 160
    s_cmp_ge_u32 s2, 160
    s_cselect_b32 s77, s48, s77
    s_and_b32 s48, s2, 31
    s_add_u32 s48, s48, 160
    s_and_b32 s50, s46, 11
    s_cmp_eq_u32 s50, 1
    s_cselect_b32 s77, s48, s77
    s_mul_i32 s50, s77, 3
    s_add_u32 s50, s50, s47
    s_cmp_eq_u32 s47, 3
    s_cselect_b32 s50, 480, s50
    s_mul_i32 s52, s50, 52429
    s_lshr_b32 s52, s52, 19
    s_mul_i32 s48, s52, 10
    s_sub_u32 s50, s50, s48
    s_mul_i32 s51, s52, 40960
    s_lshl_b32 s48, s50, 7
    s_add_u32 s51, s51, s48
    s_min_u32 s6, s47, 2
    s_lshl_b32 s6, s6, 12
    s_add_u32 s6, s6, 149632
    s_cmp_ge_u32 s52, 48
    s_cbranch_scc1 L_norp_2
    s_add_u32 m0, s6, 0
    s_add_u32 s48, s51, 0
    buffer_load_dwordx4 v12, s[36:39], s48 offen lds
    s_add_u32 m0, s6, 1024
    s_add_u32 s48, s51, 10240
    buffer_load_dwordx4 v12, s[36:39], s48 offen lds
    s_add_u32 m0, s6, 2048
    s_add_u32 s48, s51, 20480
    buffer_load_dwordx4 v12, s[36:39], s48 offen lds
    s_add_u32 m0, s6, 3072
    s_add_u32 s48, s51, 30720
    buffer_load_dwordx4 v12, s[36:39], s48 offen lds
L_norp_2:
    s_mul_i32 s7, s50, 196608
    s_lshl_b32 s48, s52, 10
    s_add_u32 s7, s7, s48
    s_add_u32 s7, s7, 0xbc0000
    s_mov_b32 s81, s52
    s_cmp_ge_u32 s81, 48
    s_cbranch_scc1 L_w2_3
    s_waitcnt vmcnt(16)
    s_branch L_w2_4
L_w2_3:
    s_waitcnt vmcnt(12)
L_w2_4:
    s_barrier
    s_add_u32 s48, s61, 0
    s_lshl_b32 s57, s48, 7
    s_add_u32 s57, s57, s54
    s_mul_i32 s58, s48, 196608
    s_add_u32 s58, s58, s55
    s_add_u32 s61, s61, 1
    s_cmp_eq_u32 s61, 10
    s_cselect_b32 s61, 0, s61
    s_add_u32 m0, s56, 0
    s_add_u32 s48, s57, 0
    buffer_load_dwordx4 v2, s[8:11], s48 offen lds
    s_lshr_b32 s83, s47, 1
    s_lshl_b32 s83, s83, 5
    s_and_b32 s67, s47, 1
    s_add_u32 s83, s83, s67
    v_lshrrev_b32 v146, 4, v0
    v_lshl_add_u32 v147, v146, 3, s83
    v_cmp_eq_u32 vcc, 0, v147
    v_cvt_f32_u32 v147, v147
    v_cndmask_b32 v145, 1.0, 0.5, vcc
    s_add_u32 m0, s56, 1024
    s_add_u32 s48, s57, 655360
    buffer_load_dwordx4 v3, s[8:11], s48 offen lds
    s_lshr_b32 s83, s65, 1
    s_and_b32 s67, s65, 1
    s_mul_i32 s67, s67, 20
    s_add_u32 s83, s83, s67
    s_add_u32 s83, s83, 16
    s_lshl_b32 s83, s83, 4
    s_lshl_b32 s67, s65, 5
    v_and_b32 v146, 15, v0
    s_add_u32 m0, s56, 2048
    s_add_u32 s48, s57, 1310720
    buffer_load_dwordx4 v2, s[8:11], s48 offen lds
    v_add_u32 v148, s67, v146
    v_cvt_f32_u32 v148, v148
    v_mul_f32 v149, v147, v148
    v_mul_f32 v149, 0x3acccccd, v149
    v_fract_f32 v136, v149
    v_mul_f32 v149, 0x3dcccccd, v148
    v_fract_f32 v139, v149
    v_mul_f32 v142, 0x3b4ccccd, v148
    s_add_u32 m0, s56, 3072
    s_add_u32 s48, s57, 1966080
    buffer_load_dwordx4 v3, s[8:11], s48 offen lds
    v_add_u32 v148, s67, v146
    v_add_u32 v148, 16, v148
    v_cvt_f32_u32 v148, v148
    v_mul_f32 v149, v147, v148
    v_mul_f32 v149, 0x3acccccd, v149
    v_fract_f32 v137, v149
    v_mul_f32 v149, 0x3dcccccd, v148
    v_fract_f32 v140, v149
    v_mul_f32 v143, 0x3b4ccccd, v148
    s_add_u32 m0, s56, 16384
    s_add_u32 s48, s58, 0
    buffer_load_dwordx4 v4, s[12:15], s48 offen lds
    v_add_u32 v148, s83, v146
    v_cvt_f32_u32 v148, v148
    v_mul_f32 v149, v147, v148
    v_mul_f32 v149, 0x3acccccd, v149
    v_fract_f32 v138, v149
    v_mul_f32 v149, 0x3dcccccd, v148
    v_fract_f32 v141, v149
    v_mul_f32 v144, 0x3b4ccccd, v148
    s_add_u32 m0, s56, 17408
    s_add_u32 s48, s58, 12288
    buffer_load_dwordx4 v4, s[12:15], s48 offen lds
    v_mov_b32 v146, v136
    v_cos_f32 v148, v146
    v_sin_f32_e64 v152, -v146
    v_add_f32 v146, v146, v142
    v_cos_f32 v149, v146
    v_sin_f32_e64 v153, -v146
    v_add_f32 v146, v146, v142
    v_cos_f32 v150, v146
    s_add_u32 m0, s56, 18432
    s_add_u32 s48, s58, 24576
    buffer_load_dwordx4 v1, s[12:15], s48 offen lds
    v_sin_f32_e64 v154, -v146
    v_add_f32 v146, v146, v142
    v_cos_f32 v151, v146
    v_sin_f32_e64 v155, -v146
    v_mul_f32 v148, v145, v148
    v_cvt_pk_bf16_f32 v64, v148, v149
    v_cvt_pk_bf16_f32 v65, v150, v151
    v_cvt_pk_bf16_f32 v66, v152, v153
    v_cvt_pk_bf16_f32 v67, v154, v155
    s_add_u32 m0, s56, 19456
    s_add_u32 s48, s58, 36864
    buffer_load_dwordx4 v1, s[12:15], s48 offen lds
    v_mov_b32 v146, v137
    v_cos_f32 v148, v146
    v_sin_f32_e64 v152, -v146
    v_add_f32 v146, v146, v143
    v_cos_f32 v149, v146
    v_sin_f32_e64 v153, -v146
    v_add_f32 v146, v146, v143
    v_cos_f32 v150, v146
    s_add_u32 m0, s56, 32768
    s_add_u32 s48, s58, 0
    buffer_load_dwordx4 v4, s[16:19], s48 offen lds
    v_sin_f32_e64 v154, -v146
    v_add_f32 v146, v146, v143
    v_cos_f32 v151, v146
    v_sin_f32_e64 v155, -v146
    v_mul_f32 v148, v145, v148
    v_cvt_pk_bf16_f32 v68, v148, v149
    v_cvt_pk_bf16_f32 v69, v150, v151
    v_cvt_pk_bf16_f32 v70, v152, v153
    s_add_u32 m0, s56, 33792
    s_add_u32 s48, s58, 12288
    buffer_load_dwordx4 v4, s[16:19], s48 offen lds
    v_cvt_pk_bf16_f32 v71, v154, v155
    v_and_b32 v146, 1, v0
    v_lshlrev_b32 v146, 15, v146
    v_or_b32 v146, 0x3f00, v146
    v_cmp_gt_u32 vcc, 16, v0
    v_cndmask_b32 v124, 0, v146, vcc
    v_mov_b32 v125, 0
    v_mov_b32 v126, 0
    v_mov_b32 v127, 0
    s_add_u32 m0, s56, 34816
    s_add_u32 s48, s58, 24576
    buffer_load_dwordx4 v1, s[16:19], s48 offen lds
    v_and_b32 v146, 1, v0
    v_lshlrev_b32 v146, 15, v146
    v_or_b32 v146, 0x3f00, v146
    v_cmp_gt_u32 vcc, 16, v0
    v_cndmask_b32 v128, 0, v146, vcc
    v_mov_b32 v129, 0
    v_mov_b32 v130, 0
    v_mov_b32 v131, 0
    s_add_u32 m0, s56, 35840
    s_add_u32 s48, s58, 36864
    buffer_load_dwordx4 v1, s[16:19], s48 offen lds
    v_and_b32 v146, 1, v0
    v_lshlrev_b32 v146, 15, v146
    v_or_b32 v146, 0x3f00, v146
    v_cmp_gt_u32 vcc, 16, v0
    v_cndmask_b32 v132, 0, v146, vcc
    v_mov_b32 v133, 0
    v_mov_b32 v134, 0
    v_mov_b32 v135, 0
    s_cmp_ge_u32 s81, 48
    s_cbranch_scc1 L_w2_5
    s_waitcnt vmcnt(16)
    s_branch L_w2_6
L_w2_5:
    s_waitcnt vmcnt(12)
L_w2_6:
    s_barrier
    s_add_u32 s48, s61, 0
    s_lshl_b32 s57, s48, 7
    s_add_u32 s57, s57, s54
    s_mul_i32 s58, s48, 196608
    s_add_u32 s58, s58, s55
    s_add_u32 s61, s61, 1
    s_cmp_eq_u32 s61, 10
    s_cselect_b32 s61, 0, s61
    s_add_u32 m0, s56, 49152
    s_add_u32 s48, s57, 0
    buffer_load_dwordx4 v2, s[8:11], s48 offen lds
    s_add_u32 m0, s56, 50176
    s_add_u32 s48, s57, 655360
    buffer_load_dwordx4 v3, s[8:11], s48 offen lds
    s_add_u32 m0, s56, 51200
    s_add_u32 s48, s57, 1310720
    buffer_load_dwordx4 v2, s[8:11], s48 offen lds
    s_add_u32 m0, s56, 52224
    s_add_u32 s48, s57, 1966080
    buffer_load_dwordx4 v3, s[8:11], s48 offen lds
    s_add_u32 m0, s56, 65536
    s_add_u32 s48, s58, 0
    buffer_load_dwordx4 v4, s[12:15], s48 offen lds
    s_add_u32 m0, s56, 66560
    s_add_u32 s48, s58, 12288
    buffer_load_dwordx4 v4, s[12:15], s48 offen lds
    s_add_u32 m0, s56, 67584
    s_add_u32 s48, s58, 24576
    buffer_load_dwordx4 v1, s[12:15], s48 offen lds
    s_add_u32 m0, s56, 68608
    s_add_u32 s48, s58, 36864
    buffer_load_dwordx4 v1, s[12:15], s48 offen lds
    s_add_u32 m0, s56, 81920
    s_add_u32 s48, s58, 0
    buffer_load_dwordx4 v4, s[16:19], s48 offen lds
    s_add_u32 m0, s56, 82944
    s_add_u32 s48, s58, 12288
    buffer_load_dwordx4 v4, s[16:19], s48 offen lds
    s_add_u32 m0, s56, 83968
    s_add_u32 s48, s58, 24576
    buffer_load_dwordx4 v1, s[16:19], s48 offen lds
    s_add_u32 m0, s56, 84992
    s_add_u32 s48, s58, 36864
    buffer_load_dwordx4 v1, s[16:19], s48 offen lds
    s_waitcnt vmcnt(24)
    s_cmp_ge_u32 s81, 48
    s_cbranch_scc1 L_norp_7
    v_lshrrev_b32 v56, 2, v0
    v_lshlrev_b32 v56, 7, v56
    v_and_b32 v57, 3, v0
    v_lshl_add_u32 v56, v57, 3, v56
    v_bfe_u32 v57, v0, 3, 2
    v_lshl_add_u32 v56, v57, 5, v56
    v_add_u32 v56, s6, v56
    v_xor_b32 v57, 32, v56
    v_xor_b32 v58, 64, v56
    v_xor_b32 v59, 96, v56
    ds_read_b64_tr_b16 v[16:17], v56 offset:0
    ds_read_b64_tr_b16 v[18:19], v56 offset:2048
    ds_read_b64_tr_b16 v[20:21], v57 offset:0
    ds_read_b64_tr_b16 v[22:23], v57 offset:2048
    ds_read_b64_tr_b16 v[24:25], v58 offset:0
    ds_read_b64_tr_b16 v[26:27], v58 offset:2048
    ds_read_b64_tr_b16 v[28:29], v59 offset:0
    ds_read_b64_tr_b16 v[30:31], v59 offset:2048
    s_waitcnt lgkmcnt(6)
    s_add_u32 s48, s7, 0
    buffer_store_dwordx4 v[16:19], v5, s[20:23], s48 offen sc1
    s_waitcnt lgkmcnt(4)
    s_add_u32 s48, s7, 49152
    buffer_store_dwordx4 v[20:23], v5, s[20:23], s48 offen sc1
    s_waitcnt lgkmcnt(2)
    s_add_u32 s48, s7, 98304
    buffer_store_dwordx4 v[24:27], v5, s[20:23], s48 offen sc1
    s_waitcnt lgkmcnt(0)
    s_add_u32 s48, s7, 147456
    buffer_store_dwordx4 v[28:31], v5, s[20:23], s48 offen sc1
L_norp_7:
    s_cmp_ge_u32 s81, 48
    s_cbranch_scc1 L_w2_8
    s_waitcnt vmcnt(16)
    s_branch L_w2_9
L_w2_8:
    s_waitcnt vmcnt(12)
L_w2_9:
    s_barrier
    s_add_u32 s48, s61, 0
    s_lshl_b32 s57, s48, 7
    s_add_u32 s57, s57, s54
    s_mul_i32 s58, s48, 196608
    s_add_u32 s58, s58, s55
    s_add_u32 s61, s61, 1
    s_cmp_eq_u32 s61, 10
    s_cselect_b32 s61, 0, s61
    s_add_u32 m0, s56, 98304
    s_add_u32 s48, s57, 0
    buffer_load_dwordx4 v2, s[8:11], s48 offen lds
    v_mov_b32 v146, v138
    v_cos_f32 v148, v146
    v_sin_f32_e64 v152, -v146
    v_add_f32 v146, v146, v144
    v_cos_f32 v149, v146
    s_add_u32 m0, s56, 99328
    s_add_u32 s48, s57, 655360
    buffer_load_dwordx4 v3, s[8:11], s48 offen lds
    v_sin_f32_e64 v153, -v146
    v_add_f32 v146, v146, v144
    v_cos_f32 v150, v146
    v_sin_f32_e64 v154, -v146
    s_add_u32 m0, s56, 100352
    s_add_u32 s48, s57, 1310720
    buffer_load_dwordx4 v2, s[8:11], s48 offen lds
    v_add_f32 v146, v146, v144
    v_cos_f32 v151, v146
    v_sin_f32_e64 v155, -v146
    v_mul_f32 v148, v145, v148
    s_add_u32 m0, s56, 101376
    s_add_u32 s48, s57, 1966080
    buffer_load_dwordx4 v3, s[8:11], s48 offen lds
    v_cvt_pk_bf16_f32 v72, v148, v149
    v_cvt_pk_bf16_f32 v73, v150, v151
    v_cvt_pk_bf16_f32 v74, v152, v153
    v_cvt_pk_bf16_f32 v75, v154, v155
    s_add_u32 m0, s56, 114688
    s_add_u32 s48, s58, 0
    buffer_load_dwordx4 v4, s[12:15], s48 offen lds
    v_fma_f32 v146, 1.0, v139, v136
    v_cos_f32 v148, v146
    v_sin_f32_e64 v152, -v146
    v_add_f32 v146, v146, v142
    s_add_u32 m0, s56, 115712
    s_add_u32 s48, s58, 12288
    buffer_load_dwordx4 v4, s[12:15], s48 offen lds
    v_cos_f32 v149, v146
    v_sin_f32_e64 v153, -v146
    v_add_f32 v146, v146, v142
    v_cos_f32 v150, v146
    s_add_u32 m0, s56, 116736
    s_add_u32 s48, s58, 24576
    buffer_load_dwordx4 v1, s[12:15], s48 offen lds
    v_sin_f32_e64 v154, -v146
    v_add_f32 v146, v146, v142
    v_cos_f32 v151, v146
    v_sin_f32_e64 v155, -v146
    s_add_u32 m0, s56, 117760
    s_add_u32 s48, s58, 36864
    buffer_load_dwordx4 v1, s[12:15], s48 offen lds
    v_cvt_pk_bf16_f32 v76, v148, v149
    v_cvt_pk_bf16_f32 v77, v150, v151
    v_cvt_pk_bf16_f32 v78, v152, v153
    v_cvt_pk_bf16_f32 v79, v154, v155
    s_add_u32 m0, s56, 131072
    s_add_u32 s48, s58, 0
    buffer_load_dwordx4 v4, s[16:19], s48 offen lds
    v_fma_f32 v146, 1.0, v140, v137
    v_cos_f32 v148, v146
    v_sin_f32_e64 v152, -v146
    v_add_f32 v146, v146, v143
    s_add_u32 m0, s56, 132096
    s_add_u32 s48, s58, 12288
    buffer_load_dwordx4 v4, s[16:19], s48 offen lds
    v_cos_f32 v149, v146
    v_sin_f32_e64 v153, -v146
    v_add_f32 v146, v146, v143
    v_cos_f32 v150, v146
    s_add_u32 m0, s56, 133120
    s_add_u32 s48, s58, 24576
    buffer_load_dwordx4 v1, s[16:19], s48 offen lds
    v_sin_f32_e64 v154, -v146
    v_add_f32 v146, v146, v143
    v_cos_f32 v151, v146
    v_sin_f32_e64 v155, -v146
    s_add_u32 m0, s56, 134144
    s_add_u32 s48, s58, 36864
    buffer_load_dwordx4 v1, s[16:19], s48 offen lds
    v_cvt_pk_bf16_f32 v80, v148, v149
    v_cvt_pk_bf16_f32 v81, v150, v151
    v_cvt_pk_bf16_f32 v82, v152, v153
    v_cvt_pk_bf16_f32 v83, v154, v155
    s_waitcnt vmcnt(12)
    s_barrier
    s_cmp_lg_u32 s47, 0
    s_cbranch_scc1 L_nocf_10
    s_lshl_b32 s50, s77, 7
    s_add_u32 s50, s50, 0x50000
    v_mov_b32 v16, s62
    v_mov_b32 v17, 0
    s_mov_b64 exec, 1
    buffer_store_dword v16, v17, s[20:23], s50 offen sc1
    s_mov_b64 exec, -1
L_nocf_10:
    s_add_u32 s48, s61, 0
    s_lshl_b32 s57, s48, 7
    s_add_u32 s57, s57, s54
    s_mul_i32 s58, s48, 196608
    s_add_u32 s58, s58, s55
    s_add_u32 s61, s61, 1
    s_cmp_eq_u32 s61, 10
    s_cselect_b32 s61, 0, s61
    s_add_u32 m0, s56, 0
    s_add_u32 s48, s57, 0
    buffer_load_dwordx4 v2, s[8:11], s48 offen lds
    v_fma_f32 v146, 1.0, v141, v138
    v_cos_f32 v148, v146
    v_sin_f32_e64 v152, -v146
    v_add_f32 v146, v146, v144
    s_add_u32 m0, s56, 1024
    s_add_u32 s48, s57, 655360
    buffer_load_dwordx4 v3, s[8:11], s48 offen lds
    v_cos_f32 v149, v146
    v_sin_f32_e64 v153, -v146
    v_add_f32 v146, v146, v144
    v_cos_f32 v150, v146
    s_add_u32 m0, s56, 2048
    s_add_u32 s48, s57, 1310720
    buffer_load_dwordx4 v2, s[8:11], s48 offen lds
    v_sin_f32_e64 v154, -v146
    v_add_f32 v146, v146, v144
    v_cos_f32 v151, v146
    v_sin_f32_e64 v155, -v146
    s_add_u32 m0, s56, 3072
    s_add_u32 s48, s57, 1966080
    buffer_load_dwordx4 v3, s[8:11], s48 offen lds
    v_cvt_pk_bf16_f32 v84, v148, v149
    v_cvt_pk_bf16_f32 v85, v150, v151
    v_cvt_pk_bf16_f32 v86, v152, v153
    v_cvt_pk_bf16_f32 v87, v154, v155
    s_add_u32 m0, s56, 16384
    s_add_u32 s48, s58, 0
    buffer_load_dwordx4 v4, s[12:15], s48 offen lds
    v_fma_f32 v146, 2.0, v139, v136
    v_cos_f32 v148, v146
    v_sin_f32_e64 v152, -v146
    v_add_f32 v146, v146, v142
    s_add_u32 m0, s56, 17408
    s_add_u32 s48, s58, 12288
    buffer_load_dwordx4 v4, s[12:15], s48 offen lds
    v_cos_f32 v149, v146
    v_sin_f32_e64 v153, -v146
    v_add_f32 v146, v146, v142
    v_cos_f32 v150, v146
    s_add_u32 m0, s56, 18432
    s_add_u32 s48, s58, 24576
    buffer_load_dwordx4 v1, s[12:15], s48 offen lds
    v_sin_f32_e64 v154, -v146
    v_add_f32 v146, v146, v142
    v_cos_f32 v151, v146
    v_sin_f32_e64 v155, -v146
    s_add_u32 m0, s56, 19456
    s_add_u32 s48, s58, 36864
    buffer_load_dwordx4 v1, s[12:15], s48 offen lds
    v_cvt_pk_bf16_f32 v88, v148, v149
    v_cvt_pk_bf16_f32 v89, v150, v151
    v_cvt_pk_bf16_f32 v90, v152, v153
    v_cvt_pk_bf16_f32 v91, v154, v155
    s_add_u32 m0, s56, 32768
    s_add_u32 s48, s58, 0
    buffer_load_dwordx4 v4, s[16:19], s48 offen lds
    v_fma_f32 v146, 2.0, v140, v137
    v_cos_f32 v148, v146
    v_sin_f32_e64 v152, -v146
    v_add_f32 v146, v146, v143
    s_add_u32 m0, s56, 33792
    s_add_u32 s48, s58, 12288
    buffer_load_dwordx4 v4, s[16:19], s48 offen lds
    v_cos_f32 v149, v146
    v_sin_f32_e64 v153, -v146
    v_add_f32 v146, v146, v143
    v_cos_f32 v150, v146
    s_add_u32 m0, s56, 34816
    s_add_u32 s48, s58, 24576
    buffer_load_dwordx4 v1, s[16:19], s48 offen lds
    v_sin_f32_e64 v154, -v146
    v_add_f32 v146, v146, v143
    v_cos_f32 v151, v146
    v_sin_f32_e64 v155, -v146
    s_add_u32 m0, s56, 35840
    s_add_u32 s48, s58, 36864
    buffer_load_dwordx4 v1, s[16:19], s48 offen lds
    v_cvt_pk_bf16_f32 v92, v148, v149
    v_cvt_pk_bf16_f32 v93, v150, v151
    v_cvt_pk_bf16_f32 v94, v152, v153
    v_cvt_pk_bf16_f32 v95, v154, v155
    s_waitcnt vmcnt(12)
    s_barrier
    s_add_u32 s48, s61, 0
    s_lshl_b32 s57, s48, 7
    s_add_u32 s57, s57, s54
    s_mul_i32 s58, s48, 196608
    s_add_u32 s58, s58, s55
    s_add_u32 s61, s61, 1
    s_cmp_eq_u32 s61, 10
    s_cselect_b32 s61, 0, s61
    s_add_u32 m0, s56, 49152
    s_add_u32 s48, s57, 0
    buffer_load_dwordx4 v2, s[8:11], s48 offen lds
    v_fma_f32 v146, 2.0, v141, v138
    v_cos_f32 v148, v146
    v_sin_f32_e64 v152, -v146
    s_add_u32 m0, s56, 50176
    s_add_u32 s48, s57, 655360
    buffer_load_dwordx4 v3, s[8:11], s48 offen lds
    v_add_f32 v146, v146, v144
    v_cos_f32 v149, v146
    v_sin_f32_e64 v153, -v146
    s_add_u32 m0, s56, 51200
    s_add_u32 s48, s57, 1310720
    buffer_load_dwordx4 v2, s[8:11], s48 offen lds
    v_add_f32 v146, v146, v144
    v_cos_f32 v150, v146
    v_sin_f32_e64 v154, -v146
    s_add_u32 m0, s56, 52224
    s_add_u32 s48, s57, 1966080
    buffer_load_dwordx4 v3, s[8:11], s48 offen lds
    v_add_f32 v146, v146, v144
    v_cos_f32 v151, v146
    s_add_u32 m0, s56, 65536
    s_add_u32 s48, s58, 0
    buffer_load_dwordx4 v4, s[12:15], s48 offen lds
    v_sin_f32_e64 v155, -v146
    v_cvt_pk_bf16_f32 v96, v148, v149
    v_cvt_pk_bf16_f32 v97, v150, v151
    s_add_u32 m0, s56, 66560
    s_add_u32 s48, s58, 12288
    buffer_load_dwordx4 v4, s[12:15], s48 offen lds
    v_cvt_pk_bf16_f32 v98, v152, v153
    v_cvt_pk_bf16_f32 v99, v154, v155
    v_fma_f32 v146, 4.0, v139, v136
    s_add_u32 m0, s56, 67584
    s_add_u32 s48, s58, 24576
    buffer_load_dwordx4 v1, s[12:15], s48 offen lds
    v_sub_f32 v146, v146, v139
    v_cos_f32 v148, v146
    v_sin_f32_e64 v152, -v146
    s_add_u32 m0, s56, 68608
    s_add_u32 s48, s58, 36864
    buffer_load_dwordx4 v1, s[12:15], s48 offen lds
    v_add_f32 v146, v146, v142
    v_cos_f32 v149, v146
    s_add_u32 m0, s56, 81920
    s_add_u32 s48, s58, 0
    buffer_load_dwordx4 v4, s[16:19], s48 offen lds
    v_sin_f32_e64 v153, -v146
    v_add_f32 v146, v146, v142
    v_cos_f32 v150, v146
    s_add_u32 m0, s56, 82944
    s_add_u32 s48, s58, 12288
    buffer_load_dwordx4 v4, s[16:19], s48 offen lds
    v_sin_f32_e64 v154, -v146
    v_add_f32 v146, v146, v142
    v_cos_f32 v151, v146
    s_add_u32 m0, s56, 83968
    s_add_u32 s48, s58, 24576
    buffer_load_dwordx4 v1, s[16:19], s48 offen lds
    v_sin_f32_e64 v155, -v146
    v_cvt_pk_bf16_f32 v100, v148, v149
    v_cvt_pk_bf16_f32 v101, v150, v151
    s_add_u32 m0, s56, 84992
    s_add_u32 s48, s58, 36864
    buffer_load_dwordx4 v1, s[16:19], s48 offen lds
    v_cvt_pk_bf16_f32 v102, v152, v153
    v_cvt_pk_bf16_f32 v103, v154, v155
    s_lshr_b32 s50, s2, 3
    s_lshl_b32 s50, s50, 2
    s_add_u32 s50, s50, s47
    s_mul_i32 s48, s50, 54
    v_min_u32 v12, 53, v0
    v_add_u32 v12, s48, v12
    v_lshrrev_b32 v13, 8, v12
    v_and_b32 v12, 255, v12
    s_and_b32 s48, s2, 1
    s_lshl_b32 s49, s48, 3
    s_lshl_b32 s48, s48, 1
    s_add_u32 s48, s48, 16
    v_cmp_gt_u32 vcc, 16, v13
    v_and_b32 v14, 7, v13
    v_add_u32 v14, s49, v14
    v_bfe_u32 v17, v13, 3, 1
    v_mad_u32_u24 v14, v17, 20, v14
    v_and_b32 v16, 1, v13
    v_add_u32 v16, s48, v16
    v_bfe_u32 v17, v13, 1, 1
    v_mad_u32_u24 v16, v17, 20, v16
    v_cndmask_b32 v13, v16, v14, vcc
    v_mul_u32_u24 v13, 49152, v13
    v_lshl_add_u32 v60, v12, 7, v13
    s_waitcnt vmcnt(12)
    s_barrier
    s_add_u32 s48, s61, 0
    s_lshl_b32 s57, s48, 7
    s_add_u32 s57, s57, s54
    s_mul_i32 s58, s48, 196608
    s_add_u32 s58, s58, s55
    s_add_u32 s61, s61, 1
    s_cmp_eq_u32 s61, 10
    s_cselect_b32 s61, 0, s61
    s_add_u32 m0, s56, 98304
    s_add_u32 s48, s57, 0
    buffer_load_dwordx4 v2, s[8:11], s48 offen lds
    v_fma_f32 v146, 4.0, v140, v137
    v_sub_f32 v146, v146, v140
    v_cos_f32 v148, v146
    v_sin_f32_e64 v152, -v146
    v_add_f32 v146, v146, v143
    s_add_u32 m0, s56, 99328
    s_add_u32 s48, s57, 655360
    buffer_load_dwordx4 v3, s[8:11], s48 offen lds
    v_cos_f32 v149, v146
    v_sin_f32_e64 v153, -v146
    v_add_f32 v146, v146, v143
    v_cos_f32 v150, v146
    s_add_u32 m0, s56, 100352
    s_add_u32 s48, s57, 1310720
    buffer_load_dwordx4 v2, s[8:11], s48 offen lds
    v_sin_f32_e64 v154, -v146
    v_add_f32 v146, v146, v143
    v_cos_f32 v151, v146
    v_sin_f32_e64 v155, -v146
    s_add_u32 m0, s56, 101376
    s_add_u32 s48, s57, 1966080
    buffer_load_dwordx4 v3, s[8:11], s48 offen lds
    v_cvt_pk_bf16_f32 v104, v148, v149
    v_cvt_pk_bf16_f32 v105, v150, v151
    v_cvt_pk_bf16_f32 v106, v152, v153
    v_cvt_pk_bf16_f32 v107, v154, v155
    s_add_u32 m0, s56, 114688
    s_add_u32 s48, s58, 0
    buffer_load_dwordx4 v4, s[12:15], s48 offen lds
    v_fma_f32 v146, 4.0, v141, v138
    v_sub_f32 v146, v146, v141
    v_cos_f32 v148, v146
    v_sin_f32_e64 v152, -v146
    s_add_u32 m0, s56, 115712
    s_add_u32 s48, s58, 12288
    buffer_load_dwordx4 v4, s[12:15], s48 offen lds
    v_add_f32 v146, v146, v144
    v_cos_f32 v149, v146
    v_sin_f32_e64 v153, -v146
    v_add_f32 v146, v146, v144
    s_add_u32 m0, s56, 116736
    s_add_u32 s48, s58, 24576
    buffer_load_dwordx4 v1, s[12:15], s48 offen lds
    v_cos_f32 v150, v146
    v_sin_f32_e64 v154, -v146
    v_add_f32 v146, v146, v144
    v_cos_f32 v151, v146
    v_sin_f32_e64 v155, -v146
    s_add_u32 m0, s56, 117760
    s_add_u32 s48, s58, 36864
    buffer_load_dwordx4 v1, s[12:15], s48 offen lds
    v_cvt_pk_bf16_f32 v108, v148, v149
    v_cvt_pk_bf16_f32 v109, v150, v151
    v_cvt_pk_bf16_f32 v110, v152, v153
    v_cvt_pk_bf16_f32 v111, v154, v155
    s_add_u32 m0, s56, 131072
    s_add_u32 s48, s58, 0
    buffer_load_dwordx4 v4, s[16:19], s48 offen lds
    v_fma_f32 v146, 4.0, v139, v136
    v_cos_f32 v148, v146
    v_sin_f32_e64 v152, -v146
    v_add_f32 v146, v146, v142
    s_add_u32 m0, s56, 132096
    s_add_u32 s48, s58, 12288
    buffer_load_dwordx4 v4, s[16:19], s48 offen lds
    v_cos_f32 v149, v146
    v_sin_f32_e64 v153, -v146
    v_add_f32 v146, v146, v142
    v_cos_f32 v150, v146
    s_add_u32 m0, s56, 133120
    s_add_u32 s48, s58, 24576
    buffer_load_dwordx4 v1, s[16:19], s48 offen lds
    v_sin_f32_e64 v154, -v146
    v_add_f32 v146, v146, v142
    v_cos_f32 v151, v146
    v_sin_f32_e64 v155, -v146
    s_add_u32 m0, s56, 134144
    s_add_u32 s48, s58, 36864
    buffer_load_dwordx4 v1, s[16:19], s48 offen lds
    v_cvt_pk_bf16_f32 v112, v148, v149
    v_cvt_pk_bf16_f32 v113, v150, v151
    v_cvt_pk_bf16_f32 v114, v152, v153
    v_cvt_pk_bf16_f32 v115, v154, v155
    s_waitcnt vmcnt(12)
    s_barrier
    s_mov_b32 s48, 0x1000
    buffer_load_dword v34, v15, s[20:23], s48 offen sc1
    s_mov_b32 s48, 0x50000
    buffer_load_dword v35, v10, s[20:23], s48 offen sc1
    s_add_u32 s48, s61, 0
    s_lshl_b32 s57, s48, 7
    s_add_u32 s57, s57, s54
    s_mul_i32 s58, s48, 196608
    s_add_u32 s58, s58, s55
    s_add_u32 s61, s61, 1
    s_cmp_eq_u32 s61, 10
    s_cselect_b32 s61, 0, s61
    s_add_u32 m0, s56, 0
    s_add_u32 s48, s57, 0
    buffer_load_dwordx4 v2, s[8:11], s48 offen lds
    v_fma_f32 v146, 4.0, v140, v137
    v_cos_f32 v148, v146
    v_sin_f32_e64 v152, -v146
    s_add_u32 m0, s56, 1024
    s_add_u32 s48, s57, 655360
    buffer_load_dwordx4 v3, s[8:11], s48 offen lds
    v_add_f32 v146, v146, v143
    v_cos_f32 v149, v146
    v_sin_f32_e64 v153, -v146
    s_add_u32 m0, s56, 2048
    s_add_u32 s48, s57, 1310720
    buffer_load_dwordx4 v2, s[8:11], s48 offen lds
    v_add_f32 v146, v146, v143
    v_cos_f32 v150, v146
    s_add_u32 m0, s56, 3072
    s_add_u32 s48, s57, 1966080
    buffer_load_dwordx4 v3, s[8:11], s48 offen lds
    v_sin_f32_e64 v154, -v146
    v_add_f32 v146, v146, v143
    v_cos_f32 v151, v146
    s_add_u32 m0, s56, 16384
    s_add_u32 s48, s58, 0
    buffer_load_dwordx4 v4, s[12:15], s48 offen lds
    v_sin_f32_e64 v155, -v146
    v_cvt_pk_bf16_f32 v116, v148, v149
    v_cvt_pk_bf16_f32 v117, v150, v151
    s_add_u32 m0, s56, 17408
    s_add_u32 s48, s58, 12288
    buffer_load_dwordx4 v4, s[12:15], s48 offen lds
    v_cvt_pk_bf16_f32 v118, v152, v153
    v_cvt_pk_bf16_f32 v119, v154, v155
    s_add_u32 m0, s56, 18432
    s_add_u32 s48, s58, 24576
    buffer_load_dwordx4 v1, s[12:15], s48 offen lds
    v_fma_f32 v146, 4.0, v141, v138
    v_cos_f32 v148, v146
    v_sin_f32_e64 v152, -v146
    s_add_u32 m0, s56, 19456
    s_add_u32 s48, s58, 36864
    buffer_load_dwordx4 v1, s[12:15], s48 offen lds
    v_add_f32 v146, v146, v144
    v_cos_f32 v149, v146
    v_sin_f32_e64 v153, -v146
    s_add_u32 m0, s56, 32768
    s_add_u32 s48, s58, 0
    buffer_load_dwordx4 v4, s[16:19], s48 offen lds
    v_add_f32 v146, v146, v144
    v_cos_f32 v150, v146
    s_add_u32 m0, s56, 33792
    s_add_u32 s48, s58, 12288
    buffer_load_dwordx4 v4, s[16:19], s48 offen lds
    v_sin_f32_e64 v154, -v146
    v_add_f32 v146, v146, v144
    v_cos_f32 v151, v146
    s_add_u32 m0, s56, 34816
    s_add_u32 s48, s58, 24576
    buffer_load_dwordx4 v1, s[16:19], s48 offen lds
    v_sin_f32_e64 v155, -v146
    v_cvt_pk_bf16_f32 v120, v148, v149
    v_cvt_pk_bf16_f32 v121, v150, v151
    s_add_u32 m0, s56, 35840
    s_add_u32 s48, s58, 36864
    buffer_load_dwordx4 v1, s[16:19], s48 offen lds
    v_cvt_pk_bf16_f32 v122, v152, v153
    v_cvt_pk_bf16_f32 v123, v154, v155
    s_lshr_b32 s73, s65, 1
    s_and_b32 s48, s65, 1
    s_mul_i32 s48, s48, 20
    s_add_u32 s73, s73, s48
    s_add_u32 s73, s73, 16
    s_lshl_b32 s73, s73, 5
    s_lshl_b32 s48, s47, 10
    s_add_u32 s48, s48, 0xbc0000
    s_mul_i32 s6, s65, 98304
    s_add_u32 s6, s6, s48
    s_mul_i32 s75, s73, 1536
    s_add_u32 s75, s75, s48
    s_waitcnt vmcnt(14)
    s_barrier
    s_waitcnt vmcnt(12)
    v_cmp_ne_u32 vcc, s62, v34
    s_cbranch_vccnz L_rare_11
L_back_12:
    v_cmp_ne_u32 vcc, s62, v35
    s_cbranch_vccnz L_rare_15
L_back_16:
    s_lshl_b32 s48, s45, 10
    s_add_u32 s48, s48, 0x28000
    buffer_load_dword v38, v36, s[20:23], s48 offen sc1
    s_mov_b32 s48, 0x30000
    buffer_load_dwordx4 v[40:43], v37, s[20:23], s48 offen sc1
    s_mov_b32 s48, 0x3c000
    buffer_load_dwordx4 v[44:47], v37, s[20:23], s48 offen sc1
    s_mov_b32 s48, 0x48000
    buffer_load_dwordx4 v[48:51], v52, s[20:23], s48 offen sc1
    s_mov_b32 s48, 0xbc4000
    buffer_load_dword v62, v60, s[20:23], s48 offen sc1
    s_waitcnt vmcnt(5)
    s_barrier
    s_mul_i32 s53, s47, 20480
    s_and_b32 s82, s65, 3
    s_mul_i32 s82, s82, 0
    s_and_b32 s48, s64, 7
    s_mul_i32 s48, s48, 0
    s_add_u32 s82, s82, s48
    s_waitcnt vmcnt(1)
    v_add_u32 v36, 147456, v36
    ds_write_b32 v36, v38
    v_pk_add_f32 v[40:41], v[40:41], v[44:45]
    v_pk_add_f32 v[42:43], v[42:43], v[46:47]
    v_pk_add_f32 v[40:41], v[40:41], v[48:49]
    v_pk_add_f32 v[42:43], v[42:43], v[50:51]
    v_mov_b32 v44, v40
    v_mov_b32 v45, v41
    v_mov_b32 v46, v42
    v_mov_b32 v47, v43
    s_nop 0
    v_permlane16_swap_b32 v40, v44
    v_permlane16_swap_b32 v41, v45
    v_permlane16_swap_b32 v42, v46
    v_permlane16_swap_b32 v43, v47
    s_nop 0
    v_add_f32 v40, v40, v44
    v_add_f32 v41, v41, v45
    v_add_f32 v42, v42, v46
    v_add_f32 v43, v43, v47
    v_mov_b32 v44, v40
    v_mov_b32 v45, v41
    v_mov_b32 v46, v42
    v_mov_b32 v47, v43
    s_nop 0
    v_permlane32_swap_b32 v40, v44
    v_permlane32_swap_b32 v41, v45
    v_permlane32_swap_b32 v42, v46
    v_permlane32_swap_b32 v43, v47
    s_nop 0
    v_add_f32 v40, v40, v44
    v_add_f32 v41, v41, v45
    v_add_f32 v42, v42, v46
    v_add_f32 v43, v43, v47
    s_lshl_b32 s48, s47, 8
    s_add_u32 s48, s48, 148480
    v_lshl_add_u32 v37, v39, 4, s48
    ds_write_b128 v37, v[40:43]
    s_waitcnt lgkmcnt(0)
    s_barrier
    v_mov_b32 v12, 149504
L_hout_19:
    s_sleep 1
    ds_read_b32 v13, v12 offset:4
    s_waitcnt lgkmcnt(0)
    v_cmp_ne_u32 vcc, 4, v13
    s_cbranch_vccnz L_hout_19
    s_mul_i32 s53, s47, 20480
    s_and_b32 s82, s65, 3
    s_mul_i32 s82, s82, 0
    s_and_b32 s48, s64, 7
    s_mul_i32 s48, s48, 0
    s_add_u32 s82, s82, s48
    s_add_u32 s67, s82, 0
    s_cmp_ge_u32 s67, 12
    s_cselect_b32 s48, 12, 0
    s_sub_u32 s67, s67, s48
    s_lshl_b32 s67, s67, 12
    s_add_u32 s49, s67, s6
    s_add_u32 m0, s53, 65536
    s_add_u32 s48, s49, 0
    buffer_load_dwordx4 v5, s[20:23], s48 offen sc1 lds
    s_add_u32 m0, s53, 66560
    s_add_u32 s48, s49, 49152
    buffer_load_dwordx4 v5, s[20:23], s48 offen sc1 lds
    s_add_u32 m0, s53, 67584
    s_add_u32 s48, s49, 983040
    buffer_load_dwordx4 v5, s[20:23], s48 offen sc1 lds
    s_add_u32 m0, s53, 68608
    s_add_u32 s48, s49, 1032192
    buffer_load_dwordx4 v5, s[20:23], s48 offen sc1 lds
    s_add_u32 m0, s53, 69632
    s_add_u32 s48, s67, s75
    buffer_load_dwordx4 v5, s[20:23], s48 offen sc1 lds
    s_add_u32 s67, s82, 1
    s_cmp_ge_u32 s67, 12
    s_cselect_b32 s48, 12, 0
    s_sub_u32 s67, s67, s48
    s_lshl_b32 s67, s67, 12
    s_add_u32 s49, s67, s6
    s_add_u32 m0, s53, 70656
    s_add_u32 s48, s49, 0
    buffer_load_dwordx4 v5, s[20:23], s48 offen sc1 lds
    s_add_u32 m0, s53, 71680
    s_add_u32 s48, s49, 49152
    buffer_load_dwordx4 v5, s[20:23], s48 offen sc1 lds
    s_add_u32 m0, s53, 72704
    s_add_u32 s48, s49, 983040
    buffer_load_dwordx4 v5, s[20:23], s48 offen sc1 lds
    s_add_u32 m0, s53, 73728
    s_add_u32 s48, s49, 1032192
    buffer_load_dwordx4 v5, s[20:23], s48 offen sc1 lds
    s_add_u32 m0, s53, 74752
    s_add_u32 s48, s67, s75
    buffer_load_dwordx4 v5, s[20:23], s48 offen sc1 lds
    s_add_u32 s67, s82, 2
    s_cmp_ge_u32 s67, 12
    s_cselect_b32 s48, 12, 0
    s_sub_u32 s67, s67, s48
    s_lshl_b32 s67, s67, 12
    s_add_u32 s49, s67, s6
    s_add_u32 m0, s53, 75776
    s_add_u32 s48, s49, 0
    buffer_load_dwordx4 v5, s[20:23], s48 offen sc1 lds
    s_add_u32 m0, s53, 76800
    s_add_u32 s48, s49, 49152
    buffer_load_dwordx4 v5, s[20:23], s48 offen sc1 lds
    s_add_u32 m0, s53, 77824
    s_add_u32 s48, s49, 983040
    buffer_load_dwordx4 v5, s[20:23], s48 offen sc1 lds
    s_add_u32 m0, s53, 78848
    s_add_u32 s48, s49, 1032192
    buffer_load_dwordx4 v5, s[20:23], s48 offen sc1 lds
    s_add_u32 m0, s53, 79872
    s_add_u32 s48, s67, s75
    buffer_load_dwordx4 v5, s[20:23], s48 offen sc1 lds
    s_add_u32 s67, s82, 3
    s_cmp_ge_u32 s67, 12
    s_cselect_b32 s48, 12, 0
    s_sub_u32 s67, s67, s48
    s_lshl_b32 s67, s67, 12
    s_add_u32 s49, s67, s6
    s_add_u32 m0, s53, 80896
    s_add_u32 s48, s49, 0
    buffer_load_dwordx4 v5, s[20:23], s48 offen sc1 lds
    s_add_u32 m0, s53, 81920
    s_add_u32 s48, s49, 49152
    buffer_load_dwordx4 v5, s[20:23], s48 offen sc1 lds
    s_add_u32 m0, s53, 82944
    s_add_u32 s48, s49, 983040
    buffer_load_dwordx4 v5, s[20:23], s48 offen sc1 lds
    s_add_u32 m0, s53, 83968
    s_add_u32 s48, s49, 1032192
    buffer_load_dwordx4 v5, s[20:23], s48 offen sc1 lds
    s_add_u32 m0, s53, 84992
    s_add_u32 s48, s67, s75
    buffer_load_dwordx4 v5, s[20:23], s48 offen sc1 lds
    s_lshl_b32 s48, s47, 2
    s_add_u32 s48, s48, 149520
    v_mov_b32 v12, s48
    v_mov_b32 v13, 1
    s_waitcnt vmcnt(0)
    ds_write_b32 v12, v13
    v_lshlrev_b32 v11, 7, v0
    s_cmp_lg_u32 s47, 0
    s_cbranch_scc1 L_nofup_20
    s_mov_b32 s48, 0xe000
    buffer_load_dword v16, v11, s[20:23], s48 offen sc1
L_nofup_20:
    s_branch L_zpart
L_ffn_c:
    s_lshl_b32 s48, s46, 2
    s_add_u32 s48, s48, s44
    s_lshl_b32 s48, s48, 2
    v_lshrrev_b32 v36, 4, v0
    v_add_u32 v37, s48, v36
    v_and_b32 v36, 31, v37
    v_lshlrev_b32 v36, 6, v36
    v_lshrrev_b32 v38, 5, v37
    v_add_u32 v36, v36, v38
    s_lshl_b32 s48, s45, 2
    v_add_u32 v36, s48, v36
    v_mul_u32_u24 v36, 1280, v36
    v_and_b32 v38, 15, v0
    v_lshl_add_u32 v36, v38, 4, v36
    s_and_b32 s57, s44, 1
    s_lshr_b32 s58, s44, 1
    s_waitcnt lgkmcnt(0)
    s_mov_b32 s8, s64
    s_and_b32 s9, s65, 0xffff
    s_mov_b32 s10, 0x280000
    s_mov_b32 s11, 0x00020000
    s_load_dword s62, s[82:83], 0x0
    s_mov_b32 s20, s82
    s_and_b32 s21, s83, 0xffff
    s_mov_b32 s22, 0x10000000
    s_mov_b32 s23, 0x00020000
    s_mov_b32 s40, s78
    s_and_b32 s41, s79, 0xffff
    s_mov_b32 s42, 0x280000
    s_mov_b32 s43, 0x00020000
    s_cmp_ge_u32 s46, 8
    s_cbranch_scc1 L_nost_21
    buffer_load_dwordx4 v[16:19], v36, s[8:11], 0 offen offset:0
    buffer_load_dwordx4 v[20:23], v36, s[8:11], 0 offen offset:256
    buffer_load_dwordx4 v[24:27], v36, s[8:11], 0 offen offset:512
    buffer_load_dwordx4 v[28:31], v36, s[8:11], 0 offen offset:768
    buffer_load_dwordx4 v[32:35], v36, s[8:11], 0 offen offset:1024
L_nost_21:
    s_lshl_b32 s59, s45, 3
    s_add_u32 s59, s59, s46
    s_lshl_b32 s59, s59, 7
    s_add_u32 s59, s59, 0x1000
    s_and_b32 s3, s2, 7
    s_lshr_b32 s48, s2, 3
    s_lshr_b32 s64, s3, 1
    s_lshl_b32 s64, s64, 3
    s_and_b32 s49, s48, 7
    s_add_u32 s64, s64, s49
    s_and_b32 s3, s3, 1
    s_lshl_b32 s3, s3, 2
    s_lshr_b32 s48, s48, 3
    s_add_u32 s65, s3, s48
    s_lshr_b32 s73, s65, 1
    s_and_b32 s48, s65, 1
    s_mul_i32 s48, s48, 20
    s_add_u32 s73, s73, s48
    s_add_u32 s73, s73, 16
    s_lshl_b32 s73, s73, 5
    s_lshl_b32 s48, s44, 10
    s_add_u32 s48, s48, 0xbc0000
    s_mul_i32 s6, s65, 98304
    s_add_u32 s6, s6, s48
    s_mul_i32 s75, s73, 1536
    s_add_u32 s75, s75, s48
    s_lshl_b32 s72, s65, 6
    s_mul_i32 s66, s64, 196608
    s_lshl_b32 s48, s44, 11
    s_add_u32 s66, s66, s48
    s_and_b32 s48, s44, 1
    s_lshl_b32 s48, s48, 10
    s_lshl_b32 s49, s64, 1
    s_add_u32 s48, s48, s49
    s_lshr_b32 s49, s44, 1
    s_add_u32 s48, s48, s49
    s_mul_i32 s48, s48, 1280
    s_add_u32 s72, s72, s48
    s_add_u32 s73, s73, s48
    v_and_b32 v5, 15, v0
    v_lshlrev_b32 v5, 7, v5
    s_lshl_b32 s48, s57, 13
    v_add_u32 v5, s48, v5
    v_lshrrev_b32 v6, 4, v0
    v_bfe_u32 v7, v0, 1, 3
    v_xor_b32 v6, v6, v7
    v_lshl_add_u32 v8, v6, 4, v5
    v_xor_b32 v9, 64, v8
    v_lshrrev_b32 v5, 4, v0
    v_bfe_u32 v6, v0, 2, 2
    v_lshl_add_u32 v7, v5, 3, v6
    v_lshlrev_b32 v7, 8, v7
    v_and_b32 v5, 1, v5
    v_lshl_add_u32 v5, v6, 1, v5
    s_lshl_b32 s48, s58, 2
    v_xor_b32 v5, s48, v5
    v_lshl_add_u32 v7, v5, 5, v7
    v_and_b32 v6, 3, v0
    v_lshl_add_u32 v10, v6, 3, v7
    v_xor_b32 v11, 32, v10
    v_xor_b32 v12, 64, v10
    v_xor_b32 v13, 96, v10
    s_getpc_b64 s[4:5]
    s_add_u32 s4, s4, dft_tables@rel32@lo+4
    s_addc_u32 s5, s5, dft_tables@rel32@hi+12
    s_mov_b32 s24, s4
    s_and_b32 s25, s5, 0xffff
    s_mov_b32 s26, 0x66000
    s_mov_b32 s27, 0x00020000
    s_lshr_b32 s61, s2, 3
    s_lshl_b32 s61, s61, 2
    s_add_u32 s61, s61, s44
    s_mul_i32 s48, s61, 9
    v_min_u32 v5, 8, v0
    v_add_u32 v5, s48, v5
    v_min_u32 v5, 799, v5
    v_lshlrev_b32 v5, 7, v5
    s_bfe_u32 s48, s2, 0x20001
    s_mul_i32 s48, s48, 102400
    buffer_load_dword v1, v5, s[24:27], s48 offen
    s_cmp_ge_u32 s46, 8
    s_cbranch_scc1 L_nost_22
    s_waitcnt vmcnt(1)
    v_lshlrev_b32 v40, 16, v16
    v_and_b32 v41, 0xffff0000, v16
    v_lshlrev_b32 v42, 16, v17
    v_and_b32 v43, 0xffff0000, v17
    v_lshlrev_b32 v44, 16, v18
    v_and_b32 v45, 0xffff0000, v18
    v_lshlrev_b32 v46, 16, v19
    v_and_b32 v47, 0xffff0000, v19
    v_lshlrev_b32 v48, 16, v20
    v_and_b32 v49, 0xffff0000, v20
    v_lshlrev_b32 v50, 16, v21
    v_and_b32 v51, 0xffff0000, v21
    v_lshlrev_b32 v52, 16, v22
    v_and_b32 v53, 0xffff0000, v22
    v_lshlrev_b32 v54, 16, v23
    v_and_b32 v55, 0xffff0000, v23
    v_lshlrev_b32 v56, 16, v24
    v_and_b32 v57, 0xffff0000, v24
    v_lshlrev_b32 v58, 16, v25
    v_and_b32 v59, 0xffff0000, v25
    v_lshlrev_b32 v60, 16, v26
    v_and_b32 v61, 0xffff0000, v26
    v_lshlrev_b32 v62, 16, v27
    v_and_b32 v63, 0xffff0000, v27
    v_lshlrev_b32 v64, 16, v28
    v_and_b32 v65, 0xffff0000, v28
    v_lshlrev_b32 v66, 16, v29
    v_and_b32 v67, 0xffff0000, v29
    v_lshlrev_b32 v68, 16, v30
    v_and_b32 v69, 0xffff0000, v30
    v_lshlrev_b32 v70, 16, v31
    v_and_b32 v71, 0xffff0000, v31
    v_lshlrev_b32 v72, 16, v32
    v_and_b32 v73, 0xffff0000, v32
    v_lshlrev_b32 v74, 16, v33
    v_and_b32 v75, 0xffff0000, v33
    v_lshlrev_b32 v76, 16, v34
    v_and_b32 v77, 0xffff0000, v34
    v_lshlrev_b32 v78, 16, v35
    v_and_b32 v79, 0xffff0000, v35
    v_pk_add_f32 v[80:81], v[40:41], v[42:43]
    v_pk_add_f32 v[80:81], v[80:81], v[44:45]
    v_pk_add_f32 v[80:81], v[80:81], v[46:47]
    v_pk_add_f32 v[80:81], v[80:81], v[48:49]
    v_pk_add_f32 v[80:81], v[80:81], v[50:51]
    v_pk_add_f32 v[80:81], v[80:81], v[52:53]
    v_pk_add_f32 v[80:81], v[80:81], v[54:55]
    v_pk_add_f32 v[80:81], v[80:81], v[56:57]
    v_pk_add_f32 v[80:81], v[80:81], v[58:59]
    v_pk_add_f32 v[80:81], v[80:81], v[60:61]
    v_pk_add_f32 v[80:81], v[80:81], v[62:63]
    v_pk_add_f32 v[80:81], v[80:81], v[64:65]
    v_pk_add_f32 v[80:81], v[80:81], v[66:67]
    v_pk_add_f32 v[80:81], v[80:81], v[68:69]
    v_pk_add_f32 v[80:81], v[80:81], v[70:71]
    v_pk_add_f32 v[80:81], v[80:81], v[72:73]
    v_pk_add_f32 v[80:81], v[80:81], v[74:75]
    v_pk_add_f32 v[80:81], v[80:81], v[76:77]
    v_pk_add_f32 v[80:81], v[80:81], v[78:79]
    v_add_f32 v80, v80, v81
    s_nop 1
    v_add_f32_dpp v80, v80, v80 quad_perm:[1,0,3,2] row_mask:0xf bank_mask:0xf
    s_nop 1
    v_add_f32_dpp v80, v80, v80 quad_perm:[2,3,0,1] row_mask:0xf bank_mask:0xf
    s_nop 1
    v_add_f32_dpp v80, v80, v80 row_half_mirror row_mask:0xf bank_mask:0xf
    s_nop 1
    v_add_f32_dpp v80, v80, v80 row_mirror row_mask:0xf bank_mask:0xf
    v_mul_f32 v80, 0x3acccccd, v80
    v_pk_add_f32 v[40:41], v[40:41], v[80:81] op_sel_hi:[1,0] neg_lo:[0,1] neg_hi:[0,1]
    v_pk_add_f32 v[42:43], v[42:43], v[80:81] op_sel_hi:[1,0] neg_lo:[0,1] neg_hi:[0,1]
    v_pk_add_f32 v[44:45], v[44:45], v[80:81] op_sel_hi:[1,0] neg_lo:[0,1] neg_hi:[0,1]
    v_pk_add_f32 v[46:47], v[46:47], v[80:81] op_sel_hi:[1,0] neg_lo:[0,1] neg_hi:[0,1]
    v_pk_add_f32 v[48:49], v[48:49], v[80:81] op_sel_hi:[1,0] neg_lo:[0,1] neg_hi:[0,1]
    v_pk_add_f32 v[50:51], v[50:51], v[80:81] op_sel_hi:[1,0] neg_lo:[0,1] neg_hi:[0,1]
    v_pk_add_f32 v[52:53], v[52:53], v[80:81] op_sel_hi:[1,0] neg_lo:[0,1] neg_hi:[0,1]
    v_pk_add_f32 v[54:55], v[54:55], v[80:81] op_sel_hi:[1,0] neg_lo:[0,1] neg_hi:[0,1]
    v_pk_add_f32 v[56:57], v[56:57], v[80:81] op_sel_hi:[1,0] neg_lo:[0,1] neg_hi:[0,1]
    v_pk_add_f32 v[58:59], v[58:59], v[80:81] op_sel_hi:[1,0] neg_lo:[0,1] neg_hi:[0,1]
    v_pk_add_f32 v[60:61], v[60:61], v[80:81] op_sel_hi:[1,0] neg_lo:[0,1] neg_hi:[0,1]
    v_pk_add_f32 v[62:63], v[62:63], v[80:81] op_sel_hi:[1,0] neg_lo:[0,1] neg_hi:[0,1]
    v_pk_add_f32 v[64:65], v[64:65], v[80:81] op_sel_hi:[1,0] neg_lo:[0,1] neg_hi:[0,1]
    v_pk_add_f32 v[66:67], v[66:67], v[80:81] op_sel_hi:[1,0] neg_lo:[0,1] neg_hi:[0,1]
    v_pk_add_f32 v[68:69], v[68:69], v[80:81] op_sel_hi:[1,0] neg_lo:[0,1] neg_hi:[0,1]
    v_pk_add_f32 v[70:71], v[70:71], v[80:81] op_sel_hi:[1,0] neg_lo:[0,1] neg_hi:[0,1]
    v_pk_add_f32 v[72:73], v[72:73], v[80:81] op_sel_hi:[1,0] neg_lo:[0,1] neg_hi:[0,1]
    v_pk_add_f32 v[74:75], v[74:75], v[80:81] op_sel_hi:[1,0] neg_lo:[0,1] neg_hi:[0,1]
    v_pk_add_f32 v[76:77], v[76:77], v[80:81] op_sel_hi:[1,0] neg_lo:[0,1] neg_hi:[0,1]
    v_pk_add_f32 v[78:79], v[78:79], v[80:81] op_sel_hi:[1,0] neg_lo:[0,1] neg_hi:[0,1]
    v_pk_mul_f32 v[82:83], v[40:41], v[40:41]
    v_pk_fma_f32 v[82:83], v[42:43], v[42:43], v[82:83]
    v_pk_fma_f32 v[82:83], v[44:45], v[44:45], v[82:83]
    v_pk_fma_f32 v[82:83], v[46:47], v[46:47], v[82:83]
    v_pk_fma_f32 v[82:83], v[48:49], v[48:49], v[82:83]
    v_pk_fma_f32 v[82:83], v[50:51], v[50:51], v[82:83]
    v_pk_fma_f32 v[82:83], v[52:53], v[52:53], v[82:83]
    v_pk_fma_f32 v[82:83], v[54:55], v[54:55], v[82:83]
    v_pk_fma_f32 v[82:83], v[56:57], v[56:57], v[82:83]
    v_pk_fma_f32 v[82:83], v[58:59], v[58:59], v[82:83]
    v_pk_fma_f32 v[82:83], v[60:61], v[60:61], v[82:83]
    v_pk_fma_f32 v[82:83], v[62:63], v[62:63], v[82:83]
    v_pk_fma_f32 v[82:83], v[64:65], v[64:65], v[82:83]
    v_pk_fma_f32 v[82:83], v[66:67], v[66:67], v[82:83]
    v_pk_fma_f32 v[82:83], v[68:69], v[68:69], v[82:83]
    v_pk_fma_f32 v[82:83], v[70:71], v[70:71], v[82:83]
    v_pk_fma_f32 v[82:83], v[72:73], v[72:73], v[82:83]
    v_pk_fma_f32 v[82:83], v[74:75], v[74:75], v[82:83]
    v_pk_fma_f32 v[82:83], v[76:77], v[76:77], v[82:83]
    v_pk_fma_f32 v[82:83], v[78:79], v[78:79], v[82:83]
    v_add_f32 v82, v82, v83
    s_nop 1
    v_add_f32_dpp v82, v82, v82 quad_perm:[1,0,3,2] row_mask:0xf bank_mask:0xf
    s_nop 1
    v_add_f32_dpp v82, v82, v82 quad_perm:[2,3,0,1] row_mask:0xf bank_mask:0xf
    s_nop 1
    v_add_f32_dpp v82, v82, v82 row_half_mirror row_mask:0xf bank_mask:0xf
    s_nop 1
    v_add_f32_dpp v82, v82, v82 row_mirror row_mask:0xf bank_mask:0xf
    v_mul_f32 v82, 0x3acccccd, v82
    v_cvt_pk_bf16_f32 v82, v82, v82
    v_and_b32 v82, 0xffff0000, v82
    v_add_f32 v82, 0x3727c5ac, v82
    v_cvt_pk_bf16_f32 v82, v82, v82
    v_and_b32 v82, 0xffff0000, v82
    v_sqrt_f32 v82, v82
    s_nop 0
    v_cvt_pk_bf16_f32 v82, v82, v82
    v_and_b32 v82, 0xffff0000, v82
    v_rcp_f32 v82, v82
    v_cvt_pk_bf16_f32 v80, v80, v80
    v_and_b32 v80, 0xffff0000, v80
    v_and_b32 v38, 15, v0
    v_cmp_eq_u32 vcc, 1, v38
    v_lshlrev_b32 v17, 2, v37
    v_lshl_add_u32 v17, v38, 9, v17
    v_cndmask_b32 v82, v82, v80, vcc
    v_cmp_gt_u32 vcc, 2, v38
    s_lshl_b32 s48, s45, 10
    s_add_u32 s48, s48, 0x28000
    s_and_saveexec_b64 s[4:5], vcc
    buffer_store_dword v82, v17, s[20:23], s48 offen sc1
    s_mov_b64 exec, s[4:5]
L_nost_22:
    s_and_b32 s60, s2, 1
    s_mul_i32 s60, s60, 5
    s_bfe_u32 s48, s2, 0x10003
    s_mul_i32 s48, s48, 3
    s_add_u32 s60, s60, s48
    s_bfe_u32 s81, s2, 0x20004
    s_add_u32 s60, s60, s81
    s_mul_i32 s60, s60, 12288
    s_lshl_b32 s48, s46, 2
    s_lshl_b32 s49, s57, 1
    s_add_u32 s48, s48, s49
    s_add_u32 s48, s48, s58
    s_lshl_b32 s48, s48, 8
    s_add_u32 s60, s60, s48
    s_add_u32 s60, s60, 0x30000
    s_bfe_u32 s48, s2, 0x30003
    s_cmp_ge_u32 s48, 5
    s_cselect_b32 s81, 100, s81
    s_cmp_lg_u32 s44, 0
    s_cselect_b32 s79, 100, s81
    v_mov_b32 v2, 0x3f803f80
    v_mov_b32 v3, 0x3f803f80
    v_mov_b32 v4, 0x3f803f80
    v_mov_b32 v5, 0x3f803f80
    v_and_b32 v14, 48, v0
    s_mov_b32 s52, 0
    s_mov_b32 s53, 49152
    s_mov_b32 s50, 0
    s_waitcnt lgkmcnt(0)
    s_mul_i32 s62, s62, 0x9E3779B1
    s_add_u32 s62, s62, 0x7F4A7C15
    s_barrier
    ds_read_b128 v[16:19], v8 offset:0
    ds_read_b64_tr_b16 v[32:33], v10 offset:16384
    ds_read_b64_tr_b16 v[34:35], v10 offset:17408
    ds_read_b128 v[20:23], v8 offset:2048
    ds_read_b128 v[24:27], v8 offset:4096
    ds_read_b128 v[28:31], v8 offset:6144
    ds_read_b64_tr_b16 v[48:49], v10 offset:32768
    ds_read_b64_tr_b16 v[50:51], v10 offset:33792
    ds_read_b64_tr_b16 v[36:37], v11 offset:16384
    ds_read_b64_tr_b16 v[38:39], v11 offset:17408
    ds_read_b64_tr_b16 v[52:53], v11 offset:32768
    ds_read_b64_tr_b16 v[54:55], v11 offset:33792
    ds_read_b64_tr_b16 v[40:41], v12 offset:16384
    ds_read_b64_tr_b16 v[42:43], v12 offset:17408
    ds_read_b64_tr_b16 v[56:57], v12 offset:32768
    ds_read_b64_tr_b16 v[58:59], v12 offset:33792
    ds_read_b64_tr_b16 v[44:45], v13 offset:16384
    ds_read_b64_tr_b16 v[46:47], v13 offset:17408
    ds_read_b64_tr_b16 v[60:61], v13 offset:32768
    ds_read_b64_tr_b16 v[62:63], v13 offset:33792
    s_waitcnt lgkmcnt(15)
    v_mfma_f32_16x16x32_bf16 v[112:115], v[32:35], v[16:19], 0
    ds_read_b128 v[64:67], v9 offset:0
    v_mfma_f32_16x16x32_bf16 v[116:119], v[32:35], v[20:23], 0
    ds_read_b64_tr_b16 v[80:81], v10 offset:24576
    v_mfma_f32_16x16x32_bf16 v[120:123], v[32:35], v[24:27], 0
    ds_read_b64_tr_b16 v[82:83], v10 offset:25600
    s_waitcnt lgkmcnt(15)
    v_mfma_f32_16x16x32_bf16 v[124:127], v[32:35], v[28:31], 0
    ds_read_b128 v[68:71], v9 offset:2048
    v_mfma_f32_16x16x32_bf16 v[188:191], v[48:51], v[28:31], 0
    ds_read_b128 v[72:75], v9 offset:4096
    v_mfma_f32_16x16x32_bf16 v[184:187], v[48:51], v[24:27], 0
    ds_read_b128 v[76:79], v9 offset:6144
    v_mfma_f32_16x16x32_bf16 v[180:183], v[48:51], v[20:23], 0
    ds_read_b64_tr_b16 v[96:97], v10 offset:40960
    v_mfma_f32_16x16x32_bf16 v[176:179], v[48:51], v[16:19], 0
    ds_read_b64_tr_b16 v[98:99], v10 offset:41984
    s_waitcnt lgkmcnt(15)
    v_mfma_f32_16x16x32_bf16 v[128:131], v[36:39], v[16:19], 0
    ds_read_b64_tr_b16 v[84:85], v11 offset:24576
    v_mfma_f32_16x16x32_bf16 v[132:135], v[36:39], v[20:23], 0
    ds_read_b64_tr_b16 v[86:87], v11 offset:25600
    v_mfma_f32_16x16x32_bf16 v[136:139], v[36:39], v[24:27], 0
    ds_read_b64_tr_b16 v[100:101], v11 offset:40960
    v_mfma_f32_16x16x32_bf16 v[140:143], v[36:39], v[28:31], 0
    ds_read_b64_tr_b16 v[102:103], v11 offset:41984
    v_mfma_f32_16x16x32_bf16 v[204:207], v[52:55], v[28:31], 0
    ds_read_b64_tr_b16 v[88:89], v12 offset:24576
    v_mfma_f32_16x16x32_bf16 v[200:203], v[52:55], v[24:27], 0
    ds_read_b64_tr_b16 v[90:91], v12 offset:25600
    v_mfma_f32_16x16x32_bf16 v[196:199], v[52:55], v[20:23], 0
    ds_read_b64_tr_b16 v[104:105], v12 offset:40960
    v_mfma_f32_16x16x32_bf16 v[192:195], v[52:55], v[16:19], 0
    ds_read_b64_tr_b16 v[106:107], v12 offset:41984
    s_waitcnt lgkmcnt(15)
    v_mfma_f32_16x16x32_bf16 v[144:147], v[40:43], v[16:19], 0
    ds_read_b64_tr_b16 v[92:93], v13 offset:24576
    v_mfma_f32_16x16x32_bf16 v[148:151], v[40:43], v[20:23], 0
    ds_read_b64_tr_b16 v[94:95], v13 offset:25600
    v_mfma_f32_16x16x32_bf16 v[152:155], v[40:43], v[24:27], 0
    ds_read_b64_tr_b16 v[108:109], v13 offset:40960
    v_mfma_f32_16x16x32_bf16 v[156:159], v[40:43], v[28:31], 0
    ds_read_b64_tr_b16 v[110:111], v13 offset:41984
    v_mfma_f32_16x16x32_bf16 v[220:223], v[56:59], v[28:31], 0
    v_mfma_f32_16x16x32_bf16 v[216:219], v[56:59], v[24:27], 0
    v_mfma_f32_16x16x32_bf16 v[212:215], v[56:59], v[20:23], 0
    v_mfma_f32_16x16x32_bf16 v[208:211], v[56:59], v[16:19], 0
    v_mfma_f32_16x16x32_bf16 v[160:163], v[44:47], v[16:19], 0
    v_mfma_f32_16x16x32_bf16 v[164:167], v[44:47], v[20:23], 0
    v_mfma_f32_16x16x32_bf16 v[168:171], v[44:47], v[24:27], 0
    v_mfma_f32_16x16x32_bf16 v[172:175], v[44:47], v[28:31], 0
    v_mfma_f32_16x16x32_bf16 v[236:239], v[60:63], v[28:31], 0
    v_mfma_f32_16x16x32_bf16 v[232:235], v[60:63], v[24:27], 0
    v_mfma_f32_16x16x32_bf16 v[228:231], v[60:63], v[20:23], 0
    v_mfma_f32_16x16x32_bf16 v[224:227], v[60:63], v[16:19], 0
    s_cmp_eq_u32 s81, 0
    s_cbranch_scc1 L_rare_23
L_back_24:
    s_waitcnt lgkmcnt(15)
    v_mfma_f32_16x16x32_bf16 v[112:115], v[80:83], v[64:67], v[112:115]
    v_add_u32 v8, 49152, v8
    v_add_u32 v9, 49152, v9
    v_add_u32 v10, 49152, v10
    v_add_u32 v11, 49152, v11
    v_add_u32 v12, 49152, v12
    v_add_u32 v13, 49152, v13
    v_mfma_f32_16x16x32_bf16 v[116:119], v[80:83], v[68:71], v[116:119]
    v_mfma_f32_16x16x32_bf16 v[120:123], v[80:83], v[72:75], v[120:123]
    s_waitcnt lgkmcnt(14)
    v_mfma_f32_16x16x32_bf16 v[124:127], v[80:83], v[76:79], v[124:127]
    s_waitcnt lgkmcnt(0) vmcnt(0)
    s_barrier
    s_lshr_b32 s48, s46, 3
    s_or_b32 s48, s48, s44
    s_cbranch_scc0 L_rare_27
L_back_28:
    v_mfma_f32_16x16x32_bf16 v[188:191], v[96:99], v[76:79], v[188:191]
    ds_read_b128 v[16:19], v8 offset:0
    v_mfma_f32_16x16x32_bf16 v[184:187], v[96:99], v[72:75], v[184:187]
    ds_read_b64_tr_b16 v[32:33], v10 offset:16384
    v_mfma_f32_16x16x32_bf16 v[180:183], v[96:99], v[68:71], v[180:183]
    ds_read_b64_tr_b16 v[34:35], v10 offset:17408
    v_mfma_f32_16x16x32_bf16 v[176:179], v[96:99], v[64:67], v[176:179]
    ds_read_b128 v[20:23], v8 offset:2048
    v_mfma_f32_16x16x32_bf16 v[128:131], v[84:87], v[64:67], v[128:131]
    s_cmp_eq_u32 s81, 0
    s_cbranch_scc1 L_rare_29
L_back_30:
    ds_read_b128 v[24:27], v8 offset:4096
    v_mfma_f32_16x16x32_bf16 v[132:135], v[84:87], v[68:71], v[132:135]
    ds_read_b128 v[28:31], v8 offset:6144
    v_mfma_f32_16x16x32_bf16 v[136:139], v[84:87], v[72:75], v[136:139]
    ds_read_b64_tr_b16 v[48:49], v10 offset:32768
    v_mfma_f32_16x16x32_bf16 v[140:143], v[84:87], v[76:79], v[140:143]
    ds_read_b64_tr_b16 v[50:51], v10 offset:33792
    v_mfma_f32_16x16x32_bf16 v[204:207], v[100:103], v[76:79], v[204:207]
    ds_read_b64_tr_b16 v[36:37], v11 offset:16384
    v_mfma_f32_16x16x32_bf16 v[200:203], v[100:103], v[72:75], v[200:203]
    ds_read_b64_tr_b16 v[38:39], v11 offset:17408
    v_mfma_f32_16x16x32_bf16 v[196:199], v[100:103], v[68:71], v[196:199]
    ds_read_b64_tr_b16 v[52:53], v11 offset:32768
    v_mfma_f32_16x16x32_bf16 v[192:195], v[100:103], v[64:67], v[192:195]
    ds_read_b64_tr_b16 v[54:55], v11 offset:33792
    v_mfma_f32_16x16x32_bf16 v[144:147], v[88:91], v[64:67], v[144:147]
    ds_read_b64_tr_b16 v[40:41], v12 offset:16384
    v_mfma_f32_16x16x32_bf16 v[148:151], v[88:91], v[68:71], v[148:151]
    ds_read_b64_tr_b16 v[42:43], v12 offset:17408
    v_mfma_f32_16x16x32_bf16 v[152:155], v[88:91], v[72:75], v[152:155]
    ds_read_b64_tr_b16 v[56:57], v12 offset:32768
    v_mfma_f32_16x16x32_bf16 v[156:159], v[88:91], v[76:79], v[156:159]
    ds_read_b64_tr_b16 v[58:59], v12 offset:33792
    v_mfma_f32_16x16x32_bf16 v[220:223], v[104:107], v[76:79], v[220:223]
    ds_read_b64_tr_b16 v[44:45], v13 offset:16384
    v_mfma_f32_16x16x32_bf16 v[216:219], v[104:107], v[72:75], v[216:219]
    ds_read_b64_tr_b16 v[46:47], v13 offset:17408
    v_mfma_f32_16x16x32_bf16 v[212:215], v[104:107], v[68:71], v[212:215]
    ds_read_b64_tr_b16 v[60:61], v13 offset:32768
    v_mfma_f32_16x16x32_bf16 v[208:211], v[104:107], v[64:67], v[208:211]
    ds_read_b64_tr_b16 v[62:63], v13 offset:33792
    v_mfma_f32_16x16x32_bf16 v[160:163], v[92:95], v[64:67], v[160:163]
    v_mfma_f32_16x16x32_bf16 v[164:167], v[92:95], v[68:71], v[164:167]
    v_mfma_f32_16x16x32_bf16 v[168:171], v[92:95], v[72:75], v[168:171]
    v_mfma_f32_16x16x32_bf16 v[172:175], v[92:95], v[76:79], v[172:175]
    v_mfma_f32_16x16x32_bf16 v[236:239], v[108:111], v[76:79], v[236:239]
    v_mfma_f32_16x16x32_bf16 v[232:235], v[108:111], v[72:75], v[232:235]
    v_mfma_f32_16x16x32_bf16 v[228:231], v[108:111], v[68:71], v[228:231]
    s_cmp_eq_u32 s81, 0
    s_cbranch_scc1 L_rare_33
L_back_34:
    v_mfma_f32_16x16x32_bf16 v[224:227], v[108:111], v[64:67], v[224:227]
    s_waitcnt lgkmcnt(15)
    v_mfma_f32_16x16x32_bf16 v[112:115], v[32:35], v[16:19], v[112:115]
    ds_read_b128 v[64:67], v9 offset:0
    v_mfma_f32_16x16x32_bf16 v[116:119], v[32:35], v[20:23], v[116:119]
    ds_read_b64_tr_b16 v[80:81], v10 offset:24576
    v_mfma_f32_16x16x32_bf16 v[120:123], v[32:35], v[24:27], v[120:123]
    ds_read_b64_tr_b16 v[82:83], v10 offset:25600
    s_waitcnt lgkmcnt(15)
    v_mfma_f32_16x16x32_bf16 v[124:127], v[32:35], v[28:31], v[124:127]
    ds_read_b128 v[68:71], v9 offset:2048
    v_mfma_f32_16x16x32_bf16 v[188:191], v[48:51], v[28:31], v[188:191]
    ds_read_b128 v[72:75], v9 offset:4096
    v_mfma_f32_16x16x32_bf16 v[184:187], v[48:51], v[24:27], v[184:187]
    ds_read_b128 v[76:79], v9 offset:6144
    v_mfma_f32_16x16x32_bf16 v[180:183], v[48:51], v[20:23], v[180:183]
    ds_read_b64_tr_b16 v[96:97], v10 offset:40960
    v_mfma_f32_16x16x32_bf16 v[176:179], v[48:51], v[16:19], v[176:179]
    ds_read_b64_tr_b16 v[98:99], v10 offset:41984
    s_waitcnt lgkmcnt(15)
    v_mfma_f32_16x16x32_bf16 v[128:131], v[36:39], v[16:19], v[128:131]
    ds_read_b64_tr_b16 v[84:85], v11 offset:24576
    v_mfma_f32_16x16x32_bf16 v[132:135], v[36:39], v[20:23], v[132:135]
    ds_read_b64_tr_b16 v[86:87], v11 offset:25600
    v_mfma_f32_16x16x32_bf16 v[136:139], v[36:39], v[24:27], v[136:139]
    ds_read_b64_tr_b16 v[100:101], v11 offset:40960
    v_mfma_f32_16x16x32_bf16 v[140:143], v[36:39], v[28:31], v[140:143]
    ds_read_b64_tr_b16 v[102:103], v11 offset:41984
    v_mfma_f32_16x16x32_bf16 v[204:207], v[52:55], v[28:31], v[204:207]
    ds_read_b64_tr_b16 v[88:89], v12 offset:24576
    v_mfma_f32_16x16x32_bf16 v[200:203], v[52:55], v[24:27], v[200:203]
    ds_read_b64_tr_b16 v[90:91], v12 offset:25600
    v_mfma_f32_16x16x32_bf16 v[196:199], v[52:55], v[20:23], v[196:199]
    ds_read_b64_tr_b16 v[104:105], v12 offset:40960
    v_mfma_f32_16x16x32_bf16 v[192:195], v[52:55], v[16:19], v[192:195]
    ds_read_b64_tr_b16 v[106:107], v12 offset:41984
    s_waitcnt lgkmcnt(15)
    v_mfma_f32_16x16x32_bf16 v[144:147], v[40:43], v[16:19], v[144:147]
    ds_read_b64_tr_b16 v[92:93], v13 offset:24576
    v_mfma_f32_16x16x32_bf16 v[148:151], v[40:43], v[20:23], v[148:151]
    ds_read_b64_tr_b16 v[94:95], v13 offset:25600
    v_mfma_f32_16x16x32_bf16 v[152:155], v[40:43], v[24:27], v[152:155]
    ds_read_b64_tr_b16 v[108:109], v13 offset:40960
    v_mfma_f32_16x16x32_bf16 v[156:159], v[40:43], v[28:31], v[156:159]
    ds_read_b64_tr_b16 v[110:111], v13 offset:41984
    v_mfma_f32_16x16x32_bf16 v[220:223], v[56:59], v[28:31], v[220:223]
    v_mfma_f32_16x16x32_bf16 v[216:219], v[56:59], v[24:27], v[216:219]
    v_mfma_f32_16x16x32_bf16 v[212:215], v[56:59], v[20:23], v[212:215]
    v_mfma_f32_16x16x32_bf16 v[208:211], v[56:59], v[16:19], v[208:211]
    v_mfma_f32_16x16x32_bf16 v[160:163], v[44:47], v[16:19], v[160:163]
    v_mfma_f32_16x16x32_bf16 v[164:167], v[44:47], v[20:23], v[164:167]
    v_mfma_f32_16x16x32_bf16 v[168:171], v[44:47], v[24:27], v[168:171]
    v_mfma_f32_16x16x32_bf16 v[172:175], v[44:47], v[28:31], v[172:175]
    v_mfma_f32_16x16x32_bf16 v[236:239], v[60:63], v[28:31], v[236:239]
    v_mfma_f32_16x16x32_bf16 v[232:235], v[60:63], v[24:27], v[232:235]
    v_mfma_f32_16x16x32_bf16 v[228:231], v[60:63], v[20:23], v[228:231]
    v_mfma_f32_16x16x32_bf16 v[224:227], v[60:63], v[16:19], v[224:227]
    s_cmp_eq_u32 s81, 1
    s_cbranch_scc1 L_rare_35
L_back_36:
    s_waitcnt lgkmcnt(15)
    v_mfma_f32_16x16x32_bf16 v[112:115], v[80:83], v[64:67], v[112:115]
    v_add_u32 v8, 49152, v8
    v_add_u32 v9, 49152, v9
    v_add_u32 v10, 49152, v10
    v_add_u32 v11, 49152, v11
    v_add_u32 v12, 49152, v12
    v_add_u32 v13, 49152, v13
    v_mfma_f32_16x16x32_bf16 v[116:119], v[80:83], v[68:71], v[116:119]
    v_mfma_f32_16x16x32_bf16 v[120:123], v[80:83], v[72:75], v[120:123]
    s_waitcnt lgkmcnt(14)
    v_mfma_f32_16x16x32_bf16 v[124:127], v[80:83], v[76:79], v[124:127]
    s_waitcnt lgkmcnt(0)
    s_barrier
    v_mfma_f32_16x16x32_bf16 v[188:191], v[96:99], v[76:79], v[188:191]
    ds_read_b128 v[16:19], v8 offset:0
    v_mfma_f32_16x16x32_bf16 v[184:187], v[96:99], v[72:75], v[184:187]
    ds_read_b64_tr_b16 v[32:33], v10 offset:16384
    v_mfma_f32_16x16x32_bf16 v[180:183], v[96:99], v[68:71], v[180:183]
    ds_read_b64_tr_b16 v[34:35], v10 offset:17408
    v_mfma_f32_16x16x32_bf16 v[176:179], v[96:99], v[64:67], v[176:179]
    ds_read_b128 v[20:23], v8 offset:2048
    v_mfma_f32_16x16x32_bf16 v[128:131], v[84:87], v[64:67], v[128:131]
    s_cmp_eq_u32 s81, 1
    s_cbranch_scc1 L_rare_39
L_back_40:
    ds_read_b128 v[24:27], v8 offset:4096
    v_mfma_f32_16x16x32_bf16 v[132:135], v[84:87], v[68:71], v[132:135]
    ds_read_b128 v[28:31], v8 offset:6144
    v_mfma_f32_16x16x32_bf16 v[136:139], v[84:87], v[72:75], v[136:139]
    ds_read_b64_tr_b16 v[48:49], v10 offset:32768
    v_mfma_f32_16x16x32_bf16 v[140:143], v[84:87], v[76:79], v[140:143]
    ds_read_b64_tr_b16 v[50:51], v10 offset:33792
    v_mfma_f32_16x16x32_bf16 v[204:207], v[100:103], v[76:79], v[204:207]
    ds_read_b64_tr_b16 v[36:37], v11 offset:16384
    v_mfma_f32_16x16x32_bf16 v[200:203], v[100:103], v[72:75], v[200:203]
    ds_read_b64_tr_b16 v[38:39], v11 offset:17408
    v_mfma_f32_16x16x32_bf16 v[196:199], v[100:103], v[68:71], v[196:199]
    ds_read_b64_tr_b16 v[52:53], v11 offset:32768
    v_mfma_f32_16x16x32_bf16 v[192:195], v[100:103], v[64:67], v[192:195]
    ds_read_b64_tr_b16 v[54:55], v11 offset:33792
    v_mfma_f32_16x16x32_bf16 v[144:147], v[88:91], v[64:67], v[144:147]
    ds_read_b64_tr_b16 v[40:41], v12 offset:16384
    v_mfma_f32_16x16x32_bf16 v[148:151], v[88:91], v[68:71], v[148:151]
    ds_read_b64_tr_b16 v[42:43], v12 offset:17408
    v_mfma_f32_16x16x32_bf16 v[152:155], v[88:91], v[72:75], v[152:155]
    ds_read_b64_tr_b16 v[56:57], v12 offset:32768
    v_mfma_f32_16x16x32_bf16 v[156:159], v[88:91], v[76:79], v[156:159]
    ds_read_b64_tr_b16 v[58:59], v12 offset:33792
    v_mfma_f32_16x16x32_bf16 v[220:223], v[104:107], v[76:79], v[220:223]
    ds_read_b64_tr_b16 v[44:45], v13 offset:16384
    v_mfma_f32_16x16x32_bf16 v[216:219], v[104:107], v[72:75], v[216:219]
    ds_read_b64_tr_b16 v[46:47], v13 offset:17408
    v_mfma_f32_16x16x32_bf16 v[212:215], v[104:107], v[68:71], v[212:215]
    ds_read_b64_tr_b16 v[60:61], v13 offset:32768
    v_mfma_f32_16x16x32_bf16 v[208:211], v[104:107], v[64:67], v[208:211]
    ds_read_b64_tr_b16 v[62:63], v13 offset:33792
    v_mfma_f32_16x16x32_bf16 v[160:163], v[92:95], v[64:67], v[160:163]
    v_mfma_f32_16x16x32_bf16 v[164:167], v[92:95], v[68:71], v[164:167]
    v_mfma_f32_16x16x32_bf16 v[168:171], v[92:95], v[72:75], v[168:171]
    v_mfma_f32_16x16x32_bf16 v[172:175], v[92:95], v[76:79], v[172:175]
    v_mfma_f32_16x16x32_bf16 v[236:239], v[108:111], v[76:79], v[236:239]
    v_mfma_f32_16x16x32_bf16 v[232:235], v[108:111], v[72:75], v[232:235]
    v_mfma_f32_16x16x32_bf16 v[228:231], v[108:111], v[68:71], v[228:231]
    s_cmp_eq_u32 s81, 1
    s_cbranch_scc1 L_rare_43
L_back_44:
    v_mfma_f32_16x16x32_bf16 v[224:227], v[108:111], v[64:67], v[224:227]
    s_waitcnt lgkmcnt(15)
    v_mfma_f32_16x16x32_bf16 v[112:115], v[32:35], v[16:19], v[112:115]
    ds_read_b128 v[64:67], v9 offset:0
    v_mfma_f32_16x16x32_bf16 v[116:119], v[32:35], v[20:23], v[116:119]
    ds_read_b64_tr_b16 v[80:81], v10 offset:24576
    v_mfma_f32_16x16x32_bf16 v[120:123], v[32:35], v[24:27], v[120:123]
    ds_read_b64_tr_b16 v[82:83], v10 offset:25600
    s_waitcnt lgkmcnt(15)
    v_mfma_f32_16x16x32_bf16 v[124:127], v[32:35], v[28:31], v[124:127]
    ds_read_b128 v[68:71], v9 offset:2048
    v_mfma_f32_16x16x32_bf16 v[188:191], v[48:51], v[28:31], v[188:191]
    ds_read_b128 v[72:75], v9 offset:4096
    v_mfma_f32_16x16x32_bf16 v[184:187], v[48:51], v[24:27], v[184:187]
    ds_read_b128 v[76:79], v9 offset:6144
    v_mfma_f32_16x16x32_bf16 v[180:183], v[48:51], v[20:23], v[180:183]
    ds_read_b64_tr_b16 v[96:97], v10 offset:40960
    v_mfma_f32_16x16x32_bf16 v[176:179], v[48:51], v[16:19], v[176:179]
    ds_read_b64_tr_b16 v[98:99], v10 offset:41984
    s_waitcnt lgkmcnt(15)
    v_mfma_f32_16x16x32_bf16 v[128:131], v[36:39], v[16:19], v[128:131]
    ds_read_b64_tr_b16 v[84:85], v11 offset:24576
    v_mfma_f32_16x16x32_bf16 v[132:135], v[36:39], v[20:23], v[132:135]
    ds_read_b64_tr_b16 v[86:87], v11 offset:25600
    v_mfma_f32_16x16x32_bf16 v[136:139], v[36:39], v[24:27], v[136:139]
    ds_read_b64_tr_b16 v[100:101], v11 offset:40960
    v_mfma_f32_16x16x32_bf16 v[140:143], v[36:39], v[28:31], v[140:143]
    ds_read_b64_tr_b16 v[102:103], v11 offset:41984
    v_mfma_f32_16x16x32_bf16 v[204:207], v[52:55], v[28:31], v[204:207]
    ds_read_b64_tr_b16 v[88:89], v12 offset:24576
    v_mfma_f32_16x16x32_bf16 v[200:203], v[52:55], v[24:27], v[200:203]
    ds_read_b64_tr_b16 v[90:91], v12 offset:25600
    v_mfma_f32_16x16x32_bf16 v[196:199], v[52:55], v[20:23], v[196:199]
    ds_read_b64_tr_b16 v[104:105], v12 offset:40960
    v_mfma_f32_16x16x32_bf16 v[192:195], v[52:55], v[16:19], v[192:195]
    ds_read_b64_tr_b16 v[106:107], v12 offset:41984
    s_waitcnt lgkmcnt(15)
    v_mfma_f32_16x16x32_bf16 v[144:147], v[40:43], v[16:19], v[144:147]
    ds_read_b64_tr_b16 v[92:93], v13 offset:24576
    v_mfma_f32_16x16x32_bf16 v[148:151], v[40:43], v[20:23], v[148:151]
    ds_read_b64_tr_b16 v[94:95], v13 offset:25600
    v_mfma_f32_16x16x32_bf16 v[152:155], v[40:43], v[24:27], v[152:155]
    ds_read_b64_tr_b16 v[108:109], v13 offset:40960
    v_mfma_f32_16x16x32_bf16 v[156:159], v[40:43], v[28:31], v[156:159]
    ds_read_b64_tr_b16 v[110:111], v13 offset:41984
    v_mfma_f32_16x16x32_bf16 v[220:223], v[56:59], v[28:31], v[220:223]
    v_mfma_f32_16x16x32_bf16 v[216:219], v[56:59], v[24:27], v[216:219]
    v_mfma_f32_16x16x32_bf16 v[212:215], v[56:59], v[20:23], v[212:215]
    v_mfma_f32_16x16x32_bf16 v[208:211], v[56:59], v[16:19], v[208:211]
    v_mfma_f32_16x16x32_bf16 v[160:163], v[44:47], v[16:19], v[160:163]
    v_mfma_f32_16x16x32_bf16 v[164:167], v[44:47], v[20:23], v[164:167]
    v_mfma_f32_16x16x32_bf16 v[168:171], v[44:47], v[24:27], v[168:171]
    v_mfma_f32_16x16x32_bf16 v[172:175], v[44:47], v[28:31], v[172:175]
    v_mfma_f32_16x16x32_bf16 v[236:239], v[60:63], v[28:31], v[236:239]
    v_mfma_f32_16x16x32_bf16 v[232:235], v[60:63], v[24:27], v[232:235]
    v_mfma_f32_16x16x32_bf16 v[228:231], v[60:63], v[20:23], v[228:231]
    v_mfma_f32_16x16x32_bf16 v[224:227], v[60:63], v[16:19], v[224:227]
    s_cmp_eq_u32 s81, 2
    s_cbranch_scc1 L_rare_45
L_back_46:
    s_waitcnt lgkmcnt(15)
    v_mfma_f32_16x16x32_bf16 v[112:115], v[80:83], v[64:67], v[112:115]
    v_add_u32 v8, 4294868992, v8
    v_add_u32 v9, 4294868992, v9
    v_add_u32 v10, 4294868992, v10
    v_add_u32 v11, 4294868992, v11
    v_add_u32 v12, 4294868992, v12
    v_add_u32 v13, 4294868992, v13
    v_mfma_f32_16x16x32_bf16 v[116:119], v[80:83], v[68:71], v[116:119]
    v_mfma_f32_16x16x32_bf16 v[120:123], v[80:83], v[72:75], v[120:123]
    s_cmp_eq_u32 s81, 0
    s_cbranch_scc1 L_rare_49
L_back_50:
    s_waitcnt lgkmcnt(14)
    v_mfma_f32_16x16x32_bf16 v[124:127], v[80:83], v[76:79], v[124:127]
    s_waitcnt lgkmcnt(0)
    s_barrier
    s_cmp_eq_u32 s79, 0
    s_cbranch_scc1 L_rare_51
L_back_52:
    v_mfma_f32_16x16x32_bf16 v[188:191], v[96:99], v[76:79], v[188:191]
    ds_read_b128 v[16:19], v8 offset:0
    v_mfma_f32_16x16x32_bf16 v[184:187], v[96:99], v[72:75], v[184:187]
    ds_read_b64_tr_b16 v[32:33], v10 offset:16384
    v_mfma_f32_16x16x32_bf16 v[180:183], v[96:99], v[68:71], v[180:183]
    ds_read_b64_tr_b16 v[34:35], v10 offset:17408
    v_mfma_f32_16x16x32_bf16 v[176:179], v[96:99], v[64:67], v[176:179]
    ds_read_b128 v[20:23], v8 offset:2048
    v_mfma_f32_16x16x32_bf16 v[128:131], v[84:87], v[64:67], v[128:131]
    s_cmp_eq_u32 s81, 2
    s_cbranch_scc1 L_rare_53
L_back_54:
    ds_read_b128 v[24:27], v8 offset:4096
    v_mfma_f32_16x16x32_bf16 v[132:135], v[84:87], v[68:71], v[132:135]
    ds_read_b128 v[28:31], v8 offset:6144
    v_mfma_f32_16x16x32_bf16 v[136:139], v[84:87], v[72:75], v[136:139]
    ds_read_b64_tr_b16 v[48:49], v10 offset:32768
    v_mfma_f32_16x16x32_bf16 v[140:143], v[84:87], v[76:79], v[140:143]
    ds_read_b64_tr_b16 v[50:51], v10 offset:33792
    v_mfma_f32_16x16x32_bf16 v[204:207], v[100:103], v[76:79], v[204:207]
    ds_read_b64_tr_b16 v[36:37], v11 offset:16384
    v_mfma_f32_16x16x32_bf16 v[200:203], v[100:103], v[72:75], v[200:203]
    ds_read_b64_tr_b16 v[38:39], v11 offset:17408
    v_mfma_f32_16x16x32_bf16 v[196:199], v[100:103], v[68:71], v[196:199]
    ds_read_b64_tr_b16 v[52:53], v11 offset:32768
    v_mfma_f32_16x16x32_bf16 v[192:195], v[100:103], v[64:67], v[192:195]
    ds_read_b64_tr_b16 v[54:55], v11 offset:33792
    v_mfma_f32_16x16x32_bf16 v[144:147], v[88:91], v[64:67], v[144:147]
    ds_read_b64_tr_b16 v[40:41], v12 offset:16384
    v_mfma_f32_16x16x32_bf16 v[148:151], v[88:91], v[68:71], v[148:151]
    ds_read_b64_tr_b16 v[42:43], v12 offset:17408
    v_mfma_f32_16x16x32_bf16 v[152:155], v[88:91], v[72:75], v[152:155]
    ds_read_b64_tr_b16 v[56:57], v12 offset:32768
    v_mfma_f32_16x16x32_bf16 v[156:159], v[88:91], v[76:79], v[156:159]
    ds_read_b64_tr_b16 v[58:59], v12 offset:33792
    v_mfma_f32_16x16x32_bf16 v[220:223], v[104:107], v[76:79], v[220:223]
    ds_read_b64_tr_b16 v[44:45], v13 offset:16384
    v_mfma_f32_16x16x32_bf16 v[216:219], v[104:107], v[72:75], v[216:219]
    ds_read_b64_tr_b16 v[46:47], v13 offset:17408
    v_mfma_f32_16x16x32_bf16 v[212:215], v[104:107], v[68:71], v[212:215]
    ds_read_b64_tr_b16 v[60:61], v13 offset:32768
    v_mfma_f32_16x16x32_bf16 v[208:211], v[104:107], v[64:67], v[208:211]
    ds_read_b64_tr_b16 v[62:63], v13 offset:33792
    v_mfma_f32_16x16x32_bf16 v[160:163], v[92:95], v[64:67], v[160:163]
    v_mfma_f32_16x16x32_bf16 v[164:167], v[92:95], v[68:71], v[164:167]
    v_mfma_f32_16x16x32_bf16 v[168:171], v[92:95], v[72:75], v[168:171]
    v_mfma_f32_16x16x32_bf16 v[172:175], v[92:95], v[76:79], v[172:175]
    v_mfma_f32_16x16x32_bf16 v[236:239], v[108:111], v[76:79], v[236:239]
    v_mfma_f32_16x16x32_bf16 v[232:235], v[108:111], v[72:75], v[232:235]
    v_mfma_f32_16x16x32_bf16 v[228:231], v[108:111], v[68:71], v[228:231]
    s_cmp_eq_u32 s81, 2
    s_cbranch_scc1 L_rare_57
L_back_58:
    v_mfma_f32_16x16x32_bf16 v[224:227], v[108:111], v[64:67], v[224:227]
    s_waitcnt lgkmcnt(15)
    v_mfma_f32_16x16x32_bf16 v[112:115], v[32:35], v[16:19], v[112:115]
    ds_read_b128 v[64:67], v9 offset:0
    v_mfma_f32_16x16x32_bf16 v[116:119], v[32:35], v[20:23], v[116:119]
    ds_read_b64_tr_b16 v[80:81], v10 offset:24576
    v_mfma_f32_16x16x32_bf16 v[120:123], v[32:35], v[24:27], v[120:123]
    ds_read_b64_tr_b16 v[82:83], v10 offset:25600
    s_waitcnt lgkmcnt(15)
    v_mfma_f32_16x16x32_bf16 v[124:127], v[32:35], v[28:31], v[124:127]
    ds_read_b128 v[68:71], v9 offset:2048
    v_mfma_f32_16x16x32_bf16 v[188:191], v[48:51], v[28:31], v[188:191]
    ds_read_b128 v[72:75], v9 offset:4096
    v_mfma_f32_16x16x32_bf16 v[184:187], v[48:51], v[24:27], v[184:187]
    ds_read_b128 v[76:79], v9 offset:6144
    v_mfma_f32_16x16x32_bf16 v[180:183], v[48:51], v[20:23], v[180:183]
    ds_read_b64_tr_b16 v[96:97], v10 offset:40960
    v_mfma_f32_16x16x32_bf16 v[176:179], v[48:51], v[16:19], v[176:179]
    ds_read_b64_tr_b16 v[98:99], v10 offset:41984
    s_waitcnt lgkmcnt(15)
    v_mfma_f32_16x16x32_bf16 v[128:131], v[36:39], v[16:19], v[128:131]
    ds_read_b64_tr_b16 v[84:85], v11 offset:24576
    v_mfma_f32_16x16x32_bf16 v[132:135], v[36:39], v[20:23], v[132:135]
    ds_read_b64_tr_b16 v[86:87], v11 offset:25600
    v_mfma_f32_16x16x32_bf16 v[136:139], v[36:39], v[24:27], v[136:139]
    ds_read_b64_tr_b16 v[100:101], v11 offset:40960
    v_mfma_f32_16x16x32_bf16 v[140:143], v[36:39], v[28:31], v[140:143]
    ds_read_b64_tr_b16 v[102:103], v11 offset:41984
    v_mfma_f32_16x16x32_bf16 v[204:207], v[52:55], v[28:31], v[204:207]
    ds_read_b64_tr_b16 v[88:89], v12 offset:24576
    v_mfma_f32_16x16x32_bf16 v[200:203], v[52:55], v[24:27], v[200:203]
    ds_read_b64_tr_b16 v[90:91], v12 offset:25600
    v_mfma_f32_16x16x32_bf16 v[196:199], v[52:55], v[20:23], v[196:199]
    ds_read_b64_tr_b16 v[104:105], v12 offset:40960
    v_mfma_f32_16x16x32_bf16 v[192:195], v[52:55], v[16:19], v[192:195]
    ds_read_b64_tr_b16 v[106:107], v12 offset:41984
    s_waitcnt lgkmcnt(15)
    v_mfma_f32_16x16x32_bf16 v[144:147], v[40:43], v[16:19], v[144:147]
    ds_read_b64_tr_b16 v[92:93], v13 offset:24576
    v_mfma_f32_16x16x32_bf16 v[148:151], v[40:43], v[20:23], v[148:151]
    ds_read_b64_tr_b16 v[94:95], v13 offset:25600
    v_mfma_f32_16x16x32_bf16 v[152:155], v[40:43], v[24:27], v[152:155]
    ds_read_b64_tr_b16 v[108:109], v13 offset:40960
    v_mfma_f32_16x16x32_bf16 v[156:159], v[40:43], v[28:31], v[156:159]
    ds_read_b64_tr_b16 v[110:111], v13 offset:41984
    v_mfma_f32_16x16x32_bf16 v[220:223], v[56:59], v[28:31], v[220:223]
    v_mfma_f32_16x16x32_bf16 v[216:219], v[56:59], v[24:27], v[216:219]
    v_mfma_f32_16x16x32_bf16 v[212:215], v[56:59], v[20:23], v[212:215]
    v_mfma_f32_16x16x32_bf16 v[208:211], v[56:59], v[16:19], v[208:211]
    v_mfma_f32_16x16x32_bf16 v[160:163], v[44:47], v[16:19], v[160:163]
    v_mfma_f32_16x16x32_bf16 v[164:167], v[44:47], v[20:23], v[164:167]
    v_mfma_f32_16x16x32_bf16 v[168:171], v[44:47], v[24:27], v[168:171]
    v_mfma_f32_16x16x32_bf16 v[172:175], v[44:47], v[28:31], v[172:175]
    v_mfma_f32_16x16x32_bf16 v[236:239], v[60:63], v[28:31], v[236:239]
    v_mfma_f32_16x16x32_bf16 v[232:235], v[60:63], v[24:27], v[232:235]
    v_mfma_f32_16x16x32_bf16 v[228:231], v[60:63], v[20:23], v[228:231]
    v_mfma_f32_16x16x32_bf16 v[224:227], v[60:63], v[16:19], v[224:227]
    s_waitcnt lgkmcnt(15)
    v_mfma_f32_16x16x32_bf16 v[112:115], v[80:83], v[64:67], v[112:115]
    v_add_u32 v8, 49152, v8
    v_add_u32 v9, 49152, v9
    v_add_u32 v10, 49152, v10
    v_add_u32 v11, 49152, v11
    v_add_u32 v12, 49152, v12
    v_add_u32 v13, 49152, v13
    v_mfma_f32_16x16x32_bf16 v[116:119], v[80:83], v[68:71], v[116:119]
    v_mfma_f32_16x16x32_bf16 v[120:123], v[80:83], v[72:75], v[120:123]
    s_cmp_eq_u32 s81, 1
    s_cbranch_scc1 L_rare_59
L_back_60:
    s_waitcnt lgkmcnt(14)
    v_mfma_f32_16x16x32_bf16 v[124:127], v[80:83], v[76:79], v[124:127]
    s_waitcnt lgkmcnt(0)
    s_barrier
    s_cmp_eq_u32 s79, 1
    s_cbranch_scc1 L_rare_61
L_back_62:
    v_mfma_f32_16x16x32_bf16 v[188:191], v[96:99], v[76:79], v[188:191]
    ds_read_b128 v[16:19], v8 offset:0
    v_mfma_f32_16x16x32_bf16 v[184:187], v[96:99], v[72:75], v[184:187]
    ds_read_b64_tr_b16 v[32:33], v10 offset:16384
    v_mfma_f32_16x16x32_bf16 v[180:183], v[96:99], v[68:71], v[180:183]
    ds_read_b64_tr_b16 v[34:35], v10 offset:17408
    v_mfma_f32_16x16x32_bf16 v[176:179], v[96:99], v[64:67], v[176:179]
    ds_read_b128 v[20:23], v8 offset:2048
    v_mfma_f32_16x16x32_bf16 v[128:131], v[84:87], v[64:67], v[128:131]
    ds_read_b128 v[24:27], v8 offset:4096
    v_mfma_f32_16x16x32_bf16 v[132:135], v[84:87], v[68:71], v[132:135]
    ds_read_b128 v[28:31], v8 offset:6144
    v_mfma_f32_16x16x32_bf16 v[136:139], v[84:87], v[72:75], v[136:139]
    ds_read_b64_tr_b16 v[48:49], v10 offset:32768
    v_mfma_f32_16x16x32_bf16 v[140:143], v[84:87], v[76:79], v[140:143]
    ds_read_b64_tr_b16 v[50:51], v10 offset:33792
    v_mfma_f32_16x16x32_bf16 v[204:207], v[100:103], v[76:79], v[204:207]
    ds_read_b64_tr_b16 v[36:37], v11 offset:16384
    v_mfma_f32_16x16x32_bf16 v[200:203], v[100:103], v[72:75], v[200:203]
    ds_read_b64_tr_b16 v[38:39], v11 offset:17408
    v_mfma_f32_16x16x32_bf16 v[196:199], v[100:103], v[68:71], v[196:199]
    ds_read_b64_tr_b16 v[52:53], v11 offset:32768
    v_mfma_f32_16x16x32_bf16 v[192:195], v[100:103], v[64:67], v[192:195]
    ds_read_b64_tr_b16 v[54:55], v11 offset:33792
    v_mfma_f32_16x16x32_bf16 v[144:147], v[88:91], v[64:67], v[144:147]
    ds_read_b64_tr_b16 v[40:41], v12 offset:16384
    v_mfma_f32_16x16x32_bf16 v[148:151], v[88:91], v[68:71], v[148:151]
    ds_read_b64_tr_b16 v[42:43], v12 offset:17408
    v_mfma_f32_16x16x32_bf16 v[152:155], v[88:91], v[72:75], v[152:155]
    ds_read_b64_tr_b16 v[56:57], v12 offset:32768
    v_mfma_f32_16x16x32_bf16 v[156:159], v[88:91], v[76:79], v[156:159]
    ds_read_b64_tr_b16 v[58:59], v12 offset:33792
    v_mfma_f32_16x16x32_bf16 v[220:223], v[104:107], v[76:79], v[220:223]
    ds_read_b64_tr_b16 v[44:45], v13 offset:16384
    v_mfma_f32_16x16x32_bf16 v[216:219], v[104:107], v[72:75], v[216:219]
    ds_read_b64_tr_b16 v[46:47], v13 offset:17408
    v_mfma_f32_16x16x32_bf16 v[212:215], v[104:107], v[68:71], v[212:215]
    ds_read_b64_tr_b16 v[60:61], v13 offset:32768
    v_mfma_f32_16x16x32_bf16 v[208:211], v[104:107], v[64:67], v[208:211]
    ds_read_b64_tr_b16 v[62:63], v13 offset:33792
    v_mfma_f32_16x16x32_bf16 v[160:163], v[92:95], v[64:67], v[160:163]
    v_mfma_f32_16x16x32_bf16 v[164:167], v[92:95], v[68:71], v[164:167]
    v_mfma_f32_16x16x32_bf16 v[168:171], v[92:95], v[72:75], v[168:171]
    v_mfma_f32_16x16x32_bf16 v[172:175], v[92:95], v[76:79], v[172:175]
    v_mfma_f32_16x16x32_bf16 v[236:239], v[108:111], v[76:79], v[236:239]
    v_mfma_f32_16x16x32_bf16 v[232:235], v[108:111], v[72:75], v[232:235]
    v_mfma_f32_16x16x32_bf16 v[228:231], v[108:111], v[68:71], v[228:231]
    v_mfma_f32_16x16x32_bf16 v[224:227], v[108:111], v[64:67], v[224:227]
    s_waitcnt lgkmcnt(15)
    v_mfma_f32_16x16x32_bf16 v[112:115], v[32:35], v[16:19], v[112:115]
    ds_read_b128 v[64:67], v9 offset:0
    v_mfma_f32_16x16x32_bf16 v[116:119], v[32:35], v[20:23], v[116:119]
    ds_read_b64_tr_b16 v[80:81], v10 offset:24576
    v_mfma_f32_16x16x32_bf16 v[120:123], v[32:35], v[24:27], v[120:123]
    ds_read_b64_tr_b16 v[82:83], v10 offset:25600
    s_waitcnt lgkmcnt(15)
    v_mfma_f32_16x16x32_bf16 v[124:127], v[32:35], v[28:31], v[124:127]
    ds_read_b128 v[68:71], v9 offset:2048
    v_mfma_f32_16x16x32_bf16 v[188:191], v[48:51], v[28:31], v[188:191]
    ds_read_b128 v[72:75], v9 offset:4096
    v_mfma_f32_16x16x32_bf16 v[184:187], v[48:51], v[24:27], v[184:187]
    ds_read_b128 v[76:79], v9 offset:6144
    v_mfma_f32_16x16x32_bf16 v[180:183], v[48:51], v[20:23], v[180:183]
    ds_read_b64_tr_b16 v[96:97], v10 offset:40960
    v_mfma_f32_16x16x32_bf16 v[176:179], v[48:51], v[16:19], v[176:179]
    ds_read_b64_tr_b16 v[98:99], v10 offset:41984
    s_waitcnt lgkmcnt(15)
    v_mfma_f32_16x16x32_bf16 v[128:131], v[36:39], v[16:19], v[128:131]
    ds_read_b64_tr_b16 v[84:85], v11 offset:24576
    v_mfma_f32_16x16x32_bf16 v[132:135], v[36:39], v[20:23], v[132:135]
    ds_read_b64_tr_b16 v[86:87], v11 offset:25600
    v_mfma_f32_16x16x32_bf16 v[136:139], v[36:39], v[24:27], v[136:139]
    ds_read_b64_tr_b16 v[100:101], v11 offset:40960
    v_mfma_f32_16x16x32_bf16 v[140:143], v[36:39], v[28:31], v[140:143]
    ds_read_b64_tr_b16 v[102:103], v11 offset:41984
    v_mfma_f32_16x16x32_bf16 v[204:207], v[52:55], v[28:31], v[204:207]
    ds_read_b64_tr_b16 v[88:89], v12 offset:24576
    v_mfma_f32_16x16x32_bf16 v[200:203], v[52:55], v[24:27], v[200:203]
    ds_read_b64_tr_b16 v[90:91], v12 offset:25600
    v_mfma_f32_16x16x32_bf16 v[196:199], v[52:55], v[20:23], v[196:199]
    ds_read_b64_tr_b16 v[104:105], v12 offset:40960
    v_mfma_f32_16x16x32_bf16 v[192:195], v[52:55], v[16:19], v[192:195]
    ds_read_b64_tr_b16 v[106:107], v12 offset:41984
    s_waitcnt lgkmcnt(15)
    v_mfma_f32_16x16x32_bf16 v[144:147], v[40:43], v[16:19], v[144:147]
    ds_read_b64_tr_b16 v[92:93], v13 offset:24576
    v_mfma_f32_16x16x32_bf16 v[148:151], v[40:43], v[20:23], v[148:151]
    ds_read_b64_tr_b16 v[94:95], v13 offset:25600
    v_mfma_f32_16x16x32_bf16 v[152:155], v[40:43], v[24:27], v[152:155]
    ds_read_b64_tr_b16 v[108:109], v13 offset:40960
    v_mfma_f32_16x16x32_bf16 v[156:159], v[40:43], v[28:31], v[156:159]
    ds_read_b64_tr_b16 v[110:111], v13 offset:41984
    v_mfma_f32_16x16x32_bf16 v[220:223], v[56:59], v[28:31], v[220:223]
    v_mfma_f32_16x16x32_bf16 v[216:219], v[56:59], v[24:27], v[216:219]
    v_mfma_f32_16x16x32_bf16 v[212:215], v[56:59], v[20:23], v[212:215]
    v_mfma_f32_16x16x32_bf16 v[208:211], v[56:59], v[16:19], v[208:211]
    v_mfma_f32_16x16x32_bf16 v[160:163], v[44:47], v[16:19], v[160:163]
    v_mfma_f32_16x16x32_bf16 v[164:167], v[44:47], v[20:23], v[164:167]
    v_mfma_f32_16x16x32_bf16 v[168:171], v[44:47], v[24:27], v[168:171]
    v_mfma_f32_16x16x32_bf16 v[172:175], v[44:47], v[28:31], v[172:175]
    v_mfma_f32_16x16x32_bf16 v[236:239], v[60:63], v[28:31], v[236:239]
    v_mfma_f32_16x16x32_bf16 v[232:235], v[60:63], v[24:27], v[232:235]
    v_mfma_f32_16x16x32_bf16 v[228:231], v[60:63], v[20:23], v[228:231]
    v_mfma_f32_16x16x32_bf16 v[224:227], v[60:63], v[16:19], v[224:227]
    s_waitcnt lgkmcnt(15)
    v_mfma_f32_16x16x32_bf16 v[112:115], v[80:83], v[64:67], v[112:115]
    v_add_u32 v8, 49152, v8
    v_add_u32 v9, 49152, v9
    v_add_u32 v10, 49152, v10
    v_add_u32 v11, 49152, v11
    v_add_u32 v12, 49152, v12
    v_add_u32 v13, 49152, v13
    v_mfma_f32_16x16x32_bf16 v[116:119], v[80:83], v[68:71], v[116:119]
    v_mfma_f32_16x16x32_bf16 v[120:123], v[80:83], v[72:75], v[120:123]
    s_cmp_eq_u32 s81, 2
    s_cbranch_scc1 L_rare_63
L_back_64:
    s_waitcnt lgkmcnt(14)
    v_mfma_f32_16x16x32_bf16 v[124:127], v[80:83], v[76:79], v[124:127]
    s_waitcnt lgkmcnt(0)
    s_barrier
    s_cmp_eq_u32 s79, 2
    s_cbranch_scc1 L_rare_65
L_back_66:
    v_mfma_f32_16x16x32_bf16 v[188:191], v[96:99], v[76:79], v[188:191]
    ds_read_b128 v[16:19], v8 offset:0
    v_mfma_f32_16x16x32_bf16 v[184:187], v[96:99], v[72:75], v[184:187]
    ds_read_b64_tr_b16 v[32:33], v10 offset:16384
    v_mfma_f32_16x16x32_bf16 v[180:183], v[96:99], v[68:71], v[180:183]
    ds_read_b64_tr_b16 v[34:35], v10 offset:17408
    v_mfma_f32_16x16x32_bf16 v[176:179], v[96:99], v[64:67], v[176:179]
    ds_read_b128 v[20:23], v8 offset:2048
    v_mfma_f32_16x16x32_bf16 v[128:131], v[84:87], v[64:67], v[128:131]
    ds_read_b128 v[24:27], v8 offset:4096
    v_mfma_f32_16x16x32_bf16 v[132:135], v[84:87], v[68:71], v[132:135]
    ds_read_b128 v[28:31], v8 offset:6144
    v_mfma_f32_16x16x32_bf16 v[136:139], v[84:87], v[72:75], v[136:139]
    ds_read_b64_tr_b16 v[48:49], v10 offset:32768
    v_mfma_f32_16x16x32_bf16 v[140:143], v[84:87], v[76:79], v[140:143]
    ds_read_b64_tr_b16 v[50:51], v10 offset:33792
    v_mfma_f32_16x16x32_bf16 v[204:207], v[100:103], v[76:79], v[204:207]
    ds_read_b64_tr_b16 v[36:37], v11 offset:16384
    v_mfma_f32_16x16x32_bf16 v[200:203], v[100:103], v[72:75], v[200:203]
    ds_read_b64_tr_b16 v[38:39], v11 offset:17408
    v_mfma_f32_16x16x32_bf16 v[196:199], v[100:103], v[68:71], v[196:199]
    ds_read_b64_tr_b16 v[52:53], v11 offset:32768
    v_mfma_f32_16x16x32_bf16 v[192:195], v[100:103], v[64:67], v[192:195]
    ds_read_b64_tr_b16 v[54:55], v11 offset:33792
    v_mfma_f32_16x16x32_bf16 v[144:147], v[88:91], v[64:67], v[144:147]
    ds_read_b64_tr_b16 v[40:41], v12 offset:16384
    v_mfma_f32_16x16x32_bf16 v[148:151], v[88:91], v[68:71], v[148:151]
    ds_read_b64_tr_b16 v[42:43], v12 offset:17408
    v_mfma_f32_16x16x32_bf16 v[152:155], v[88:91], v[72:75], v[152:155]
    ds_read_b64_tr_b16 v[56:57], v12 offset:32768
    v_mfma_f32_16x16x32_bf16 v[156:159], v[88:91], v[76:79], v[156:159]
    ds_read_b64_tr_b16 v[58:59], v12 offset:33792
    v_mfma_f32_16x16x32_bf16 v[220:223], v[104:107], v[76:79], v[220:223]
    ds_read_b64_tr_b16 v[44:45], v13 offset:16384
    v_mfma_f32_16x16x32_bf16 v[216:219], v[104:107], v[72:75], v[216:219]
    ds_read_b64_tr_b16 v[46:47], v13 offset:17408
    v_mfma_f32_16x16x32_bf16 v[212:215], v[104:107], v[68:71], v[212:215]
    ds_read_b64_tr_b16 v[60:61], v13 offset:32768
    v_mfma_f32_16x16x32_bf16 v[208:211], v[104:107], v[64:67], v[208:211]
    ds_read_b64_tr_b16 v[62:63], v13 offset:33792
    v_mfma_f32_16x16x32_bf16 v[160:163], v[92:95], v[64:67], v[160:163]
    v_mfma_f32_16x16x32_bf16 v[164:167], v[92:95], v[68:71], v[164:167]
    v_mfma_f32_16x16x32_bf16 v[168:171], v[92:95], v[72:75], v[168:171]
    v_mfma_f32_16x16x32_bf16 v[172:175], v[92:95], v[76:79], v[172:175]
    v_mfma_f32_16x16x32_bf16 v[236:239], v[108:111], v[76:79], v[236:239]
    v_mfma_f32_16x16x32_bf16 v[232:235], v[108:111], v[72:75], v[232:235]
    v_mfma_f32_16x16x32_bf16 v[228:231], v[108:111], v[68:71], v[228:231]
    v_mfma_f32_16x16x32_bf16 v[224:227], v[108:111], v[64:67], v[224:227]
    s_mov_b32 s52, 98304
    s_mov_b32 s50, 5
L_gemm_67:
    s_waitcnt lgkmcnt(15)
    v_mfma_f32_16x16x32_bf16 v[112:115], v[32:35], v[16:19], v[112:115]
    ds_read_b128 v[64:67], v9 offset:0
    v_mfma_f32_16x16x32_bf16 v[116:119], v[32:35], v[20:23], v[116:119]
    ds_read_b64_tr_b16 v[80:81], v10 offset:24576
    v_mfma_f32_16x16x32_bf16 v[120:123], v[32:35], v[24:27], v[120:123]
    ds_read_b64_tr_b16 v[82:83], v10 offset:25600
    s_waitcnt lgkmcnt(15)
    v_mfma_f32_16x16x32_bf16 v[124:127], v[32:35], v[28:31], v[124:127]
    ds_read_b128 v[68:71], v9 offset:2048
    v_mfma_f32_16x16x32_bf16 v[188:191], v[48:51], v[28:31], v[188:191]
    ds_read_b128 v[72:75], v9 offset:4096
    v_mfma_f32_16x16x32_bf16 v[184:187], v[48:51], v[24:27], v[184:187]
    ds_read_b128 v[76:79], v9 offset:6144
    v_mfma_f32_16x16x32_bf16 v[180:183], v[48:51], v[20:23], v[180:183]
    ds_read_b64_tr_b16 v[96:97], v10 offset:40960
    v_mfma_f32_16x16x32_bf16 v[176:179], v[48:51], v[16:19], v[176:179]
    ds_read_b64_tr_b16 v[98:99], v10 offset:41984
    s_waitcnt lgkmcnt(15)
    v_mfma_f32_16x16x32_bf16 v[128:131], v[36:39], v[16:19], v[128:131]
    ds_read_b64_tr_b16 v[84:85], v11 offset:24576
    v_mfma_f32_16x16x32_bf16 v[132:135], v[36:39], v[20:23], v[132:135]
    ds_read_b64_tr_b16 v[86:87], v11 offset:25600
    v_mfma_f32_16x16x32_bf16 v[136:139], v[36:39], v[24:27], v[136:139]
    ds_read_b64_tr_b16 v[100:101], v11 offset:40960
    v_mfma_f32_16x16x32_bf16 v[140:143], v[36:39], v[28:31], v[140:143]
    ds_read_b64_tr_b16 v[102:103], v11 offset:41984
    v_mfma_f32_16x16x32_bf16 v[204:207], v[52:55], v[28:31], v[204:207]
    ds_read_b64_tr_b16 v[88:89], v12 offset:24576
    v_mfma_f32_16x16x32_bf16 v[200:203], v[52:55], v[24:27], v[200:203]
    ds_read_b64_tr_b16 v[90:91], v12 offset:25600
    v_mfma_f32_16x16x32_bf16 v[196:199], v[52:55], v[20:23], v[196:199]
    ds_read_b64_tr_b16 v[104:105], v12 offset:40960
    v_mfma_f32_16x16x32_bf16 v[192:195], v[52:55], v[16:19], v[192:195]
    ds_read_b64_tr_b16 v[106:107], v12 offset:41984
    s_waitcnt lgkmcnt(15)
    v_mfma_f32_16x16x32_bf16 v[144:147], v[40:43], v[16:19], v[144:147]
    ds_read_b64_tr_b16 v[92:93], v13 offset:24576
    v_mfma_f32_16x16x32_bf16 v[148:151], v[40:43], v[20:23], v[148:151]
    ds_read_b64_tr_b16 v[94:95], v13 offset:25600
    v_mfma_f32_16x16x32_bf16 v[152:155], v[40:43], v[24:27], v[152:155]
    ds_read_b64_tr_b16 v[108:109], v13 offset:40960
    v_mfma_f32_16x16x32_bf16 v[156:159], v[40:43], v[28:31], v[156:159]
    ds_read_b64_tr_b16 v[110:111], v13 offset:41984
    v_mfma_f32_16x16x32_bf16 v[220:223], v[56:59], v[28:31], v[220:223]
    v_mfma_f32_16x16x32_bf16 v[216:219], v[56:59], v[24:27], v[216:219]
    v_mfma_f32_16x16x32_bf16 v[212:215], v[56:59], v[20:23], v[212:215]
    v_mfma_f32_16x16x32_bf16 v[208:211], v[56:59], v[16:19], v[208:211]
    v_mfma_f32_16x16x32_bf16 v[160:163], v[44:47], v[16:19], v[160:163]
    v_mfma_f32_16x16x32_bf16 v[164:167], v[44:47], v[20:23], v[164:167]
    v_mfma_f32_16x16x32_bf16 v[168:171], v[44:47], v[24:27], v[168:171]
    v_mfma_f32_16x16x32_bf16 v[172:175], v[44:47], v[28:31], v[172:175]
    v_mfma_f32_16x16x32_bf16 v[236:239], v[60:63], v[28:31], v[236:239]
    v_mfma_f32_16x16x32_bf16 v[232:235], v[60:63], v[24:27], v[232:235]
    v_mfma_f32_16x16x32_bf16 v[228:231], v[60:63], v[20:23], v[228:231]
    v_mfma_f32_16x16x32_bf16 v[224:227], v[60:63], v[16:19], v[224:227]
    s_waitcnt lgkmcnt(15)
    v_mfma_f32_16x16x32_bf16 v[112:115], v[80:83], v[64:67], v[112:115]
    s_add_u32 s52, s52, 49152
    s_cmp_ge_u32 s52, 147456
    s_cselect_b32 s52, 0, s52
    s_cselect_b32 s51, 4294868992, s53
    v_add_u32 v8, s51, v8
    v_add_u32 v9, s51, v9
    v_add_u32 v10, s51, v10
    v_add_u32 v11, s51, v11
    v_add_u32 v12, s51, v12
    v_add_u32 v13, s51, v13
    v_mfma_f32_16x16x32_bf16 v[116:119], v[80:83], v[68:71], v[116:119]
    v_mfma_f32_16x16x32_bf16 v[120:123], v[80:83], v[72:75], v[120:123]
    s_waitcnt lgkmcnt(14)
    v_mfma_f32_16x16x32_bf16 v[124:127], v[80:83], v[76:79], v[124:127]
    s_waitcnt lgkmcnt(0)
    s_barrier
    v_mfma_f32_16x16x32_bf16 v[188:191], v[96:99], v[76:79], v[188:191]
    ds_read_b128 v[16:19], v8 offset:0
    v_mfma_f32_16x16x32_bf16 v[184:187], v[96:99], v[72:75], v[184:187]
    ds_read_b64_tr_b16 v[32:33], v10 offset:16384
    v_mfma_f32_16x16x32_bf16 v[180:183], v[96:99], v[68:71], v[180:183]
    ds_read_b64_tr_b16 v[34:35], v10 offset:17408
    v_mfma_f32_16x16x32_bf16 v[176:179], v[96:99], v[64:67], v[176:179]
    ds_read_b128 v[20:23], v8 offset:2048
    v_mfma_f32_16x16x32_bf16 v[128:131], v[84:87], v[64:67], v[128:131]
    ds_read_b128 v[24:27], v8 offset:4096
    v_mfma_f32_16x16x32_bf16 v[132:135], v[84:87], v[68:71], v[132:135]
    ds_read_b128 v[28:31], v8 offset:6144
    v_mfma_f32_16x16x32_bf16 v[136:139], v[84:87], v[72:75], v[136:139]
    ds_read_b64_tr_b16 v[48:49], v10 offset:32768
    v_mfma_f32_16x16x32_bf16 v[140:143], v[84:87], v[76:79], v[140:143]
    ds_read_b64_tr_b16 v[50:51], v10 offset:33792
    v_mfma_f32_16x16x32_bf16 v[204:207], v[100:103], v[76:79], v[204:207]
    ds_read_b64_tr_b16 v[36:37], v11 offset:16384
    v_mfma_f32_16x16x32_bf16 v[200:203], v[100:103], v[72:75], v[200:203]
    ds_read_b64_tr_b16 v[38:39], v11 offset:17408
    v_mfma_f32_16x16x32_bf16 v[196:199], v[100:103], v[68:71], v[196:199]
    ds_read_b64_tr_b16 v[52:53], v11 offset:32768
    v_mfma_f32_16x16x32_bf16 v[192:195], v[100:103], v[64:67], v[192:195]
    ds_read_b64_tr_b16 v[54:55], v11 offset:33792
    v_mfma_f32_16x16x32_bf16 v[144:147], v[88:91], v[64:67], v[144:147]
    ds_read_b64_tr_b16 v[40:41], v12 offset:16384
    v_mfma_f32_16x16x32_bf16 v[148:151], v[88:91], v[68:71], v[148:151]
    ds_read_b64_tr_b16 v[42:43], v12 offset:17408
    v_mfma_f32_16x16x32_bf16 v[152:155], v[88:91], v[72:75], v[152:155]
    ds_read_b64_tr_b16 v[56:57], v12 offset:32768
    v_mfma_f32_16x16x32_bf16 v[156:159], v[88:91], v[76:79], v[156:159]
    ds_read_b64_tr_b16 v[58:59], v12 offset:33792
    v_mfma_f32_16x16x32_bf16 v[220:223], v[104:107], v[76:79], v[220:223]
    ds_read_b64_tr_b16 v[44:45], v13 offset:16384
    v_mfma_f32_16x16x32_bf16 v[216:219], v[104:107], v[72:75], v[216:219]
    ds_read_b64_tr_b16 v[46:47], v13 offset:17408
    v_mfma_f32_16x16x32_bf16 v[212:215], v[104:107], v[68:71], v[212:215]
    ds_read_b64_tr_b16 v[60:61], v13 offset:32768
    v_mfma_f32_16x16x32_bf16 v[208:211], v[104:107], v[64:67], v[208:211]
    ds_read_b64_tr_b16 v[62:63], v13 offset:33792
    v_mfma_f32_16x16x32_bf16 v[160:163], v[92:95], v[64:67], v[160:163]
    v_mfma_f32_16x16x32_bf16 v[164:167], v[92:95], v[68:71], v[164:167]
    v_mfma_f32_16x16x32_bf16 v[168:171], v[92:95], v[72:75], v[168:171]
    v_mfma_f32_16x16x32_bf16 v[172:175], v[92:95], v[76:79], v[172:175]
    v_mfma_f32_16x16x32_bf16 v[236:239], v[108:111], v[76:79], v[236:239]
    v_mfma_f32_16x16x32_bf16 v[232:235], v[108:111], v[72:75], v[232:235]
    v_mfma_f32_16x16x32_bf16 v[228:231], v[108:111], v[68:71], v[228:231]
    v_mfma_f32_16x16x32_bf16 v[224:227], v[108:111], v[64:67], v[224:227]
    s_add_u32 s50, s50, 1
    s_cmp_lt_u32 s50, 9
    s_cbranch_scc1 L_gemm_67
    s_waitcnt lgkmcnt(15)
    v_mfma_f32_16x16x32_bf16 v[112:115], v[32:35], v[16:19], v[112:115]
    ds_read_b128 v[64:67], v9 offset:0
    v_mfma_f32_16x16x32_bf16 v[116:119], v[32:35], v[20:23], v[116:119]
    ds_read_b64_tr_b16 v[80:81], v10 offset:24576
    v_mfma_f32_16x16x32_bf16 v[120:123], v[32:35], v[24:27], v[120:123]
    ds_read_b64_tr_b16 v[82:83], v10 offset:25600
    s_waitcnt lgkmcnt(15)
    v_mfma_f32_16x16x32_bf16 v[124:127], v[32:35], v[28:31], v[124:127]
    ds_read_b128 v[68:71], v9 offset:2048
    v_mfma_f32_16x16x32_bf16 v[188:191], v[48:51], v[28:31], v[188:191]
    ds_read_b128 v[72:75], v9 offset:4096
    v_mfma_f32_16x16x32_bf16 v[184:187], v[48:51], v[24:27], v[184:187]
    ds_read_b128 v[76:79], v9 offset:6144
    v_mfma_f32_16x16x32_bf16 v[180:183], v[48:51], v[20:23], v[180:183]
    ds_read_b64_tr_b16 v[96:97], v10 offset:40960
    v_mfma_f32_16x16x32_bf16 v[176:179], v[48:51], v[16:19], v[176:179]
    ds_read_b64_tr_b16 v[98:99], v10 offset:41984
    s_waitcnt lgkmcnt(15)
    v_mfma_f32_16x16x32_bf16 v[128:131], v[36:39], v[16:19], v[128:131]
    ds_read_b64_tr_b16 v[84:85], v11 offset:24576
    v_mfma_f32_16x16x32_bf16 v[132:135], v[36:39], v[20:23], v[132:135]
    ds_read_b64_tr_b16 v[86:87], v11 offset:25600
    v_mfma_f32_16x16x32_bf16 v[136:139], v[36:39], v[24:27], v[136:139]
    ds_read_b64_tr_b16 v[100:101], v11 offset:40960
    v_mfma_f32_16x16x32_bf16 v[140:143], v[36:39], v[28:31], v[140:143]
    ds_read_b64_tr_b16 v[102:103], v11 offset:41984
    v_mfma_f32_16x16x32_bf16 v[204:207], v[52:55], v[28:31], v[204:207]
    ds_read_b64_tr_b16 v[88:89], v12 offset:24576
    v_mfma_f32_16x16x32_bf16 v[200:203], v[52:55], v[24:27], v[200:203]
    ds_read_b64_tr_b16 v[90:91], v12 offset:25600
    v_mfma_f32_16x16x32_bf16 v[196:199], v[52:55], v[20:23], v[196:199]
    ds_read_b64_tr_b16 v[104:105], v12 offset:40960
    v_mfma_f32_16x16x32_bf16 v[192:195], v[52:55], v[16:19], v[192:195]
    ds_read_b64_tr_b16 v[106:107], v12 offset:41984
    s_waitcnt lgkmcnt(15)
    v_mfma_f32_16x16x32_bf16 v[144:147], v[40:43], v[16:19], v[144:147]
    ds_read_b64_tr_b16 v[92:93], v13 offset:24576
    v_mfma_f32_16x16x32_bf16 v[148:151], v[40:43], v[20:23], v[148:151]
    ds_read_b64_tr_b16 v[94:95], v13 offset:25600
    v_mfma_f32_16x16x32_bf16 v[152:155], v[40:43], v[24:27], v[152:155]
    ds_read_b64_tr_b16 v[108:109], v13 offset:40960
    v_mfma_f32_16x16x32_bf16 v[156:159], v[40:43], v[28:31], v[156:159]
    ds_read_b64_tr_b16 v[110:111], v13 offset:41984
    v_mfma_f32_16x16x32_bf16 v[220:223], v[56:59], v[28:31], v[220:223]
    v_mfma_f32_16x16x32_bf16 v[216:219], v[56:59], v[24:27], v[216:219]
    v_mfma_f32_16x16x32_bf16 v[212:215], v[56:59], v[20:23], v[212:215]
    v_mfma_f32_16x16x32_bf16 v[208:211], v[56:59], v[16:19], v[208:211]
    v_mfma_f32_16x16x32_bf16 v[160:163], v[44:47], v[16:19], v[160:163]
    v_mfma_f32_16x16x32_bf16 v[164:167], v[44:47], v[20:23], v[164:167]
    v_mfma_f32_16x16x32_bf16 v[168:171], v[44:47], v[24:27], v[168:171]
    v_mfma_f32_16x16x32_bf16 v[172:175], v[44:47], v[28:31], v[172:175]
    v_mfma_f32_16x16x32_bf16 v[236:239], v[60:63], v[28:31], v[236:239]
    v_mfma_f32_16x16x32_bf16 v[232:235], v[60:63], v[24:27], v[232:235]
    v_mfma_f32_16x16x32_bf16 v[228:231], v[60:63], v[20:23], v[228:231]
    v_mfma_f32_16x16x32_bf16 v[224:227], v[60:63], v[16:19], v[224:227]
    s_waitcnt lgkmcnt(15)
    v_mfma_f32_16x16x32_bf16 v[112:115], v[80:83], v[64:67], v[112:115]
    v_mfma_f32_16x16x32_bf16 v[116:119], v[80:83], v[68:71], v[116:119]
    v_mfma_f32_16x16x32_bf16 v[120:123], v[80:83], v[72:75], v[120:123]
    s_waitcnt lgkmcnt(14)
    v_mfma_f32_16x16x32_bf16 v[124:127], v[80:83], v[76:79], v[124:127]
    s_waitcnt lgkmcnt(12)
    v_mfma_f32_16x16x32_bf16 v[188:191], v[96:99], v[76:79], v[188:191]
    v_mfma_f32_16x16x32_bf16 v[184:187], v[96:99], v[72:75], v[184:187]
    v_mfma_f32_16x16x32_bf16 v[180:183], v[96:99], v[68:71], v[180:183]
    v_mfma_f32_16x16x32_bf16 v[176:179], v[96:99], v[64:67], v[176:179]
    s_waitcnt lgkmcnt(10)
    v_mfma_f32_16x16x32_bf16 v[128:131], v[84:87], v[64:67], v[128:131]
    v_mfma_f32_16x16x32_bf16 v[132:135], v[84:87], v[68:71], v[132:135]
    v_mfma_f32_16x16x32_bf16 v[136:139], v[84:87], v[72:75], v[136:139]
    v_mfma_f32_16x16x32_bf16 v[140:143], v[84:87], v[76:79], v[140:143]
    s_waitcnt lgkmcnt(8)
    v_mfma_f32_16x16x32_bf16 v[204:207], v[100:103], v[76:79], v[204:207]
    v_mfma_f32_16x16x32_bf16 v[200:203], v[100:103], v[72:75], v[200:203]
    v_mfma_f32_16x16x32_bf16 v[196:199], v[100:103], v[68:71], v[196:199]
    v_mfma_f32_16x16x32_bf16 v[192:195], v[100:103], v[64:67], v[192:195]
    s_waitcnt lgkmcnt(6)
    v_mfma_f32_16x16x32_bf16 v[144:147], v[88:91], v[64:67], v[144:147]
    v_mfma_f32_16x16x32_bf16 v[148:151], v[88:91], v[68:71], v[148:151]
    v_mfma_f32_16x16x32_bf16 v[152:155], v[88:91], v[72:75], v[152:155]
    v_mfma_f32_16x16x32_bf16 v[156:159], v[88:91], v[76:79], v[156:159]
    s_waitcnt lgkmcnt(4)
    v_mfma_f32_16x16x32_bf16 v[220:223], v[104:107], v[76:79], v[220:223]
    v_mfma_f32_16x16x32_bf16 v[216:219], v[104:107], v[72:75], v[216:219]
    v_mfma_f32_16x16x32_bf16 v[212:215], v[104:107], v[68:71], v[212:215]
    v_mfma_f32_16x16x32_bf16 v[208:211], v[104:107], v[64:67], v[208:211]
    s_waitcnt lgkmcnt(2)
    v_mfma_f32_16x16x32_bf16 v[160:163], v[92:95], v[64:67], v[160:163]
    v_mfma_f32_16x16x32_bf16 v[164:167], v[92:95], v[68:71], v[164:167]
    v_mfma_f32_16x16x32_bf16 v[168:171], v[92:95], v[72:75], v[168:171]
    v_mfma_f32_16x16x32_bf16 v[172:175], v[92:95], v[76:79], v[172:175]
    s_waitcnt lgkmcnt(0)
    v_mfma_f32_16x16x32_bf16 v[236:239], v[108:111], v[76:79], v[236:239]
    v_mfma_f32_16x16x32_bf16 v[232:235], v[108:111], v[72:75], v[232:235]
    v_mfma_f32_16x16x32_bf16 v[228:231], v[108:111], v[68:71], v[228:231]
    v_mfma_f32_16x16x32_bf16 v[224:227], v[108:111], v[64:67], v[224:227]
    v_and_b32 v5, 15, v0
    v_lshlrev_b32 v5, 2, v5
    s_lshl_b32 s48, s57, 8
    s_add_u32 s48, s48, 147456
    v_add_u32 v5, s48, v5
    s_barrier
    ds_read_b32 v16, v5 offset:0
    ds_read_b32 v18, v5 offset:512
    ds_read_b32 v20, v5 offset:64
    ds_read_b32 v22, v5 offset:576
    ds_read_b32 v24, v5 offset:128
    ds_read_b32 v26, v5 offset:640
    ds_read_b32 v28, v5 offset:192
    ds_read_b32 v30, v5 offset:704
    v_lshrrev_b32 v6, 4, v0
    v_lshlrev_b32 v6, 4, v6
    s_lshl_b32 s48, s58, 8
    s_add_u32 s48, s48, 148480
    v_add_u32 v6, s48, v6
    ds_read_b128 v[32:35], v6 offset:0
    ds_read_b128 v[48:51], v6 offset:512
    ds_read_b128 v[36:39], v6 offset:64
    ds_read_b128 v[52:55], v6 offset:576
    ds_read_b128 v[40:43], v6 offset:128
    ds_read_b128 v[56:59], v6 offset:640
    ds_read_b128 v[44:47], v6 offset:192
    ds_read_b128 v[60:63], v6 offset:704
    s_lshl_b32 s59, s45, 1
    s_add_u32 s59, s59, s57
    s_mul_i32 s48, s59, 196608
    s_lshl_b32 s3, s46, 2
    s_lshl_b32 s50, s58, 1
    s_add_u32 s3, s3, s50
    s_lshl_b32 s3, s3, 11
    s_add_u32 s51, s48, s3
    s_lshl_b32 s59, s59, 1
    s_add_u32 s59, s59, s58
    s_mul_i32 s59, s59, 12
    s_add_u32 s59, s59, s46
    s_lshl_b32 s59, s59, 7
    s_add_u32 s59, s59, 0x10000
    v_lshlrev_b32 v5, 4, v0
    s_waitcnt lgkmcnt(4) vmcnt(0)
    v_mul_f32 v16, v16, v16
    v_mul_f32 v20, v20, v20
    v_mul_f32 v24, v24, v24
    v_mul_f32 v28, v28, v28
    v_pk_fma_f32 v[112:113], v[32:33], v[18:19], v[112:113] op_sel_hi:[1,0,1] neg_lo:[0,1,0] neg_hi:[0,1,0]
    v_pk_fma_f32 v[176:177], v[48:49], v[18:19], v[176:177] op_sel_hi:[1,0,1] neg_lo:[0,1,0] neg_hi:[0,1,0]
    v_pk_fma_f32 v[114:115], v[34:35], v[18:19], v[114:115] op_sel_hi:[1,0,1] neg_lo:[0,1,0] neg_hi:[0,1,0]
    v_pk_fma_f32 v[178:179], v[50:51], v[18:19], v[178:179] op_sel_hi:[1,0,1] neg_lo:[0,1,0] neg_hi:[0,1,0]
    v_max_f32 v112, 0, v112
    v_max_f32 v113, 0, v113
    v_max_f32 v114, 0, v114
    v_max_f32 v115, 0, v115
    v_pk_mul_f32 v[176:177], v[176:177], v[16:17] op_sel_hi:[1,0]
    v_pk_mul_f32 v[178:179], v[178:179], v[16:17] op_sel_hi:[1,0]
    v_pk_mul_f32 v[112:113], v[112:113], v[176:177]
    v_pk_mul_f32 v[114:115], v[114:115], v[178:179]
    v_cvt_pk_bf16_f32 v64, v112, v113
    v_cvt_pk_bf16_f32 v65, v114, v115
    v_pk_fma_f32 v[128:129], v[36:37], v[18:19], v[128:129] op_sel_hi:[1,0,1] neg_lo:[0,1,0] neg_hi:[0,1,0]
    v_pk_fma_f32 v[192:193], v[52:53], v[18:19], v[192:193] op_sel_hi:[1,0,1] neg_lo:[0,1,0] neg_hi:[0,1,0]
    v_pk_fma_f32 v[130:131], v[38:39], v[18:19], v[130:131] op_sel_hi:[1,0,1] neg_lo:[0,1,0] neg_hi:[0,1,0]
    v_pk_fma_f32 v[194:195], v[54:55], v[18:19], v[194:195] op_sel_hi:[1,0,1] neg_lo:[0,1,0] neg_hi:[0,1,0]
    v_max_f32 v128, 0, v128
    v_max_f32 v129, 0, v129
    v_max_f32 v130, 0, v130
    v_max_f32 v131, 0, v131
    v_pk_mul_f32 v[192:193], v[192:193], v[16:17] op_sel_hi:[1,0]
    v_pk_mul_f32 v[194:195], v[194:195], v[16:17] op_sel_hi:[1,0]
    v_pk_mul_f32 v[128:129], v[128:129], v[192:193]
    v_pk_mul_f32 v[130:131], v[130:131], v[194:195]
    v_cvt_pk_bf16_f32 v66, v128, v129
    v_cvt_pk_bf16_f32 v67, v130, v131
    s_add_u32 s48, s51, 393216
    buffer_store_dwordx4 v[64:67], v5, s[20:23], s48 offen offset:0 sc1
    v_pk_fma_f32 v[116:117], v[32:33], v[22:23], v[116:117] op_sel_hi:[1,0,1] neg_lo:[0,1,0] neg_hi:[0,1,0]
    v_pk_fma_f32 v[180:181], v[48:49], v[22:23], v[180:181] op_sel_hi:[1,0,1] neg_lo:[0,1,0] neg_hi:[0,1,0]
    v_pk_fma_f32 v[118:119], v[34:35], v[22:23], v[118:119] op_sel_hi:[1,0,1] neg_lo:[0,1,0] neg_hi:[0,1,0]
    v_pk_fma_f32 v[182:183], v[50:51], v[22:23], v[182:183] op_sel_hi:[1,0,1] neg_lo:[0,1,0] neg_hi:[0,1,0]
    v_max_f32 v116, 0, v116
    v_max_f32 v117, 0, v117
    v_max_f32 v118, 0, v118
    v_max_f32 v119, 0, v119
    v_pk_mul_f32 v[180:181], v[180:181], v[20:21] op_sel_hi:[1,0]
    v_pk_mul_f32 v[182:183], v[182:183], v[20:21] op_sel_hi:[1,0]
    v_pk_mul_f32 v[116:117], v[116:117], v[180:181]
    v_pk_mul_f32 v[118:119], v[118:119], v[182:183]
    v_cvt_pk_bf16_f32 v68, v116, v117
    v_cvt_pk_bf16_f32 v69, v118, v119
    v_pk_fma_f32 v[132:133], v[36:37], v[22:23], v[132:133] op_sel_hi:[1,0,1] neg_lo:[0,1,0] neg_hi:[0,1,0]
    v_pk_fma_f32 v[196:197], v[52:53], v[22:23], v[196:197] op_sel_hi:[1,0,1] neg_lo:[0,1,0] neg_hi:[0,1,0]
    v_pk_fma_f32 v[134:135], v[38:39], v[22:23], v[134:135] op_sel_hi:[1,0,1] neg_lo:[0,1,0] neg_hi:[0,1,0]
    v_pk_fma_f32 v[198:199], v[54:55], v[22:23], v[198:199] op_sel_hi:[1,0,1] neg_lo:[0,1,0] neg_hi:[0,1,0]
    v_max_f32 v132, 0, v132
    v_max_f32 v133, 0, v133
    v_max_f32 v134, 0, v134
    v_max_f32 v135, 0, v135
    v_pk_mul_f32 v[196:197], v[196:197], v[20:21] op_sel_hi:[1,0]
    v_pk_mul_f32 v[198:199], v[198:199], v[20:21] op_sel_hi:[1,0]
    v_pk_mul_f32 v[132:133], v[132:133], v[196:197]
    v_pk_mul_f32 v[134:135], v[134:135], v[198:199]
    v_cvt_pk_bf16_f32 v70, v132, v133
    v_cvt_pk_bf16_f32 v71, v134, v135
    s_add_u32 s48, s51, 393216
    buffer_store_dwordx4 v[68:71], v5, s[20:23], s48 offen offset:1024 sc1
    v_pk_fma_f32 v[120:121], v[32:33], v[26:27], v[120:121] op_sel_hi:[1,0,1] neg_lo:[0,1,0] neg_hi:[0,1,0]
    v_pk_fma_f32 v[184:185], v[48:49], v[26:27], v[184:185] op_sel_hi:[1,0,1] neg_lo:[0,1,0] neg_hi:[0,1,0]
    v_pk_fma_f32 v[122:123], v[34:35], v[26:27], v[122:123] op_sel_hi:[1,0,1] neg_lo:[0,1,0] neg_hi:[0,1,0]
    v_pk_fma_f32 v[186:187], v[50:51], v[26:27], v[186:187] op_sel_hi:[1,0,1] neg_lo:[0,1,0] neg_hi:[0,1,0]
    v_max_f32 v120, 0, v120
    v_max_f32 v121, 0, v121
    v_max_f32 v122, 0, v122
    v_max_f32 v123, 0, v123
    v_pk_mul_f32 v[184:185], v[184:185], v[24:25] op_sel_hi:[1,0]
    v_pk_mul_f32 v[186:187], v[186:187], v[24:25] op_sel_hi:[1,0]
    v_pk_mul_f32 v[120:121], v[120:121], v[184:185]
    v_pk_mul_f32 v[122:123], v[122:123], v[186:187]
    v_cvt_pk_bf16_f32 v72, v120, v121
    v_cvt_pk_bf16_f32 v73, v122, v123
    v_pk_fma_f32 v[136:137], v[36:37], v[26:27], v[136:137] op_sel_hi:[1,0,1] neg_lo:[0,1,0] neg_hi:[0,1,0]
    v_pk_fma_f32 v[200:201], v[52:53], v[26:27], v[200:201] op_sel_hi:[1,0,1] neg_lo:[0,1,0] neg_hi:[0,1,0]
    v_pk_fma_f32 v[138:139], v[38:39], v[26:27], v[138:139] op_sel_hi:[1,0,1] neg_lo:[0,1,0] neg_hi:[0,1,0]
    v_pk_fma_f32 v[202:203], v[54:55], v[26:27], v[202:203] op_sel_hi:[1,0,1] neg_lo:[0,1,0] neg_hi:[0,1,0]
    v_max_f32 v136, 0, v136
    v_max_f32 v137, 0, v137
    v_max_f32 v138, 0, v138
    v_max_f32 v139, 0, v139
    v_pk_mul_f32 v[200:201], v[200:201], v[24:25] op_sel_hi:[1,0]
    v_pk_mul_f32 v[202:203], v[202:203], v[24:25] op_sel_hi:[1,0]
    v_pk_mul_f32 v[136:137], v[136:137], v[200:201]
    v_pk_mul_f32 v[138:139], v[138:139], v[202:203]
    v_cvt_pk_bf16_f32 v74, v136, v137
    v_cvt_pk_bf16_f32 v75, v138, v139
    s_add_u32 s48, s51, 491520
    buffer_store_dwordx4 v[72:75], v5, s[20:23], s48 offen offset:0 sc1
    v_pk_fma_f32 v[124:125], v[32:33], v[30:31], v[124:125] op_sel_hi:[1,0,1] neg_lo:[0,1,0] neg_hi:[0,1,0]
    v_pk_fma_f32 v[188:189], v[48:49], v[30:31], v[188:189] op_sel_hi:[1,0,1] neg_lo:[0,1,0] neg_hi:[0,1,0]
    v_pk_fma_f32 v[126:127], v[34:35], v[30:31], v[126:127] op_sel_hi:[1,0,1] neg_lo:[0,1,0] neg_hi:[0,1,0]
    v_pk_fma_f32 v[190:191], v[50:51], v[30:31], v[190:191] op_sel_hi:[1,0,1] neg_lo:[0,1,0] neg_hi:[0,1,0]
    v_max_f32 v124, 0, v124
    v_max_f32 v125, 0, v125
    v_max_f32 v126, 0, v126
    v_max_f32 v127, 0, v127
    v_pk_mul_f32 v[188:189], v[188:189], v[28:29] op_sel_hi:[1,0]
    v_pk_mul_f32 v[190:191], v[190:191], v[28:29] op_sel_hi:[1,0]
    v_pk_mul_f32 v[124:125], v[124:125], v[188:189]
    v_pk_mul_f32 v[126:127], v[126:127], v[190:191]
    v_cvt_pk_bf16_f32 v76, v124, v125
    v_cvt_pk_bf16_f32 v77, v126, v127
    v_pk_fma_f32 v[140:141], v[36:37], v[30:31], v[140:141] op_sel_hi:[1,0,1] neg_lo:[0,1,0] neg_hi:[0,1,0]
    v_pk_fma_f32 v[204:205], v[52:53], v[30:31], v[204:205] op_sel_hi:[1,0,1] neg_lo:[0,1,0] neg_hi:[0,1,0]
    v_pk_fma_f32 v[142:143], v[38:39], v[30:31], v[142:143] op_sel_hi:[1,0,1] neg_lo:[0,1,0] neg_hi:[0,1,0]
    v_pk_fma_f32 v[206:207], v[54:55], v[30:31], v[206:207] op_sel_hi:[1,0,1] neg_lo:[0,1,0] neg_hi:[0,1,0]
    v_max_f32 v140, 0, v140
    v_max_f32 v141, 0, v141
    v_max_f32 v142, 0, v142
    v_max_f32 v143, 0, v143
    v_pk_mul_f32 v[204:205], v[204:205], v[28:29] op_sel_hi:[1,0]
    v_pk_mul_f32 v[206:207], v[206:207], v[28:29] op_sel_hi:[1,0]
    v_pk_mul_f32 v[140:141], v[140:141], v[204:205]
    v_pk_mul_f32 v[142:143], v[142:143], v[206:207]
    v_cvt_pk_bf16_f32 v78, v140, v141
    v_cvt_pk_bf16_f32 v79, v142, v143
    s_add_u32 s48, s51, 491520
    buffer_store_dwordx4 v[76:79], v5, s[20:23], s48 offen offset:1024 sc1
    s_waitcnt lgkmcnt(0)
    v_pk_fma_f32 v[144:145], v[40:41], v[18:19], v[144:145] op_sel_hi:[1,0,1] neg_lo:[0,1,0] neg_hi:[0,1,0]
    v_pk_fma_f32 v[208:209], v[56:57], v[18:19], v[208:209] op_sel_hi:[1,0,1] neg_lo:[0,1,0] neg_hi:[0,1,0]
    v_pk_fma_f32 v[146:147], v[42:43], v[18:19], v[146:147] op_sel_hi:[1,0,1] neg_lo:[0,1,0] neg_hi:[0,1,0]
    v_pk_fma_f32 v[210:211], v[58:59], v[18:19], v[210:211] op_sel_hi:[1,0,1] neg_lo:[0,1,0] neg_hi:[0,1,0]
    v_max_f32 v144, 0, v144
    v_max_f32 v145, 0, v145
    v_max_f32 v146, 0, v146
    v_max_f32 v147, 0, v147
    v_pk_mul_f32 v[208:209], v[208:209], v[16:17] op_sel_hi:[1,0]
    v_pk_mul_f32 v[210:211], v[210:211], v[16:17] op_sel_hi:[1,0]
    v_pk_mul_f32 v[144:145], v[144:145], v[208:209]
    v_pk_mul_f32 v[146:147], v[146:147], v[210:211]
    v_cvt_pk_bf16_f32 v64, v144, v145
    v_cvt_pk_bf16_f32 v65, v146, v147
    v_pk_fma_f32 v[160:161], v[44:45], v[18:19], v[160:161] op_sel_hi:[1,0,1] neg_lo:[0,1,0] neg_hi:[0,1,0]
    v_pk_fma_f32 v[224:225], v[60:61], v[18:19], v[224:225] op_sel_hi:[1,0,1] neg_lo:[0,1,0] neg_hi:[0,1,0]
    v_pk_fma_f32 v[162:163], v[46:47], v[18:19], v[162:163] op_sel_hi:[1,0,1] neg_lo:[0,1,0] neg_hi:[0,1,0]
    v_pk_fma_f32 v[226:227], v[62:63], v[18:19], v[226:227] op_sel_hi:[1,0,1] neg_lo:[0,1,0] neg_hi:[0,1,0]
    v_max_f32 v160, 0, v160
    v_max_f32 v161, 0, v161
    v_max_f32 v162, 0, v162
    v_max_f32 v163, 0, v163
    v_pk_mul_f32 v[224:225], v[224:225], v[16:17] op_sel_hi:[1,0]
    v_pk_mul_f32 v[226:227], v[226:227], v[16:17] op_sel_hi:[1,0]
    v_pk_mul_f32 v[160:161], v[160:161], v[224:225]
    v_pk_mul_f32 v[162:163], v[162:163], v[226:227]
    v_cvt_pk_bf16_f32 v66, v160, v161
    v_cvt_pk_bf16_f32 v67, v162, v163
    s_add_u32 s48, s51, 395264
    buffer_store_dwordx4 v[64:67], v5, s[20:23], s48 offen offset:0 sc1
    v_pk_fma_f32 v[148:149], v[40:41], v[22:23], v[148:149] op_sel_hi:[1,0,1] neg_lo:[0,1,0] neg_hi:[0,1,0]
    v_pk_fma_f32 v[212:213], v[56:57], v[22:23], v[212:213] op_sel_hi:[1,0,1] neg_lo:[0,1,0] neg_hi:[0,1,0]
    v_pk_fma_f32 v[150:151], v[42:43], v[22:23], v[150:151] op_sel_hi:[1,0,1] neg_lo:[0,1,0] neg_hi:[0,1,0]
    v_pk_fma_f32 v[214:215], v[58:59], v[22:23], v[214:215] op_sel_hi:[1,0,1] neg_lo:[0,1,0] neg_hi:[0,1,0]
    v_max_f32 v148, 0, v148
    v_max_f32 v149, 0, v149
    v_max_f32 v150, 0, v150
    v_max_f32 v151, 0, v151
    v_pk_mul_f32 v[212:213], v[212:213], v[20:21] op_sel_hi:[1,0]
    v_pk_mul_f32 v[214:215], v[214:215], v[20:21] op_sel_hi:[1,0]
    v_pk_mul_f32 v[148:149], v[148:149], v[212:213]
    v_pk_mul_f32 v[150:151], v[150:151], v[214:215]
    v_cvt_pk_bf16_f32 v68, v148, v149
    v_cvt_pk_bf16_f32 v69, v150, v151
    v_pk_fma_f32 v[164:165], v[44:45], v[22:23], v[164:165] op_sel_hi:[1,0,1] neg_lo:[0,1,0] neg_hi:[0,1,0]
    v_pk_fma_f32 v[228:229], v[60:61], v[22:23], v[228:229] op_sel_hi:[1,0,1] neg_lo:[0,1,0] neg_hi:[0,1,0]
    v_pk_fma_f32 v[166:167], v[46:47], v[22:23], v[166:167] op_sel_hi:[1,0,1] neg_lo:[0,1,0] neg_hi:[0,1,0]
    v_pk_fma_f32 v[230:231], v[62:63], v[22:23], v[230:231] op_sel_hi:[1,0,1] neg_lo:[0,1,0] neg_hi:[0,1,0]
    v_max_f32 v164, 0, v164
    v_max_f32 v165, 0, v165
    v_max_f32 v166, 0, v166
    v_max_f32 v167, 0, v167
    v_pk_mul_f32 v[228:229], v[228:229], v[20:21] op_sel_hi:[1,0]
    v_pk_mul_f32 v[230:231], v[230:231], v[20:21] op_sel_hi:[1,0]
    v_pk_mul_f32 v[164:165], v[164:165], v[228:229]
    v_pk_mul_f32 v[166:167], v[166:167], v[230:231]
    v_cvt_pk_bf16_f32 v70, v164, v165
    v_cvt_pk_bf16_f32 v71, v166, v167
    s_add_u32 s48, s51, 395264
    buffer_store_dwordx4 v[68:71], v5, s[20:23], s48 offen offset:1024 sc1
    v_pk_fma_f32 v[152:153], v[40:41], v[26:27], v[152:153] op_sel_hi:[1,0,1] neg_lo:[0,1,0] neg_hi:[0,1,0]
    v_pk_fma_f32 v[216:217], v[56:57], v[26:27], v[216:217] op_sel_hi:[1,0,1] neg_lo:[0,1,0] neg_hi:[0,1,0]
    v_pk_fma_f32 v[154:155], v[42:43], v[26:27], v[154:155] op_sel_hi:[1,0,1] neg_lo:[0,1,0] neg_hi:[0,1,0]
    v_pk_fma_f32 v[218:219], v[58:59], v[26:27], v[218:219] op_sel_hi:[1,0,1] neg_lo:[0,1,0] neg_hi:[0,1,0]
    v_max_f32 v152, 0, v152
    v_max_f32 v153, 0, v153
    v_max_f32 v154, 0, v154
    v_max_f32 v155, 0, v155
    v_pk_mul_f32 v[216:217], v[216:217], v[24:25] op_sel_hi:[1,0]
    v_pk_mul_f32 v[218:219], v[218:219], v[24:25] op_sel_hi:[1,0]
    v_pk_mul_f32 v[152:153], v[152:153], v[216:217]
    v_pk_mul_f32 v[154:155], v[154:155], v[218:219]
    v_cvt_pk_bf16_f32 v72, v152, v153
    v_cvt_pk_bf16_f32 v73, v154, v155
    v_pk_fma_f32 v[168:169], v[44:45], v[26:27], v[168:169] op_sel_hi:[1,0,1] neg_lo:[0,1,0] neg_hi:[0,1,0]
    v_pk_fma_f32 v[232:233], v[60:61], v[26:27], v[232:233] op_sel_hi:[1,0,1] neg_lo:[0,1,0] neg_hi:[0,1,0]
    v_pk_fma_f32 v[170:171], v[46:47], v[26:27], v[170:171] op_sel_hi:[1,0,1] neg_lo:[0,1,0] neg_hi:[0,1,0]
    v_pk_fma_f32 v[234:235], v[62:63], v[26:27], v[234:235] op_sel_hi:[1,0,1] neg_lo:[0,1,0] neg_hi:[0,1,0]
    v_max_f32 v168, 0, v168
    v_max_f32 v169, 0, v169
    v_max_f32 v170, 0, v170
    v_max_f32 v171, 0, v171
    v_pk_mul_f32 v[232:233], v[232:233], v[24:25] op_sel_hi:[1,0]
    v_pk_mul_f32 v[234:235], v[234:235], v[24:25] op_sel_hi:[1,0]
    v_pk_mul_f32 v[168:169], v[168:169], v[232:233]
    v_pk_mul_f32 v[170:171], v[170:171], v[234:235]
    v_cvt_pk_bf16_f32 v74, v168, v169
    v_cvt_pk_bf16_f32 v75, v170, v171
    s_add_u32 s48, s51, 493568
    buffer_store_dwordx4 v[72:75], v5, s[20:23], s48 offen offset:0 sc1
    v_pk_fma_f32 v[156:157], v[40:41], v[30:31], v[156:157] op_sel_hi:[1,0,1] neg_lo:[0,1,0] neg_hi:[0,1,0]
    v_pk_fma_f32 v[220:221], v[56:57], v[30:31], v[220:221] op_sel_hi:[1,0,1] neg_lo:[0,1,0] neg_hi:[0,1,0]
    v_pk_fma_f32 v[158:159], v[42:43], v[30:31], v[158:159] op_sel_hi:[1,0,1] neg_lo:[0,1,0] neg_hi:[0,1,0]
    v_pk_fma_f32 v[222:223], v[58:59], v[30:31], v[222:223] op_sel_hi:[1,0,1] neg_lo:[0,1,0] neg_hi:[0,1,0]
    v_max_f32 v156, 0, v156
    v_max_f32 v157, 0, v157
    v_max_f32 v158, 0, v158
    v_max_f32 v159, 0, v159
    v_pk_mul_f32 v[220:221], v[220:221], v[28:29] op_sel_hi:[1,0]
    v_pk_mul_f32 v[222:223], v[222:223], v[28:29] op_sel_hi:[1,0]
    v_pk_mul_f32 v[156:157], v[156:157], v[220:221]
    v_pk_mul_f32 v[158:159], v[158:159], v[222:223]
    v_cvt_pk_bf16_f32 v76, v156, v157
    v_cvt_pk_bf16_f32 v77, v158, v159
    v_pk_fma_f32 v[172:173], v[44:45], v[30:31], v[172:173] op_sel_hi:[1,0,1] neg_lo:[0,1,0] neg_hi:[0,1,0]
    v_pk_fma_f32 v[236:237], v[60:61], v[30:31], v[236:237] op_sel_hi:[1,0,1] neg_lo:[0,1,0] neg_hi:[0,1,0]
    v_pk_fma_f32 v[174:175], v[46:47], v[30:31], v[174:175] op_sel_hi:[1,0,1] neg_lo:[0,1,0] neg_hi:[0,1,0]
    v_pk_fma_f32 v[238:239], v[62:63], v[30:31], v[238:239] op_sel_hi:[1,0,1] neg_lo:[0,1,0] neg_hi:[0,1,0]
    v_max_f32 v172, 0, v172
    v_max_f32 v173, 0, v173
    v_max_f32 v174, 0, v174
    v_max_f32 v175, 0, v175
    v_pk_mul_f32 v[236:237], v[236:237], v[28:29] op_sel_hi:[1,0]
    v_pk_mul_f32 v[238:239], v[238:239], v[28:29] op_sel_hi:[1,0]
    v_pk_mul_f32 v[172:173], v[172:173], v[236:237]
    v_pk_mul_f32 v[174:175], v[174:175], v[238:239]
    v_cvt_pk_bf16_f32 v78, v172, v173
    v_cvt_pk_bf16_f32 v79, v174, v175
    s_add_u32 s48, s51, 493568
    buffer_store_dwordx4 v[76:79], v5, s[20:23], s48 offen offset:1024 sc1
    v_lshlrev_b32 v1, 4, v0
    s_add_u32 s48, s44, 0
    s_bfe_u32 s49, s48, 0x10001
    s_mul_i32 s49, s49, 98304
    s_and_b32 s48, s48, 1
    s_lshl_b32 s48, s48, 10
    s_add_u32 s48, s48, s49
    s_add_u32 s48, s48, s66
    s_add_u32 s50, s48, 393216
    s_add_u32 s48, s44, 1
    s_bfe_u32 s49, s48, 0x10001
    s_mul_i32 s49, s49, 98304
    s_and_b32 s48, s48, 1
    s_lshl_b32 s48, s48, 10
    s_add_u32 s48, s48, s49
    s_add_u32 s48, s48, s66
    s_add_u32 s51, s48, 393216
    s_add_u32 s48, s44, 2
    s_bfe_u32 s49, s48, 0x10001
    s_mul_i32 s49, s49, 98304
    s_and_b32 s48, s48, 1
    s_lshl_b32 s48, s48, 10
    s_add_u32 s48, s48, s49
    s_add_u32 s48, s48, s66
    s_add_u32 s52, s48, 393216
    s_add_u32 s48, s44, 3
    s_bfe_u32 s49, s48, 0x10001
    s_mul_i32 s49, s49, 98304
    s_and_b32 s48, s48, 1
    s_lshl_b32 s48, s48, 10
    s_add_u32 s48, s48, s49
    s_add_u32 s48, s48, s66
    s_add_u32 s53, s48, 393216
    s_and_b32 s82, s65, 3
    s_mul_i32 s82, s82, 0
    s_and_b32 s48, s64, 7
    s_mul_i32 s48, s48, 0
    s_add_u32 s82, s82, s48
    s_mov_b32 s79, 0
    s_branch L_p3c
L_dft:
    s_mov_b32 s46, s3
    s_cmp_ge_u32 s44, 4
    s_cbranch_scc0 L_dftc
    v_lshrrev_b32 v6, 3, v0
    v_mul_u32_u24 v7, 81920, v6
    v_and_b32 v8, 7, v0
    v_lshl_add_u32 v2, v8, 4, v7
    v_lshrrev_b32 v7, 4, v0
    v_xor_b32 v8, v8, v7
    v_lshlrev_b32 v6, 7, v6
    v_lshl_add_u32 v6, v8, 4, v6
    s_mul_i32 s48, s47, 20480
    s_add_u32 s48, s48, 75776
    v_add_u32 v8, s48, v6
    v_xor_b32 v9, 64, v8
    v_lshlrev_b32 v4, 4, v0
    s_lshl_b32 s54, s45, 2
    s_add_u32 s54, s54, s47
    s_mul_i32 s54, s54, 1280
    s_getpc_b64 s[4:5]
    s_add_u32 s4, s4, dft_tables@rel32@lo+4
    s_addc_u32 s5, s5, dft_tables@rel32@hi+12
    s_mov_b32 s24, s4
    s_and_b32 s25, s5, 0xffff
    s_mov_b32 s26, 0x66000
    s_mov_b32 s27, 0x00020000
    s_waitcnt lgkmcnt(0)
    s_mov_b32 s8, s64
    s_and_b32 s9, s65, 0xffff
    s_mov_b32 s10, 0x280000
    s_mov_b32 s11, 0x00020000
    s_add_u32 s48, s54, 0
    buffer_load_dwordx4 v[64:67], v2, s[8:11], s48 offen offset:0
    s_add_u32 s48, s54, 0
    buffer_load_dwordx4 v[68:71], v2, s[8:11], s48 offen offset:640
    s_add_u32 s48, s54, 655360
    buffer_load_dwordx4 v[72:75], v2, s[8:11], s48 offen offset:0
    s_add_u32 s48, s54, 655360
    buffer_load_dwordx4 v[76:79], v2, s[8:11], s48 offen offset:640
    s_add_u32 s48, s54, 1310720
    buffer_load_dwordx4 v[80:83], v2, s[8:11], s48 offen offset:0
    s_add_u32 s48, s54, 1310720
    buffer_load_dwordx4 v[84:87], v2, s[8:11], s48 offen offset:640
    v_mov_b32 v12, 149504
    v_mov_b32 v13, 0
    ds_write_b32 v12, v13
    ds_write_b32 v12, v13 offset:4
    ds_write_b32 v12, v13 offset:8
    ds_write_b32 v12, v13 offset:12
    ds_write_b32 v12, v13 offset:36
    ds_write_b32 v12, v13 offset:16
    ds_write_b32 v12, v13 offset:20
    ds_write_b32 v12, v13 offset:24
    ds_write_b32 v12, v13 offset:28
    s_load_dword s62, s[82:83], 0x0
    s_mov_b32 s20, s82
    s_and_b32 s21, s83, 0xffff
    s_mov_b32 s22, 0x10000000
    s_mov_b32 s23, 0x00020000
    s_mov_b32 s28, s66
    s_and_b32 s29, s67, 0xffff
    s_mov_b32 s30, 0x141000
    s_mov_b32 s31, 0x00020000
    s_mov_b32 s32, s68
    s_and_b32 s33, s69, 0xffff
    s_mov_b32 s34, 0x141000
    s_mov_b32 s35, 0x00020000
    s_mov_b32 s40, s78
    s_and_b32 s41, s79, 0xffff
    s_mov_b32 s42, 0x280000
    s_mov_b32 s43, 0x00020000
    s_cmp_ge_u32 s46, 2
    s_cselect_b32 s76, -1.0, 1.0
    s_add_u32 s48, s54, 128
    buffer_load_dwordx4 v[96:99], v2, s[8:11], s48 offen offset:0
    s_add_u32 s48, s54, 128
    buffer_load_dwordx4 v[100:103], v2, s[8:11], s48 offen offset:640
    s_add_u32 s48, s54, 655488
    buffer_load_dwordx4 v[104:107], v2, s[8:11], s48 offen offset:0
    s_add_u32 s48, s54, 655488
    buffer_load_dwordx4 v[108:111], v2, s[8:11], s48 offen offset:640
    s_add_u32 s48, s54, 1310848
    buffer_load_dwordx4 v[112:115], v2, s[8:11], s48 offen offset:0
    s_add_u32 s48, s54, 1310848
    buffer_load_dwordx4 v[116:119], v2, s[8:11], s48 offen offset:640
    v_mov_b32 v44, 0xffff0000
    s_lshl_b32 s48, s45, 2
    s_add_u32 s48, s48, s47
    s_lshl_b32 s48, s48, 1
    v_and_b32 v6, 1, v0
    v_add_u32 v6, s48, v6
    v_lshlrev_b32 v15, 7, v6
    s_lshl_b32 s48, s47, 6
    v_add_u32 v10, s48, v0
    v_min_u32 v10, 159, v10
    v_lshlrev_b32 v10, 7, v10
    v_and_b32 v24, 31, v0
    v_lshrrev_b32 v25, 5, v0
    v_lshlrev_b32 v24, 2, v24
    v_lshl_add_u32 v24, v25, 9, v24
    s_lshl_b32 s48, s47, 7
    v_add_u32 v24, s48, v24
    s_waitcnt vmcnt(6)
    v_lshlrev_b32 v28, 16, v64
    v_lshlrev_b32 v32, 16, v68
    v_lshlrev_b32 v29, 16, v65
    v_lshlrev_b32 v33, 16, v69
    v_lshlrev_b32 v30, 16, v66
    v_lshlrev_b32 v34, 16, v70
    v_lshlrev_b32 v31, 16, v67
    v_lshlrev_b32 v35, 16, v71
    v_and_b32 v64, v44, v64
    v_and_b32 v65, v44, v65
    v_and_b32 v66, v44, v66
    v_and_b32 v67, v44, v67
    v_and_b32 v68, v44, v68
    v_and_b32 v69, v44, v69
    v_and_b32 v70, v44, v70
    v_and_b32 v71, v44, v71
    v_fmac_f32 v28, s76, v32
    v_fmac_f32 v29, s76, v33
    v_fmac_f32 v30, s76, v34
    v_fmac_f32 v31, s76, v35
    v_fmac_f32 v64, s76, v68
    v_fmac_f32 v65, s76, v69
    v_fmac_f32 v66, s76, v70
    v_fmac_f32 v67, s76, v71
    v_cvt_pk_bf16_f32 v64, v28, v64
    v_cvt_pk_bf16_f32 v65, v29, v65
    v_cvt_pk_bf16_f32 v66, v30, v66
    v_cvt_pk_bf16_f32 v67, v31, v67
    ds_write_b128 v8, v[64:67] offset:5120
    v_lshlrev_b32 v36, 16, v72
    v_lshlrev_b32 v40, 16, v76
    v_lshlrev_b32 v37, 16, v73
    v_lshlrev_b32 v41, 16, v77
    v_lshlrev_b32 v38, 16, v74
    v_lshlrev_b32 v42, 16, v78
    v_lshlrev_b32 v39, 16, v75
    v_lshlrev_b32 v43, 16, v79
    v_and_b32 v72, v44, v72
    v_and_b32 v73, v44, v73
    v_and_b32 v74, v44, v74
    v_and_b32 v75, v44, v75
    v_and_b32 v76, v44, v76
    v_and_b32 v77, v44, v77
    v_and_b32 v78, v44, v78
    v_and_b32 v79, v44, v79
    v_fmac_f32 v36, s76, v40
    v_fmac_f32 v37, s76, v41
    v_fmac_f32 v38, s76, v42
    v_fmac_f32 v39, s76, v43
    v_fmac_f32 v72, s76, v76
    v_fmac_f32 v73, s76, v77
    v_fmac_f32 v74, s76, v78
    v_fmac_f32 v75, s76, v79
    v_cvt_pk_bf16_f32 v72, v36, v72
    v_cvt_pk_bf16_f32 v73, v37, v73
    v_cvt_pk_bf16_f32 v74, v38, v74
    v_cvt_pk_bf16_f32 v75, v39, v75
    ds_write_b128 v9, v[72:75] offset:6144
    v_lshlrev_b32 v28, 16, v80
    v_lshlrev_b32 v32, 16, v84
    v_lshlrev_b32 v29, 16, v81
    v_lshlrev_b32 v33, 16, v85
    v_lshlrev_b32 v30, 16, v82
    v_lshlrev_b32 v34, 16, v86
    v_lshlrev_b32 v31, 16, v83
    v_lshlrev_b32 v35, 16, v87
    v_and_b32 v80, v44, v80
    v_and_b32 v81, v44, v81
    v_and_b32 v82, v44, v82
    v_and_b32 v83, v44, v83
    v_and_b32 v84, v44, v84
    v_and_b32 v85, v44, v85
    v_and_b32 v86, v44, v86
    v_and_b32 v87, v44, v87
    v_fmac_f32 v28, s76, v32
    v_fmac_f32 v29, s76, v33
    v_fmac_f32 v30, s76, v34
    v_fmac_f32 v31, s76, v35
    v_fmac_f32 v80, s76, v84
    v_fmac_f32 v81, s76, v85
    v_fmac_f32 v82, s76, v86
    v_fmac_f32 v83, s76, v87
    v_cvt_pk_bf16_f32 v80, v28, v80
    v_cvt_pk_bf16_f32 v81, v29, v81
    v_cvt_pk_bf16_f32 v82, v30, v82
    v_cvt_pk_bf16_f32 v83, v31, v83
    ds_write_b128 v8, v[80:83] offset:7168
    s_waitcnt lgkmcnt(0)
    s_barrier
    s_mul_i32 s62, s62, 0x9E3779B1
    s_add_u32 s62, s62, 0x7F4A7C15
    s_waitcnt vmcnt(0)
    s_add_u32 s48, s54, 256
    buffer_load_dwordx4 v[128:131], v2, s[8:11], s48 offen offset:0
    v_lshlrev_b32 v28, 16, v96
    v_lshlrev_b32 v32, 16, v100
    v_lshlrev_b32 v29, 16, v97
    v_lshlrev_b32 v33, 16, v101
    v_lshlrev_b32 v30, 16, v98
    v_lshlrev_b32 v34, 16, v102
    v_lshlrev_b32 v31, 16, v99
    v_lshlrev_b32 v35, 16, v103
    s_add_u32 s48, s54, 256
    buffer_load_dwordx4 v[132:135], v2, s[8:11], s48 offen offset:640
    v_and_b32 v96, v44, v96
    v_and_b32 v97, v44, v97
    v_and_b32 v98, v44, v98
    v_and_b32 v99, v44, v99
    v_and_b32 v100, v44, v100
    v_and_b32 v101, v44, v101
    v_and_b32 v102, v44, v102
    s_add_u32 s48, s54, 655616
    buffer_load_dwordx4 v[136:139], v2, s[8:11], s48 offen offset:0
    v_and_b32 v103, v44, v103
    v_fmac_f32 v28, s76, v32
    v_fmac_f32 v29, s76, v33
    v_fmac_f32 v30, s76, v34
    v_fmac_f32 v31, s76, v35
    v_fmac_f32 v96, s76, v100
    v_fmac_f32 v97, s76, v101
    s_add_u32 s48, s54, 655616
    buffer_load_dwordx4 v[140:143], v2, s[8:11], s48 offen offset:640
    v_fmac_f32 v98, s76, v102
    v_fmac_f32 v99, s76, v103
    v_cvt_pk_bf16_f32 v96, v28, v96
    v_cvt_pk_bf16_f32 v97, v29, v97
    v_cvt_pk_bf16_f32 v98, v30, v98
    v_cvt_pk_bf16_f32 v99, v31, v99
    ds_write_b128 v8, v[96:99] offset:0
    s_add_u32 s48, s54, 1310976
    buffer_load_dwordx4 v[144:147], v2, s[8:11], s48 offen offset:0
    v_lshlrev_b32 v36, 16, v104
    v_lshlrev_b32 v40, 16, v108
    v_lshlrev_b32 v37, 16, v105
    v_lshlrev_b32 v41, 16, v109
    v_lshlrev_b32 v38, 16, v106
    v_lshlrev_b32 v42, 16, v110
    v_lshlrev_b32 v39, 16, v107
    v_lshlrev_b32 v43, 16, v111
    s_add_u32 s48, s54, 1310976
    buffer_load_dwordx4 v[148:151], v2, s[8:11], s48 offen offset:640
    v_and_b32 v104, v44, v104
    v_and_b32 v105, v44, v105
    v_and_b32 v106, v44, v106
    v_and_b32 v107, v44, v107
    v_and_b32 v108, v44, v108
    v_and_b32 v109, v44, v109
    v_and_b32 v110, v44, v110
    s_add_u32 s48, s54, 384
    buffer_load_dwordx4 v[160:163], v2, s[8:11], s48 offen offset:0
    v_and_b32 v111, v44, v111
    v_fmac_f32 v36, s76, v40
    v_fmac_f32 v37, s76, v41
    v_fmac_f32 v38, s76, v42
    v_fmac_f32 v39, s76, v43
    v_fmac_f32 v104, s76, v108
    v_fmac_f32 v105, s76, v109
    s_add_u32 s48, s54, 384
    buffer_load_dwordx4 v[164:167], v2, s[8:11], s48 offen offset:640
    v_fmac_f32 v106, s76, v110
    v_fmac_f32 v107, s76, v111
    v_cvt_pk_bf16_f32 v104, v36, v104
    v_cvt_pk_bf16_f32 v105, v37, v105
    v_cvt_pk_bf16_f32 v106, v38, v106
    v_cvt_pk_bf16_f32 v107, v39, v107
    ds_write_b128 v9, v[104:107] offset:1024
    s_add_u32 s48, s54, 655744
    buffer_load_dwordx4 v[168:171], v2, s[8:11], s48 offen offset:0
    v_lshlrev_b32 v28, 16, v112
    v_lshlrev_b32 v32, 16, v116
    v_lshlrev_b32 v29, 16, v113
    v_lshlrev_b32 v33, 16, v117
    v_lshlrev_b32 v30, 16, v114
    v_lshlrev_b32 v34, 16, v118
    v_lshlrev_b32 v31, 16, v115
    v_lshlrev_b32 v35, 16, v119
    s_add_u32 s48, s54, 655744
    buffer_load_dwordx4 v[172:175], v2, s[8:11], s48 offen offset:640
    v_and_b32 v112, v44, v112
    v_and_b32 v113, v44, v113
    v_and_b32 v114, v44, v114
    v_and_b32 v115, v44, v115
    v_and_b32 v116, v44, v116
    v_and_b32 v117, v44, v117
    v_and_b32 v118, v44, v118
    s_add_u32 s48, s54, 1311104
    buffer_load_dwordx4 v[176:179], v2, s[8:11], s48 offen offset:0
    v_and_b32 v119, v44, v119
    v_fmac_f32 v28, s76, v32
    v_fmac_f32 v29, s76, v33
    v_fmac_f32 v30, s76, v34
    v_fmac_f32 v31, s76, v35
    v_fmac_f32 v112, s76, v116
    v_fmac_f32 v113, s76, v117
    s_add_u32 s48, s54, 1311104
    buffer_load_dwordx4 v[180:183], v2, s[8:11], s48 offen offset:640
    v_fmac_f32 v114, s76, v118
    v_fmac_f32 v115, s76, v119
    v_cvt_pk_bf16_f32 v112, v28, v112
    v_cvt_pk_bf16_f32 v113, v29, v113
    v_cvt_pk_bf16_f32 v114, v30, v114
    v_cvt_pk_bf16_f32 v115, v31, v115
    ds_write_b128 v8, v[112:115] offset:2048
    s_waitcnt lgkmcnt(0)
    s_barrier
    s_waitcnt vmcnt(6)
    s_add_u32 s48, s54, 512
    buffer_load_dwordx4 v[192:195], v2, s[8:11], s48 offen offset:0
    v_lshlrev_b32 v28, 16, v128
    v_lshlrev_b32 v32, 16, v132
    v_lshlrev_b32 v29, 16, v129
    v_lshlrev_b32 v33, 16, v133
    v_lshlrev_b32 v30, 16, v130
    v_lshlrev_b32 v34, 16, v134
    v_lshlrev_b32 v31, 16, v131
    v_lshlrev_b32 v35, 16, v135
    v_and_b32 v128, v44, v128
    v_and_b32 v129, v44, v129
    v_and_b32 v130, v44, v130
    v_and_b32 v131, v44, v131
    v_and_b32 v132, v44, v132
    v_and_b32 v133, v44, v133
    v_and_b32 v134, v44, v134
    s_add_u32 s48, s54, 512
    buffer_load_dwordx4 v[196:199], v2, s[8:11], s48 offen offset:640
    v_and_b32 v135, v44, v135
    v_fmac_f32 v28, s76, v32
    v_fmac_f32 v29, s76, v33
    v_fmac_f32 v30, s76, v34
    v_fmac_f32 v31, s76, v35
    v_fmac_f32 v128, s76, v132
    v_fmac_f32 v129, s76, v133
    v_fmac_f32 v130, s76, v134
    v_fmac_f32 v131, s76, v135
    v_cvt_pk_bf16_f32 v128, v28, v128
    v_cvt_pk_bf16_f32 v129, v29, v129
    v_cvt_pk_bf16_f32 v130, v30, v130
    v_cvt_pk_bf16_f32 v131, v31, v131
    ds_write_b128 v8, v[128:131] offset:5120
    s_add_u32 s48, s54, 655872
    buffer_load_dwordx4 v[200:203], v2, s[8:11], s48 offen offset:0
    v_lshlrev_b32 v36, 16, v136
    v_lshlrev_b32 v40, 16, v140
    v_lshlrev_b32 v37, 16, v137
    v_lshlrev_b32 v41, 16, v141
    v_lshlrev_b32 v38, 16, v138
    v_lshlrev_b32 v42, 16, v142
    v_lshlrev_b32 v39, 16, v139
    v_lshlrev_b32 v43, 16, v143
    v_and_b32 v136, v44, v136
    v_and_b32 v137, v44, v137
    v_and_b32 v138, v44, v138
    v_and_b32 v139, v44, v139
    v_and_b32 v140, v44, v140
    v_and_b32 v141, v44, v141
    v_and_b32 v142, v44, v142
    s_add_u32 s48, s54, 655872
    buffer_load_dwordx4 v[204:207], v2, s[8:11], s48 offen offset:640
    v_and_b32 v143, v44, v143
    v_fmac_f32 v36, s76, v40
    v_fmac_f32 v37, s76, v41
    v_fmac_f32 v38, s76, v42
    v_fmac_f32 v39, s76, v43
    v_fmac_f32 v136, s76, v140
    v_fmac_f32 v137, s76, v141
    v_fmac_f32 v138, s76, v142
    v_fmac_f32 v139, s76, v143
    v_cvt_pk_bf16_f32 v136, v36, v136
    v_cvt_pk_bf16_f32 v137, v37, v137
    v_cvt_pk_bf16_f32 v138, v38, v138
    v_cvt_pk_bf16_f32 v139, v39, v139
    ds_write_b128 v9, v[136:139] offset:6144
    s_add_u32 s48, s54, 1311232
    buffer_load_dwordx4 v[208:211], v2, s[8:11], s48 offen offset:0
    v_lshlrev_b32 v28, 16, v144
    v_lshlrev_b32 v32, 16, v148
    v_lshlrev_b32 v29, 16, v145
    v_lshlrev_b32 v33, 16, v149
    v_lshlrev_b32 v30, 16, v146
    v_lshlrev_b32 v34, 16, v150
    v_lshlrev_b32 v31, 16, v147
    v_lshlrev_b32 v35, 16, v151
    v_and_b32 v144, v44, v144
    v_and_b32 v145, v44, v145
    v_and_b32 v146, v44, v146
    v_and_b32 v147, v44, v147
    v_and_b32 v148, v44, v148
    v_and_b32 v149, v44, v149
    v_and_b32 v150, v44, v150
    s_add_u32 s48, s54, 1311232
    buffer_load_dwordx4 v[212:215], v2, s[8:11], s48 offen offset:640
    v_and_b32 v151, v44, v151
    v_fmac_f32 v28, s76, v32
    v_fmac_f32 v29, s76, v33
    v_fmac_f32 v30, s76, v34
    v_fmac_f32 v31, s76, v35
    v_fmac_f32 v144, s76, v148
    v_fmac_f32 v145, s76, v149
    v_fmac_f32 v146, s76, v150
    v_fmac_f32 v147, s76, v151
    v_cvt_pk_bf16_f32 v144, v28, v144
    v_cvt_pk_bf16_f32 v145, v29, v145
    v_cvt_pk_bf16_f32 v146, v30, v146
    v_cvt_pk_bf16_f32 v147, v31, v147
    ds_write_b128 v8, v[144:147] offset:7168
    s_mov_b32 s48, 0x1000
    buffer_load_dword v46, v15, s[20:23], s48 offen sc1
    s_waitcnt lgkmcnt(0)
    s_barrier
    s_waitcnt vmcnt(7)
    s_lshl_b32 s48, s47, 11
    s_add_u32 m0, s48, 149632
    s_add_u32 s48, s48, 409600
    buffer_load_dwordx4 v4, s[24:27], s48 offen lds
    v_lshlrev_b32 v28, 16, v160
    v_lshlrev_b32 v32, 16, v164
    v_lshlrev_b32 v29, 16, v161
    v_lshlrev_b32 v33, 16, v165
    v_lshlrev_b32 v30, 16, v162
    v_lshlrev_b32 v34, 16, v166
    v_lshlrev_b32 v31, 16, v163
    v_lshlrev_b32 v35, 16, v167
    v_and_b32 v160, v44, v160
    v_and_b32 v161, v44, v161
    v_and_b32 v162, v44, v162
    v_and_b32 v163, v44, v163
    v_and_b32 v164, v44, v164
    v_and_b32 v165, v44, v165
    v_and_b32 v166, v44, v166
    v_and_b32 v167, v44, v167
    v_fmac_f32 v28, s76, v32
    v_fmac_f32 v29, s76, v33
    v_fmac_f32 v30, s76, v34
    v_fmac_f32 v31, s76, v35
    v_fmac_f32 v160, s76, v164
    v_fmac_f32 v161, s76, v165
    v_fmac_f32 v162, s76, v166
    v_fmac_f32 v163, s76, v167
    v_cvt_pk_bf16_f32 v160, v28, v160
    v_cvt_pk_bf16_f32 v161, v29, v161
    v_cvt_pk_bf16_f32 v162, v30, v162
    v_cvt_pk_bf16_f32 v163, v31, v163
    ds_write_b128 v8, v[160:163] offset:0
    v_lshlrev_b32 v36, 16, v168
    v_lshlrev_b32 v40, 16, v172
    v_lshlrev_b32 v37, 16, v169
    v_lshlrev_b32 v41, 16, v173
    v_lshlrev_b32 v38, 16, v170
    v_lshlrev_b32 v42, 16, v174
    v_lshlrev_b32 v39, 16, v171
    v_lshlrev_b32 v43, 16, v175
    v_and_b32 v168, v44, v168
    v_and_b32 v169, v44, v169
    v_and_b32 v170, v44, v170
    v_and_b32 v171, v44, v171
    v_and_b32 v172, v44, v172
    v_and_b32 v173, v44, v173
    v_and_b32 v174, v44, v174
    s_lshl_b32 s48, s47, 11
    s_add_u32 m0, s48, 150656
    s_add_u32 s48, s48, 410624
    buffer_load_dwordx4 v4, s[24:27], s48 offen lds
    v_and_b32 v175, v44, v175
    v_fmac_f32 v36, s76, v40
    v_fmac_f32 v37, s76, v41
    v_fmac_f32 v38, s76, v42
    v_fmac_f32 v39, s76, v43
    v_fmac_f32 v168, s76, v172
    v_fmac_f32 v169, s76, v173
    v_fmac_f32 v170, s76, v174
    v_fmac_f32 v171, s76, v175
    v_cvt_pk_bf16_f32 v168, v36, v168
    v_cvt_pk_bf16_f32 v169, v37, v169
    v_cvt_pk_bf16_f32 v170, v38, v170
    v_cvt_pk_bf16_f32 v171, v39, v171
    ds_write_b128 v9, v[168:171] offset:1024
    v_lshlrev_b32 v28, 16, v176
    v_lshlrev_b32 v32, 16, v180
    v_lshlrev_b32 v29, 16, v177
    v_lshlrev_b32 v33, 16, v181
    v_lshlrev_b32 v30, 16, v178
    v_lshlrev_b32 v34, 16, v182
    v_lshlrev_b32 v31, 16, v179
    v_lshlrev_b32 v35, 16, v183
    v_and_b32 v176, v44, v176
    v_and_b32 v177, v44, v177
    v_and_b32 v178, v44, v178
    v_and_b32 v179, v44, v179
    v_and_b32 v180, v44, v180
    v_and_b32 v181, v44, v181
    v_and_b32 v182, v44, v182
    v_and_b32 v183, v44, v183
    v_fmac_f32 v28, s76, v32
    v_fmac_f32 v29, s76, v33
    v_fmac_f32 v30, s76, v34
    v_fmac_f32 v31, s76, v35
    v_fmac_f32 v176, s76, v180
    v_fmac_f32 v177, s76, v181
    v_fmac_f32 v178, s76, v182
    v_fmac_f32 v179, s76, v183
    v_cvt_pk_bf16_f32 v176, v28, v176
    v_cvt_pk_bf16_f32 v177, v29, v177
    v_cvt_pk_bf16_f32 v178, v30, v178
    v_cvt_pk_bf16_f32 v179, v31, v179
    ds_write_b128 v8, v[176:179] offset:2048
    s_waitcnt vmcnt(2)
    v_cmp_ne_u32 vcc, s62, v46
    s_cbranch_vccnz L_rare_68
L_back_69:
    s_lshl_b32 s48, s45, 10
    s_add_u32 s48, s48, 0x28000
    buffer_load_dword v26, v24, s[20:23], s48 offen sc1
    s_waitcnt lgkmcnt(0)
    s_barrier
    s_and_b32 s3, s2, 7
    s_lshl_b32 s60, s3, 2
    s_bfe_u32 s3, s2, 0x20004
    s_add_u32 s60, s60, s3
    s_bfe_u32 s3, s2, 0x10003
    v_mul_u32_u24 v12, 3121, v0
    v_lshrrev_b32 v12, 16, v12
    v_mul_u32_u24 v12, 20208, v12
    v_lshl_add_u32 v12, v0, 4, v12
    s_mul_i32 s51, s60, 642
    s_mul_i32 s48, s3, 320
    s_add_u32 s51, s51, s48
    s_and_b32 s49, s51, 15
    s_sub_u32 s51, s51, s49
    s_and_b32 s48, s47, 1
    s_mul_i32 s50, s48, 11088
    s_mul_i32 s48, s48, 677952
    s_add_u32 s51, s51, s48
    s_cmp_ge_u32 s47, 2
    s_cselect_b32 s28, s32, s28
    s_cselect_b32 s29, s33, s29
    s_cselect_b32 s48, 22272, 0
    s_add_u32 s50, s50, s48
    s_add_u32 m0, s50, 0
    s_add_u32 s48, s51, 0
    buffer_load_dwordx4 v12, s[28:31], s48 offen lds
    v_lshlrev_b32 v28, 16, v192
    v_lshlrev_b32 v32, 16, v196
    v_lshlrev_b32 v29, 16, v193
    v_lshlrev_b32 v33, 16, v197
    v_lshlrev_b32 v30, 16, v194
    v_lshlrev_b32 v34, 16, v198
    v_lshlrev_b32 v31, 16, v195
    v_lshlrev_b32 v35, 16, v199
    s_add_u32 m0, s50, 1008
    s_add_u32 s48, s51, 61632
    buffer_load_dwordx4 v12, s[28:31], s48 offen lds
    v_and_b32 v192, v44, v192
    v_and_b32 v193, v44, v193
    v_and_b32 v194, v44, v194
    v_and_b32 v195, v44, v195
    v_and_b32 v196, v44, v196
    v_and_b32 v197, v44, v197
    v_and_b32 v198, v44, v198
    v_and_b32 v199, v44, v199
    s_add_u32 m0, s50, 2016
    s_add_u32 s48, s51, 123264
    buffer_load_dwordx4 v12, s[28:31], s48 offen lds
    v_fmac_f32 v28, s76, v32
    v_fmac_f32 v29, s76, v33
    v_fmac_f32 v30, s76, v34
    v_fmac_f32 v31, s76, v35
    v_fmac_f32 v192, s76, v196
    v_fmac_f32 v193, s76, v197
    v_fmac_f32 v194, s76, v198
    v_fmac_f32 v195, s76, v199
    s_add_u32 m0, s50, 3024
    s_add_u32 s48, s51, 184896
    buffer_load_dwordx4 v12, s[28:31], s48 offen lds
    v_cvt_pk_bf16_f32 v192, v28, v192
    v_cvt_pk_bf16_f32 v193, v29, v193
    v_cvt_pk_bf16_f32 v194, v30, v194
    v_cvt_pk_bf16_f32 v195, v31, v195
    ds_write_b128 v8, v[192:195] offset:5120
    v_lshlrev_b32 v36, 16, v200
    v_lshlrev_b32 v40, 16, v204
    v_lshlrev_b32 v37, 16, v201
    s_add_u32 m0, s50, 4032
    s_add_u32 s48, s51, 246528
    buffer_load_dwordx4 v12, s[28:31], s48 offen lds
    v_lshlrev_b32 v41, 16, v205
    v_lshlrev_b32 v38, 16, v202
    v_lshlrev_b32 v42, 16, v206
    v_lshlrev_b32 v39, 16, v203
    v_lshlrev_b32 v43, 16, v207
    v_and_b32 v200, v44, v200
    v_and_b32 v201, v44, v201
    v_and_b32 v202, v44, v202
    s_add_u32 m0, s50, 5040
    s_add_u32 s48, s51, 308160
    buffer_load_dwordx4 v12, s[28:31], s48 offen lds
    v_and_b32 v203, v44, v203
    v_and_b32 v204, v44, v204
    v_and_b32 v205, v44, v205
    v_and_b32 v206, v44, v206
    v_and_b32 v207, v44, v207
    v_fmac_f32 v36, s76, v40
    v_fmac_f32 v37, s76, v41
    v_fmac_f32 v38, s76, v42
    s_add_u32 m0, s50, 6048
    s_add_u32 s48, s51, 369792
    buffer_load_dwordx4 v12, s[28:31], s48 offen lds
    v_fmac_f32 v39, s76, v43
    v_fmac_f32 v200, s76, v204
    v_fmac_f32 v201, s76, v205
    v_fmac_f32 v202, s76, v206
    v_fmac_f32 v203, s76, v207
    v_cvt_pk_bf16_f32 v200, v36, v200
    v_cvt_pk_bf16_f32 v201, v37, v201
    v_cvt_pk_bf16_f32 v202, v38, v202
    s_add_u32 m0, s50, 7056
    s_add_u32 s48, s51, 431424
    buffer_load_dwordx4 v12, s[28:31], s48 offen lds
    v_cvt_pk_bf16_f32 v203, v39, v203
    ds_write_b128 v9, v[200:203] offset:6144
    v_lshlrev_b32 v28, 16, v208
    v_lshlrev_b32 v32, 16, v212
    v_lshlrev_b32 v29, 16, v209
    v_lshlrev_b32 v33, 16, v213
    v_lshlrev_b32 v30, 16, v210
    v_lshlrev_b32 v34, 16, v214
    s_add_u32 m0, s50, 8064
    s_add_u32 s48, s51, 493056
    buffer_load_dwordx4 v12, s[28:31], s48 offen lds
    v_lshlrev_b32 v31, 16, v211
    v_lshlrev_b32 v35, 16, v215
    v_and_b32 v208, v44, v208
    v_and_b32 v209, v44, v209
    v_and_b32 v210, v44, v210
    v_and_b32 v211, v44, v211
    v_and_b32 v212, v44, v212
    v_and_b32 v213, v44, v213
    s_add_u32 m0, s50, 9072
    s_add_u32 s48, s51, 554688
    buffer_load_dwordx4 v12, s[28:31], s48 offen lds
    v_and_b32 v214, v44, v214
    v_and_b32 v215, v44, v215
    v_fmac_f32 v28, s76, v32
    v_fmac_f32 v29, s76, v33
    v_fmac_f32 v30, s76, v34
    v_fmac_f32 v31, s76, v35
    v_fmac_f32 v208, s76, v212
    v_fmac_f32 v209, s76, v213
    s_add_u32 m0, s50, 10080
    s_add_u32 s48, s51, 616320
    buffer_load_dwordx4 v12, s[28:31], s48 offen lds
    v_fmac_f32 v210, s76, v214
    v_fmac_f32 v211, s76, v215
    v_cvt_pk_bf16_f32 v208, v28, v208
    v_cvt_pk_bf16_f32 v209, v29, v209
    v_cvt_pk_bf16_f32 v210, v30, v210
    v_cvt_pk_bf16_f32 v211, v31, v211
    ds_write_b128 v8, v[208:211] offset:7168
    s_waitcnt vmcnt(11)
    v_add_u32 v24, 147456, v24
    s_mov_b32 exec_hi, 0
    v_mul_f32 v26, 0x35cccccd, v26
    s_mov_b32 exec_hi, -1
    ds_write_b32 v24, v26
    s_waitcnt lgkmcnt(0)
    s_barrier
    s_mov_b32 s48, 0x50000
    buffer_load_dword v41, v10, s[20:23], s48 offen sc1
    s_and_b32 s3, s2, 7
    s_lshr_b32 s48, s2, 3
    s_lshr_b32 s64, s3, 1
    s_lshl_b32 s64, s64, 3
    s_and_b32 s49, s48, 7
    s_add_u32 s64, s64, s49
    s_and_b32 s3, s3, 1
    s_lshl_b32 s3, s3, 2
    s_lshr_b32 s48, s48, 3
    s_add_u32 s65, s3, s48
    s_mul_i32 s70, s47, 16384
    s_lshl_b32 s68, s64, 7
    s_lshl_b32 s48, s47, 12
    s_add_u32 s68, s68, s48
    s_add_u32 s68, s68, 0x910000
    s_mul_i32 s69, s65, 21
    s_add_u32 s69, s69, s47
    s_mul_i32 s69, s69, 3072
    s_add_u32 s69, s69, 409600
    s_lshl_b32 s78, s64, 1
    s_lshr_b32 s73, s65, 1
    s_and_b32 s48, s65, 1
    s_mul_i32 s48, s48, 20
    s_add_u32 s73, s73, s48
    s_add_u32 s73, s73, 16
    s_lshl_b32 s73, s73, 5
    s_lshl_b32 s48, s47, 10
    s_add_u32 s48, s48, 0xbc0000
    s_mul_i32 s6, s65, 98304
    s_add_u32 s6, s6, s48
    s_mul_i32 s75, s73, 1536
    s_add_u32 s75, s75, s48
    v_lshlrev_b32 v5, 4, v0
    v_and_b32 v56, 15, v0
    v_lshlrev_b32 v56, 6, v56
    v_add_u32 v56, s78, v56
    v_cvt_f32_u32 v56, v56
    v_mul_f32 v56, 0x3a000000, v56
    v_lshrrev_b32 v57, 5, v0
    v_lshlrev_b32 v57, 3, v57
    v_cvt_f32_u32 v57, v57
    v_bfe_u32 v58, v0, 4, 1
    v_cvt_f32_u32 v58, v58
    v_mul_f32 v58, 0x3e800000, v58
    v_fma_f32 v59, v57, v56, v58
    v_mov_b32 v60, v59
    v_cos_f32 v61, v60
    v_add_f32 v60, v60, v56
    v_cos_f32 v62, v60
    v_add_f32 v60, v60, v56
    v_cvt_pk_bf16_f32 v160, v61, v62
    v_xor_b32 v168, 0x80000000, v160
    v_cos_f32 v61, v60
    v_add_f32 v60, v60, v56
    v_cos_f32 v62, v60
    v_add_f32 v60, v60, v56
    v_cvt_pk_bf16_f32 v161, v61, v62
    v_xor_b32 v169, 0x80000000, v161
    v_cos_f32 v61, v60
    v_add_f32 v60, v60, v56
    v_cos_f32 v62, v60
    v_add_f32 v60, v60, v56
    v_cvt_pk_bf16_f32 v162, v61, v62
    v_xor_b32 v170, 0x80000000, v162
    v_cos_f32 v61, v60
    v_add_f32 v60, v60, v56
    v_cos_f32 v62, v60
    v_add_f32 v60, v60, v56
    v_cvt_pk_bf16_f32 v163, v61, v62
    v_xor_b32 v171, 0x80000000, v163
    v_add_f32 v60, 0xbe800000, v59
    v_cos_f32 v61, v60
    v_add_f32 v60, v60, v56
    v_cos_f32 v62, v60
    v_add_f32 v60, v60, v56
    v_cvt_pk_bf16_f32 v176, v61, v62
    v_xor_b32 v184, 0x80000000, v176
    v_cos_f32 v61, v60
    v_add_f32 v60, v60, v56
    v_cos_f32 v62, v60
    v_add_f32 v60, v60, v56
    v_cvt_pk_bf16_f32 v177, v61, v62
    v_xor_b32 v185, 0x80000000, v177
    v_cos_f32 v61, v60
    v_add_f32 v60, v60, v56
    v_cos_f32 v62, v60
    v_add_f32 v60, v60, v56
    v_cvt_pk_bf16_f32 v178, v61, v62
    v_xor_b32 v186, 0x80000000, v178
    v_cos_f32 v61, v60
    v_add_f32 v60, v60, v56
    v_cos_f32 v62, v60
    v_add_f32 v60, v60, v56
    v_cvt_pk_bf16_f32 v179, v61, v62
    v_xor_b32 v187, 0x80000000, v179
    v_add_f32 v59, 0x41800000, v57
    v_fma_f32 v59, v59, v56, v58
    v_mov_b32 v60, v59
    v_cos_f32 v61, v60
    v_add_f32 v60, v60, v56
    v_cos_f32 v62, v60
    v_add_f32 v60, v60, v56
    v_cvt_pk_bf16_f32 v164, v61, v62
    v_xor_b32 v172, 0x80000000, v164
    v_cos_f32 v61, v60
    v_add_f32 v60, v60, v56
    v_cos_f32 v62, v60
    v_add_f32 v60, v60, v56
    v_cvt_pk_bf16_f32 v165, v61, v62
    v_xor_b32 v173, 0x80000000, v165
    v_cos_f32 v61, v60
    v_add_f32 v60, v60, v56
    v_cos_f32 v62, v60
    v_add_f32 v60, v60, v56
    v_cvt_pk_bf16_f32 v166, v61, v62
    v_xor_b32 v174, 0x80000000, v166
    v_cos_f32 v61, v60
    v_add_f32 v60, v60, v56
    v_cos_f32 v62, v60
    v_add_f32 v60, v60, v56
    v_cvt_pk_bf16_f32 v167, v61, v62
    v_xor_b32 v175, 0x80000000, v167
    v_add_f32 v60, 0xbe800000, v59
    v_cos_f32 v61, v60
    v_add_f32 v60, v60, v56
    v_cos_f32 v62, v60
    v_add_f32 v60, v60, v56
    v_cvt_pk_bf16_f32 v180, v61, v62
    v_xor_b32 v188, 0x80000000, v180
    v_cos_f32 v61, v60
    v_add_f32 v60, v60, v56
    v_cos_f32 v62, v60
    v_add_f32 v60, v60, v56
    v_cvt_pk_bf16_f32 v181, v61, v62
    v_xor_b32 v189, 0x80000000, v181
    v_cos_f32 v61, v60
    v_add_f32 v60, v60, v56
    v_cos_f32 v62, v60
    v_add_f32 v60, v60, v56
    v_cvt_pk_bf16_f32 v182, v61, v62
    v_xor_b32 v190, 0x80000000, v182
    v_cos_f32 v61, v60
    v_add_f32 v60, v60, v56
    v_cos_f32 v62, v60
    v_add_f32 v60, v60, v56
    v_cvt_pk_bf16_f32 v183, v61, v62
    v_xor_b32 v191, 0x80000000, v183
    v_add_f32 v56, 0x3a000000, v56
    v_fma_f32 v59, v57, v56, v58
    v_mov_b32 v60, v59
    v_cos_f32 v61, v60
    v_add_f32 v60, v60, v56
    v_cos_f32 v62, v60
    v_add_f32 v60, v60, v56
    v_cvt_pk_bf16_f32 v224, v61, v62
    v_xor_b32 v232, 0x80000000, v224
    v_cos_f32 v61, v60
    v_add_f32 v60, v60, v56
    v_cos_f32 v62, v60
    v_add_f32 v60, v60, v56
    v_cvt_pk_bf16_f32 v225, v61, v62
    v_xor_b32 v233, 0x80000000, v225
    v_cos_f32 v61, v60
    v_add_f32 v60, v60, v56
    v_cos_f32 v62, v60
    v_add_f32 v60, v60, v56
    v_cvt_pk_bf16_f32 v226, v61, v62
    v_xor_b32 v234, 0x80000000, v226
    v_cos_f32 v61, v60
    v_add_f32 v60, v60, v56
    v_cos_f32 v62, v60
    v_add_f32 v60, v60, v56
    v_cvt_pk_bf16_f32 v227, v61, v62
    v_xor_b32 v235, 0x80000000, v227
    v_add_f32 v60, 0xbe800000, v59
    v_cos_f32 v61, v60
    v_add_f32 v60, v60, v56
    v_cos_f32 v62, v60
    v_add_f32 v60, v60, v56
    v_cvt_pk_bf16_f32 v240, v61, v62
    v_xor_b32 v248, 0x80000000, v240
    v_cos_f32 v61, v60
    v_add_f32 v60, v60, v56
    v_cos_f32 v62, v60
    v_add_f32 v60, v60, v56
    v_cvt_pk_bf16_f32 v241, v61, v62
    v_xor_b32 v249, 0x80000000, v241
    v_cos_f32 v61, v60
    v_add_f32 v60, v60, v56
    v_cos_f32 v62, v60
    v_add_f32 v60, v60, v56
    v_cvt_pk_bf16_f32 v242, v61, v62
    v_xor_b32 v250, 0x80000000, v242
    v_cos_f32 v61, v60
    v_add_f32 v60, v60, v56
    v_cos_f32 v62, v60
    v_add_f32 v60, v60, v56
    v_cvt_pk_bf16_f32 v243, v61, v62
    v_xor_b32 v251, 0x80000000, v243
    v_add_f32 v59, 0x41800000, v57
    v_fma_f32 v59, v59, v56, v58
    v_mov_b32 v60, v59
    v_cos_f32 v61, v60
    v_add_f32 v60, v60, v56
    v_cos_f32 v62, v60
    v_add_f32 v60, v60, v56
    v_cvt_pk_bf16_f32 v228, v61, v62
    v_xor_b32 v236, 0x80000000, v228
    v_cos_f32 v61, v60
    v_add_f32 v60, v60, v56
    v_cos_f32 v62, v60
    v_add_f32 v60, v60, v56
    v_cvt_pk_bf16_f32 v229, v61, v62
    v_xor_b32 v237, 0x80000000, v229
    v_cos_f32 v61, v60
    v_add_f32 v60, v60, v56
    v_cos_f32 v62, v60
    v_add_f32 v60, v60, v56
    v_cvt_pk_bf16_f32 v230, v61, v62
    v_xor_b32 v238, 0x80000000, v230
    v_cos_f32 v61, v60
    v_add_f32 v60, v60, v56
    v_cos_f32 v62, v60
    v_add_f32 v60, v60, v56
    v_cvt_pk_bf16_f32 v231, v61, v62
    v_xor_b32 v239, 0x80000000, v231
    v_add_f32 v60, 0xbe800000, v59
    v_cos_f32 v61, v60
    v_add_f32 v60, v60, v56
    v_cos_f32 v62, v60
    v_add_f32 v60, v60, v56
    v_cvt_pk_bf16_f32 v244, v61, v62
    v_xor_b32 v252, 0x80000000, v244
    v_cos_f32 v61, v60
    v_add_f32 v60, v60, v56
    v_cos_f32 v62, v60
    v_add_f32 v60, v60, v56
    v_cvt_pk_bf16_f32 v245, v61, v62
    v_xor_b32 v253, 0x80000000, v245
    v_cos_f32 v61, v60
    v_add_f32 v60, v60, v56
    v_cos_f32 v62, v60
    v_add_f32 v60, v60, v56
    v_cvt_pk_bf16_f32 v246, v61, v62
    v_xor_b32 v254, 0x80000000, v246
    v_cos_f32 v61, v60
    v_add_f32 v60, v60, v56
    v_cos_f32 v62, v60
    v_add_f32 v60, v60, v56
    v_cvt_pk_bf16_f32 v247, v61, v62
    v_xor_b32 v255, 0x80000000, v247
    s_lshr_b32 s83, s47, 1
    s_lshl_b32 s83, s83, 5
    s_and_b32 s67, s47, 1
    s_add_u32 s83, s83, s67
    v_lshrrev_b32 v146, 4, v0
    v_lshl_add_u32 v147, v146, 3, s83
    v_cmp_eq_u32 vcc, 0, v147
    v_cvt_f32_u32 v147, v147
    v_cndmask_b32 v145, 1.0, 0.5, vcc
    s_lshr_b32 s83, s65, 1
    s_and_b32 s67, s65, 1
    s_mul_i32 s67, s67, 20
    s_add_u32 s83, s83, s67
    s_add_u32 s83, s83, 16
    s_lshl_b32 s83, s83, 4
    s_lshl_b32 s67, s65, 5
    v_and_b32 v146, 15, v0
    v_add_u32 v148, s67, v146
    v_cvt_f32_u32 v148, v148
    v_mul_f32 v149, v147, v148
    v_mul_f32 v149, 0x3acccccd, v149
    v_fract_f32 v136, v149
    v_mul_f32 v149, 0x3dcccccd, v148
    v_fract_f32 v139, v149
    v_mul_f32 v142, 0x3b4ccccd, v148
    v_add_u32 v148, s67, v146
    v_add_u32 v148, 16, v148
    v_cvt_f32_u32 v148, v148
    v_mul_f32 v149, v147, v148
    v_mul_f32 v149, 0x3acccccd, v149
    v_fract_f32 v137, v149
    v_mul_f32 v149, 0x3dcccccd, v148
    v_fract_f32 v140, v149
    v_mul_f32 v143, 0x3b4ccccd, v148
    v_add_u32 v148, s83, v146
    v_cvt_f32_u32 v148, v148
    v_mul_f32 v149, v147, v148
    v_mul_f32 v149, 0x3acccccd, v149
    v_fract_f32 v138, v149
    v_mul_f32 v149, 0x3dcccccd, v148
    v_fract_f32 v141, v149
    v_mul_f32 v144, 0x3b4ccccd, v148
    v_fma_f32 v146, 2.0, v141, v138
    v_cos_f32 v148, v146
    v_sin_f32_e64 v152, -v146
    v_add_f32 v146, v146, v144
    v_cos_f32 v149, v146
    v_sin_f32_e64 v153, -v146
    v_add_f32 v146, v146, v144
    v_cos_f32 v150, v146
    v_sin_f32_e64 v154, -v146
    v_add_f32 v146, v146, v144
    v_cos_f32 v151, v146
    v_sin_f32_e64 v155, -v146
    v_cvt_pk_bf16_f32 v96, v148, v149
    v_cvt_pk_bf16_f32 v97, v150, v151
    v_cvt_pk_bf16_f32 v98, v152, v153
    v_cvt_pk_bf16_f32 v99, v154, v155
    v_fma_f32 v146, 4.0, v139, v136
    v_sub_f32 v146, v146, v139
    v_cos_f32 v148, v146
    v_sin_f32_e64 v152, -v146
    v_add_f32 v146, v146, v142
    v_cos_f32 v149, v146
    v_sin_f32_e64 v153, -v146
    v_add_f32 v146, v146, v142
    v_cos_f32 v150, v146
    v_sin_f32_e64 v154, -v146
    v_add_f32 v146, v146, v142
    v_cos_f32 v151, v146
    v_sin_f32_e64 v155, -v146
    v_cvt_pk_bf16_f32 v100, v148, v149
    v_cvt_pk_bf16_f32 v101, v150, v151
    v_cvt_pk_bf16_f32 v102, v152, v153
    v_cvt_pk_bf16_f32 v103, v154, v155
    v_fma_f32 v146, 4.0, v140, v137
    v_sub_f32 v146, v146, v140
    v_cos_f32 v148, v146
    v_sin_f32_e64 v152, -v146
    v_add_f32 v146, v146, v143
    v_cos_f32 v149, v146
    v_sin_f32_e64 v153, -v146
    v_add_f32 v146, v146, v143
    v_cos_f32 v150, v146
    v_sin_f32_e64 v154, -v146
    v_add_f32 v146, v146, v143
    v_cos_f32 v151, v146
    v_sin_f32_e64 v155, -v146
    v_cvt_pk_bf16_f32 v104, v148, v149
    v_cvt_pk_bf16_f32 v105, v150, v151
    v_cvt_pk_bf16_f32 v106, v152, v153
    v_cvt_pk_bf16_f32 v107, v154, v155
    v_fma_f32 v146, 4.0, v141, v138
    v_sub_f32 v146, v146, v141
    v_cos_f32 v148, v146
    v_sin_f32_e64 v152, -v146
    v_add_f32 v146, v146, v144
    v_cos_f32 v149, v146
    v_sin_f32_e64 v153, -v146
    v_add_f32 v146, v146, v144
    v_cos_f32 v150, v146
    v_sin_f32_e64 v154, -v146
    v_add_f32 v146, v146, v144
    v_cos_f32 v151, v146
    v_sin_f32_e64 v155, -v146
    v_cvt_pk_bf16_f32 v108, v148, v149
    v_cvt_pk_bf16_f32 v109, v150, v151
    v_cvt_pk_bf16_f32 v110, v152, v153
    v_cvt_pk_bf16_f32 v111, v154, v155
    v_fma_f32 v146, 4.0, v139, v136
    v_cos_f32 v148, v146
    v_sin_f32_e64 v152, -v146
    v_add_f32 v146, v146, v142
    v_cos_f32 v149, v146
    v_sin_f32_e64 v153, -v146
    v_add_f32 v146, v146, v142
    v_cos_f32 v150, v146
    v_sin_f32_e64 v154, -v146
    v_add_f32 v146, v146, v142
    v_cos_f32 v151, v146
    v_sin_f32_e64 v155, -v146
    v_cvt_pk_bf16_f32 v112, v148, v149
    v_cvt_pk_bf16_f32 v113, v150, v151
    v_cvt_pk_bf16_f32 v114, v152, v153
    v_cvt_pk_bf16_f32 v115, v154, v155
    v_fma_f32 v146, 4.0, v140, v137
    v_cos_f32 v148, v146
    v_sin_f32_e64 v152, -v146
    v_add_f32 v146, v146, v143
    v_cos_f32 v149, v146
    v_sin_f32_e64 v153, -v146
    v_add_f32 v146, v146, v143
    v_cos_f32 v150, v146
    v_sin_f32_e64 v154, -v146
    v_add_f32 v146, v146, v143
    v_cos_f32 v151, v146
    v_sin_f32_e64 v155, -v146
    v_cvt_pk_bf16_f32 v116, v148, v149
    v_cvt_pk_bf16_f32 v117, v150, v151
    v_cvt_pk_bf16_f32 v118, v152, v153
    v_cvt_pk_bf16_f32 v119, v154, v155
    v_fma_f32 v146, 4.0, v141, v138
    v_cos_f32 v148, v146
    v_sin_f32_e64 v152, -v146
    v_add_f32 v146, v146, v144
    v_cos_f32 v149, v146
    v_sin_f32_e64 v153, -v146
    v_add_f32 v146, v146, v144
    v_cos_f32 v150, v146
    v_sin_f32_e64 v154, -v146
    v_add_f32 v146, v146, v144
    v_cos_f32 v151, v146
    v_sin_f32_e64 v155, -v146
    v_cvt_pk_bf16_f32 v120, v148, v149
    v_cvt_pk_bf16_f32 v121, v150, v151
    v_cvt_pk_bf16_f32 v122, v152, v153
    v_cvt_pk_bf16_f32 v123, v154, v155
    v_and_b32 v146, 1, v0
    v_lshlrev_b32 v146, 15, v146
    v_or_b32 v146, 0x3f00, v146
    v_cmp_gt_u32 vcc, 16, v0
    v_cndmask_b32 v124, 0, v146, vcc
    v_mov_b32 v125, 0
    v_mov_b32 v126, 0
    v_mov_b32 v127, 0
    s_branch L_dft_l
L_dftc:
    s_getpc_b64 s[4:5]
    s_add_u32 s4, s4, dft_tables@rel32@lo+4
    s_addc_u32 s5, s5, dft_tables@rel32@hi+12
    s_mov_b32 s24, s4
    s_and_b32 s25, s5, 0xffff
    s_mov_b32 s26, 0x66000
    s_mov_b32 s27, 0x00020000
    v_lshlrev_b32 v13, 4, v0
    s_mul_i32 s55, s46, 102400
    s_mul_i32 s56, s44, 5120
    s_add_u32 s55, s55, s56
    s_lshl_b32 s57, s56, 2
    v_lshrrev_b32 v3, 3, v0
    v_mul_u32_u24 v4, 81920, v3
    v_and_b32 v1, 7, v0
    v_lshl_add_u32 v14, v1, 4, v4
    v_lshrrev_b32 v4, 4, v0
    v_xor_b32 v1, v1, v4
    v_lshlrev_b32 v3, 7, v3
    v_lshl_add_u32 v3, v1, 4, v3
    s_mul_i32 s48, s47, 20480
    s_add_u32 s48, s48, 75776
    v_add_u32 v1, s48, v3
    v_xor_b32 v2, 64, v1
    s_lshl_b32 s54, s45, 2
    s_add_u32 s54, s54, s47
    s_mul_i32 s54, s54, 1280
    s_waitcnt lgkmcnt(0)
    s_mov_b32 s8, s64
    s_and_b32 s9, s65, 0xffff
    s_mov_b32 s10, 0x280000
    s_mov_b32 s11, 0x00020000
    s_add_u32 s48, s54, 1966080
    buffer_load_dwordx4 v[224:227], v14, s[8:11], s48 offen offset:0
    s_add_u32 s48, s54, 1966080
    buffer_load_dwordx4 v[228:231], v14, s[8:11], s48 offen offset:640
    s_add_u32 m0, s56, 0
    s_add_u32 s48, s55, 0
    buffer_load_dwordx4 v13, s[24:27], s48 offen lds
    s_add_u32 m0, s56, 1024
    s_add_u32 s48, s55, 1024
    buffer_load_dwordx4 v13, s[24:27], s48 offen lds
    s_add_u32 m0, s56, 2048
    s_add_u32 s48, s55, 2048
    buffer_load_dwordx4 v13, s[24:27], s48 offen lds
    s_add_u32 m0, s56, 3072
    s_add_u32 s48, s55, 3072
    buffer_load_dwordx4 v13, s[24:27], s48 offen lds
    s_add_u32 m0, s56, 4096
    s_add_u32 s48, s55, 4096
    buffer_load_dwordx4 v13, s[24:27], s48 offen lds
    s_add_u32 s48, s54, 1966208
    buffer_load_dwordx4 v[240:243], v14, s[8:11], s48 offen offset:0
    s_add_u32 s48, s54, 1966208
    buffer_load_dwordx4 v[244:247], v14, s[8:11], s48 offen offset:640
    s_mul_i32 s48, s44, 20480
    s_add_u32 s48, s48, 80896
    v_and_b32 v5, 31, v0
    v_lshlrev_b32 v5, 7, v5
    v_add_u32 v5, s48, v5
    v_lshrrev_b32 v6, 5, v0
    v_bfe_u32 v7, v0, 1, 3
    v_xor_b32 v6, v6, v7
    v_lshl_add_u32 v8, v6, 4, v5
    v_xor_b32 v9, 32, v8
    v_xor_b32 v10, 64, v8
    v_xor_b32 v11, 96, v8
    v_mov_b32 v12, v13
    v_add_u32 v3, 126976, v13
    s_waitcnt lgkmcnt(0)
    s_load_dword s62, s[82:83], 0x0
    s_mov_b32 s20, s82
    s_and_b32 s21, s83, 0xffff
    s_mov_b32 s22, 0x10000000
    s_mov_b32 s23, 0x00020000
    s_mov_b32 s40, s78
    s_and_b32 s41, s79, 0xffff
    s_mov_b32 s42, 0x280000
    s_mov_b32 s43, 0x00020000
    s_and_b32 s3, s2, 7
    s_lshr_b32 s48, s2, 3
    s_lshr_b32 s64, s3, 1
    s_lshl_b32 s64, s64, 3
    s_and_b32 s49, s48, 7
    s_add_u32 s64, s64, s49
    s_and_b32 s3, s3, 1
    s_lshl_b32 s3, s3, 2
    s_lshr_b32 s48, s48, 3
    s_add_u32 s65, s3, s48
    s_lshr_b32 s73, s65, 1
    s_and_b32 s48, s65, 1
    s_mul_i32 s48, s48, 20
    s_add_u32 s73, s73, s48
    s_add_u32 s73, s73, 16
    s_lshl_b32 s73, s73, 5
    s_lshl_b32 s48, s44, 10
    s_add_u32 s48, s48, 0xbc0000
    s_mul_i32 s6, s65, 98304
    s_add_u32 s6, s6, s48
    s_mul_i32 s75, s73, 1536
    s_add_u32 s75, s75, s48
    s_lshl_b32 s72, s65, 6
    s_mul_i32 s66, s64, 196608
    s_lshl_b32 s48, s44, 11
    s_add_u32 s66, s66, s48
    s_and_b32 s48, s44, 1
    s_lshl_b32 s48, s48, 10
    s_lshl_b32 s49, s64, 1
    s_add_u32 s48, s48, s49
    s_lshr_b32 s49, s44, 1
    s_add_u32 s48, s48, s49
    s_mul_i32 s48, s48, 1280
    s_add_u32 s72, s72, s48
    s_add_u32 s73, s73, s48
    s_cmp_ge_u32 s46, 2
    s_cselect_b32 s76, -1.0, 1.0
    v_mov_b32 v72, 0xffff0000
    s_lshl_b32 s78, s45, 2
    s_add_u32 s78, s78, s44
    v_and_b32 v5, 31, v0
    v_lshrrev_b32 v6, 5, v0
    v_lshlrev_b32 v6, 8, v6
    v_add_u32 v6, s78, v6
    v_mul_u32_u24 v6, v6, v5
    v_mul_u32_u24 v7, 0, v5
    v_add_u32 v7, v7, v6
    v_and_b32 v7, 0x7ff, v7
    v_cvt_f32_u32 v7, v7
    v_mul_f32 v7, 0x3a000000, v7
    v_cos_f32 v176, v7
    v_sin_f32 v192, v7
    v_mul_u32_u24 v7, 64, v5
    v_add_u32 v7, v7, v6
    v_and_b32 v7, 0x7ff, v7
    v_cvt_f32_u32 v7, v7
    v_mul_f32 v7, 0x3a000000, v7
    v_cos_f32 v177, v7
    v_sin_f32 v193, v7
    v_mul_u32_u24 v7, 128, v5
    v_add_u32 v7, v7, v6
    v_and_b32 v7, 0x7ff, v7
    v_cvt_f32_u32 v7, v7
    v_mul_f32 v7, 0x3a000000, v7
    v_cos_f32 v178, v7
    v_sin_f32 v194, v7
    v_mul_u32_u24 v7, 192, v5
    v_add_u32 v7, v7, v6
    v_and_b32 v7, 0x7ff, v7
    v_cvt_f32_u32 v7, v7
    v_mul_f32 v7, 0x3a000000, v7
    v_cos_f32 v179, v7
    v_sin_f32 v195, v7
    v_mul_u32_u24 v7, 512, v5
    v_add_u32 v7, v7, v6
    v_and_b32 v7, 0x7ff, v7
    v_cvt_f32_u32 v7, v7
    v_mul_f32 v7, 0x3a000000, v7
    v_cos_f32 v180, v7
    v_sin_f32 v196, v7
    v_mul_u32_u24 v7, 576, v5
    v_add_u32 v7, v7, v6
    v_and_b32 v7, 0x7ff, v7
    v_cvt_f32_u32 v7, v7
    v_mul_f32 v7, 0x3a000000, v7
    v_cos_f32 v181, v7
    v_sin_f32 v197, v7
    v_mul_u32_u24 v7, 640, v5
    v_add_u32 v7, v7, v6
    v_and_b32 v7, 0x7ff, v7
    v_cvt_f32_u32 v7, v7
    v_mul_f32 v7, 0x3a000000, v7
    v_cos_f32 v182, v7
    v_sin_f32 v198, v7
    v_mul_u32_u24 v7, 704, v5
    v_add_u32 v7, v7, v6
    v_and_b32 v7, 0x7ff, v7
    v_cvt_f32_u32 v7, v7
    v_mul_f32 v7, 0x3a000000, v7
    v_cos_f32 v183, v7
    v_sin_f32 v199, v7
    v_mul_u32_u24 v7, 1024, v5
    v_add_u32 v7, v7, v6
    v_and_b32 v7, 0x7ff, v7
    v_cvt_f32_u32 v7, v7
    s_add_u32 m0, s56, 20480
    s_add_u32 s48, s55, 20480
    buffer_load_dwordx4 v13, s[24:27], s48 offen lds
    v_mul_f32 v7, 0x3a000000, v7
    v_cos_f32 v184, v7
    v_sin_f32 v200, v7
    v_mul_u32_u24 v7, 1088, v5
    v_add_u32 v7, v7, v6
    v_and_b32 v7, 0x7ff, v7
    v_cvt_f32_u32 v7, v7
    v_mul_f32 v7, 0x3a000000, v7
    s_add_u32 m0, s56, 21504
    s_add_u32 s48, s55, 21504
    buffer_load_dwordx4 v13, s[24:27], s48 offen lds
    v_cos_f32 v185, v7
    v_sin_f32 v201, v7
    v_mul_u32_u24 v7, 1152, v5
    v_add_u32 v7, v7, v6
    v_and_b32 v7, 0x7ff, v7
    v_cvt_f32_u32 v7, v7
    v_mul_f32 v7, 0x3a000000, v7
    s_add_u32 m0, s56, 22528
    s_add_u32 s48, s55, 22528
    buffer_load_dwordx4 v13, s[24:27], s48 offen lds
    v_cos_f32 v186, v7
    v_sin_f32 v202, v7
    v_mul_u32_u24 v7, 1216, v5
    v_add_u32 v7, v7, v6
    v_and_b32 v7, 0x7ff, v7
    v_cvt_f32_u32 v7, v7
    v_mul_f32 v7, 0x3a000000, v7
    v_cos_f32 v187, v7
    s_add_u32 m0, s56, 23552
    s_add_u32 s48, s55, 23552
    buffer_load_dwordx4 v13, s[24:27], s48 offen lds
    v_sin_f32 v203, v7
    v_mul_u32_u24 v7, 1536, v5
    v_add_u32 v7, v7, v6
    v_and_b32 v7, 0x7ff, v7
    v_cvt_f32_u32 v7, v7
    v_mul_f32 v7, 0x3a000000, v7
    v_cos_f32 v188, v7
    s_add_u32 m0, s56, 24576
    s_add_u32 s48, s55, 24576
    buffer_load_dwordx4 v13, s[24:27], s48 offen lds
    v_sin_f32 v204, v7
    v_mul_u32_u24 v7, 1600, v5
    v_add_u32 v7, v7, v6
    v_and_b32 v7, 0x7ff, v7
    v_cvt_f32_u32 v7, v7
    v_mul_f32 v7, 0x3a000000, v7
    v_cos_f32 v189, v7
    v_sin_f32 v205, v7
    s_add_u32 s48, s54, 1966336
    buffer_load_dwordx4 v[160:163], v14, s[8:11], s48 offen offset:0
    v_mul_u32_u24 v7, 1664, v5
    v_add_u32 v7, v7, v6
    v_and_b32 v7, 0x7ff, v7
    v_cvt_f32_u32 v7, v7
    v_mul_f32 v7, 0x3a000000, v7
    v_cos_f32 v190, v7
    v_sin_f32 v206, v7
    s_add_u32 s48, s54, 1966336
    buffer_load_dwordx4 v[164:167], v14, s[8:11], s48 offen offset:640
    v_mul_u32_u24 v7, 1728, v5
    v_add_u32 v7, v7, v6
    v_and_b32 v7, 0x7ff, v7
    v_cvt_f32_u32 v7, v7
    v_mul_f32 v7, 0x3a000000, v7
    v_cos_f32 v191, v7
    v_sin_f32 v207, v7
    s_waitcnt vmcnt(14)
    s_add_u32 m0, s57, 65536
    s_add_u32 s48, s55, 40960
    buffer_load_dwordx4 v13, s[24:27], s48 offen lds
    v_lshlrev_b32 v64, 16, v224
    v_lshlrev_b32 v68, 16, v228
    v_lshlrev_b32 v65, 16, v225
    v_lshlrev_b32 v69, 16, v229
    v_lshlrev_b32 v66, 16, v226
    v_lshlrev_b32 v70, 16, v230
    s_add_u32 m0, s57, 66560
    s_add_u32 s48, s55, 41984
    buffer_load_dwordx4 v13, s[24:27], s48 offen lds
    v_lshlrev_b32 v67, 16, v227
    v_lshlrev_b32 v71, 16, v231
    v_and_b32 v224, v72, v224
    v_and_b32 v225, v72, v225
    v_and_b32 v226, v72, v226
    v_and_b32 v227, v72, v227
    s_add_u32 m0, s57, 67584
    s_add_u32 s48, s55, 43008
    buffer_load_dwordx4 v13, s[24:27], s48 offen lds
    v_and_b32 v228, v72, v228
    v_and_b32 v229, v72, v229
    v_and_b32 v230, v72, v230
    v_and_b32 v231, v72, v231
    v_fmac_f32 v64, s76, v68
    v_fmac_f32 v65, s76, v69
    s_add_u32 m0, s57, 68608
    s_add_u32 s48, s55, 44032
    buffer_load_dwordx4 v13, s[24:27], s48 offen lds
    v_fmac_f32 v66, s76, v70
    v_fmac_f32 v67, s76, v71
    v_fmac_f32 v224, s76, v228
    v_fmac_f32 v225, s76, v229
    v_fmac_f32 v226, s76, v230
    v_fmac_f32 v227, s76, v231
    s_add_u32 m0, s57, 69632
    s_add_u32 s48, s55, 45056
    buffer_load_dwordx4 v13, s[24:27], s48 offen lds
    v_cvt_pk_bf16_f32 v224, v64, v224
    v_cvt_pk_bf16_f32 v225, v65, v225
    v_cvt_pk_bf16_f32 v226, v66, v226
    v_cvt_pk_bf16_f32 v227, v67, v227
    ds_write_b128 v2, v[224:227] offset:8192
    s_mov_b32 s52, 49152
    s_mov_b32 s53, 49152
    s_mov_b32 s50, 0
    s_waitcnt lgkmcnt(0) vmcnt(14)
    s_mul_i32 s62, s62, 0x9E3779B1
    s_add_u32 s62, s62, 0x7F4A7C15
    s_barrier
    ds_read_b128 v[16:19], v8
    ds_read_b128 v[20:23], v12 offset:0
    ds_read_b128 v[24:27], v12 offset:1024
    ds_read_b128 v[28:31], v12 offset:2048
    ds_read_b128 v[32:35], v12 offset:3072
    ds_read_b128 v[36:39], v12 offset:4096
    s_waitcnt lgkmcnt(4)
    v_mfma_f32_32x32x16_bf16 v[80:95], v[16:19], v[20:23], 0
    s_waitcnt vmcnt(12)
    v_lshlrev_b32 v64, 16, v240
    v_lshlrev_b32 v68, 16, v244
    ds_read_b128 v[40:43], v9
    ds_read_b128 v[44:47], v12 offset:5120
    s_waitcnt lgkmcnt(5)
    v_mfma_f32_32x32x16_bf16 v[96:111], v[16:19], v[24:27], 0
    v_lshlrev_b32 v65, 16, v241
    v_lshlrev_b32 v69, 16, v245
    ds_read_b128 v[48:51], v12 offset:6144
    ds_read_b128 v[52:55], v12 offset:7168
    s_waitcnt lgkmcnt(6)
    v_mfma_f32_32x32x16_bf16 v[112:127], v[16:19], v[28:31], 0
    v_lshlrev_b32 v66, 16, v242
    s_add_u32 s48, s54, 1966464
    buffer_load_dwordx4 v[208:211], v14, s[8:11], s48 offen offset:0
    v_lshlrev_b32 v70, 16, v246
    ds_read_b128 v[56:59], v12 offset:8192
    ds_read_b128 v[60:63], v12 offset:9216
    s_waitcnt lgkmcnt(7)
    v_mfma_f32_32x32x16_bf16 v[128:143], v[16:19], v[32:35], 0
    v_lshlrev_b32 v67, 16, v243
    v_lshlrev_b32 v71, 16, v247
    s_waitcnt lgkmcnt(6)
    v_mfma_f32_32x32x16_bf16 v[144:159], v[16:19], v[36:39], 0
    v_and_b32 v240, v72, v240
    v_and_b32 v241, v72, v241
    s_add_u32 s48, s54, 1966464
    buffer_load_dwordx4 v[212:215], v14, s[8:11], s48 offen offset:640
    s_waitcnt lgkmcnt(4)
    v_mfma_f32_32x32x16_bf16 v[80:95], v[40:43], v[44:47], v[80:95]
    v_and_b32 v242, v72, v242
    v_and_b32 v243, v72, v243
    ds_read_b128 v[16:19], v10
    ds_read_b128 v[20:23], v12 offset:10240
    s_waitcnt lgkmcnt(5)
    v_mfma_f32_32x32x16_bf16 v[96:111], v[40:43], v[48:51], v[96:111]
    v_and_b32 v244, v72, v244
    v_and_b32 v245, v72, v245
    v_and_b32 v246, v72, v246
    ds_read_b128 v[24:27], v12 offset:11264
    ds_read_b128 v[28:31], v12 offset:12288
    s_waitcnt lgkmcnt(6)
    v_mfma_f32_32x32x16_bf16 v[112:127], v[40:43], v[52:55], v[112:127]
    s_add_u32 m0, s57, 70656
    s_add_u32 s48, s55, 61440
    buffer_load_dwordx4 v13, s[24:27], s48 offen lds
    v_and_b32 v247, v72, v247
    ds_read_b128 v[32:35], v12 offset:13312
    ds_read_b128 v[36:39], v12 offset:14336
    s_waitcnt lgkmcnt(7)
    v_mfma_f32_32x32x16_bf16 v[128:143], v[40:43], v[56:59], v[128:143]
    v_fmac_f32 v64, s76, v68
    v_fmac_f32 v65, s76, v69
    v_fmac_f32 v66, s76, v70
    s_waitcnt lgkmcnt(6)
    v_mfma_f32_32x32x16_bf16 v[144:159], v[40:43], v[60:63], v[144:159]
    v_fmac_f32 v67, s76, v71
    s_add_u32 m0, s57, 71680
    s_add_u32 s48, s55, 62464
    buffer_load_dwordx4 v13, s[24:27], s48 offen lds
    s_waitcnt lgkmcnt(4)
    v_mfma_f32_32x32x16_bf16 v[80:95], v[16:19], v[20:23], v[80:95]
    v_fmac_f32 v240, s76, v244
    v_fmac_f32 v241, s76, v245
    v_fmac_f32 v242, s76, v246
    ds_read_b128 v[40:43], v11
    ds_read_b128 v[44:47], v12 offset:15360
    s_waitcnt lgkmcnt(5)
    v_mfma_f32_32x32x16_bf16 v[96:111], v[16:19], v[24:27], v[96:111]
    v_fmac_f32 v243, s76, v247
    v_cvt_pk_bf16_f32 v240, v64, v240
    ds_read_b128 v[48:51], v12 offset:16384
    ds_read_b128 v[52:55], v12 offset:17408
    s_waitcnt lgkmcnt(6)
    v_mfma_f32_32x32x16_bf16 v[112:127], v[16:19], v[28:31], v[112:127]
    s_add_u32 m0, s57, 72704
    s_add_u32 s48, s55, 63488
    buffer_load_dwordx4 v13, s[24:27], s48 offen lds
    v_cvt_pk_bf16_f32 v241, v65, v241
    v_cvt_pk_bf16_f32 v242, v66, v242
    ds_read_b128 v[56:59], v12 offset:18432
    ds_read_b128 v[60:63], v12 offset:19456
    s_waitcnt lgkmcnt(7)
    v_mfma_f32_32x32x16_bf16 v[128:143], v[16:19], v[32:35], v[128:143]
    v_cvt_pk_bf16_f32 v243, v67, v243
    ds_write_b128 v2, v[240:243] offset:3072
    s_waitcnt lgkmcnt(6)
    v_mfma_f32_32x32x16_bf16 v[144:159], v[16:19], v[36:39], v[144:159]
    s_add_u32 m0, s57, 73728
    s_add_u32 s48, s55, 64512
    buffer_load_dwordx4 v13, s[24:27], s48 offen lds
    s_add_u32 m0, s57, 74752
    s_add_u32 s48, s55, 65536
    buffer_load_dwordx4 v13, s[24:27], s48 offen lds
    s_waitcnt lgkmcnt(4)
    v_mfma_f32_32x32x16_bf16 v[80:95], v[40:43], v[44:47], v[80:95]
    v_add_u32 v8, 4294962176, v8
    v_add_u32 v9, 4294962176, v9
    v_add_u32 v10, 4294962176, v10
    v_add_u32 v11, 4294962176, v11
    v_add_u32 v12, 20480, v12
    s_waitcnt lgkmcnt(0) vmcnt(14)
    s_barrier
    ds_read_b128 v[16:19], v8
    ds_read_b128 v[20:23], v12 offset:0
    v_mfma_f32_32x32x16_bf16 v[96:111], v[40:43], v[48:51], v[96:111]
    ds_read_b128 v[24:27], v12 offset:1024
    ds_read_b128 v[28:31], v12 offset:2048
    v_mfma_f32_32x32x16_bf16 v[112:127], v[40:43], v[52:55], v[112:127]
    ds_read_b128 v[32:35], v12 offset:3072
    ds_read_b128 v[36:39], v12 offset:4096
    v_mfma_f32_32x32x16_bf16 v[128:143], v[40:43], v[56:59], v[128:143]
    v_mfma_f32_32x32x16_bf16 v[144:159], v[40:43], v[60:63], v[144:159]
    s_waitcnt lgkmcnt(4)
    v_mfma_f32_32x32x16_bf16 v[80:95], v[16:19], v[20:23], v[80:95]
    s_waitcnt vmcnt(12)
    v_lshlrev_b32 v64, 16, v160
    v_lshlrev_b32 v68, 16, v164
    ds_read_b128 v[40:43], v9
    ds_read_b128 v[44:47], v12 offset:5120
    s_waitcnt lgkmcnt(5)
    v_mfma_f32_32x32x16_bf16 v[96:111], v[16:19], v[24:27], v[96:111]
    v_lshlrev_b32 v65, 16, v161
    v_lshlrev_b32 v69, 16, v165
    ds_read_b128 v[48:51], v12 offset:6144
    ds_read_b128 v[52:55], v12 offset:7168
    s_waitcnt lgkmcnt(6)
    v_mfma_f32_32x32x16_bf16 v[112:127], v[16:19], v[28:31], v[112:127]
    v_lshlrev_b32 v66, 16, v162
    s_add_u32 s48, s54, 1966592
    buffer_load_dwordx4 v[224:227], v14, s[8:11], s48 offen offset:0
    v_lshlrev_b32 v70, 16, v166
    ds_read_b128 v[56:59], v12 offset:8192
    ds_read_b128 v[60:63], v12 offset:9216
    s_waitcnt lgkmcnt(7)
    v_mfma_f32_32x32x16_bf16 v[128:143], v[16:19], v[32:35], v[128:143]
    v_lshlrev_b32 v67, 16, v163
    v_lshlrev_b32 v71, 16, v167
    s_waitcnt lgkmcnt(6)
    v_mfma_f32_32x32x16_bf16 v[144:159], v[16:19], v[36:39], v[144:159]
    v_and_b32 v160, v72, v160
    v_and_b32 v161, v72, v161
    s_add_u32 s48, s54, 1966592
    buffer_load_dwordx4 v[228:231], v14, s[8:11], s48 offen offset:640
    s_waitcnt lgkmcnt(4)
    v_mfma_f32_32x32x16_bf16 v[80:95], v[40:43], v[44:47], v[80:95]
    v_and_b32 v162, v72, v162
    v_and_b32 v163, v72, v163
    ds_read_b128 v[16:19], v10
    ds_read_b128 v[20:23], v12 offset:10240
    s_waitcnt lgkmcnt(5)
    v_mfma_f32_32x32x16_bf16 v[96:111], v[40:43], v[48:51], v[96:111]
    v_and_b32 v164, v72, v164
    v_and_b32 v165, v72, v165
    v_and_b32 v166, v72, v166
    ds_read_b128 v[24:27], v12 offset:11264
    ds_read_b128 v[28:31], v12 offset:12288
    s_waitcnt lgkmcnt(6)
    v_mfma_f32_32x32x16_bf16 v[112:127], v[40:43], v[52:55], v[112:127]
    s_add_u32 m0, s56, 45056
    s_add_u32 s48, s55, 81920
    buffer_load_dwordx4 v13, s[24:27], s48 offen lds
    v_and_b32 v167, v72, v167
    ds_read_b128 v[32:35], v12 offset:13312
    ds_read_b128 v[36:39], v12 offset:14336
    s_waitcnt lgkmcnt(7)
    v_mfma_f32_32x32x16_bf16 v[128:143], v[40:43], v[56:59], v[128:143]
    v_fmac_f32 v64, s76, v68
    v_fmac_f32 v65, s76, v69
    v_fmac_f32 v66, s76, v70
    s_waitcnt lgkmcnt(6)
    v_mfma_f32_32x32x16_bf16 v[144:159], v[40:43], v[60:63], v[144:159]
    v_fmac_f32 v67, s76, v71
    s_add_u32 m0, s56, 46080
    s_add_u32 s48, s55, 82944
    buffer_load_dwordx4 v13, s[24:27], s48 offen lds
    s_waitcnt lgkmcnt(4)
    v_mfma_f32_32x32x16_bf16 v[80:95], v[16:19], v[20:23], v[80:95]
    v_fmac_f32 v160, s76, v164
    v_fmac_f32 v161, s76, v165
    v_fmac_f32 v162, s76, v166
    ds_read_b128 v[40:43], v11
    ds_read_b128 v[44:47], v12 offset:15360
    s_waitcnt lgkmcnt(5)
    v_mfma_f32_32x32x16_bf16 v[96:111], v[16:19], v[24:27], v[96:111]
    v_fmac_f32 v163, s76, v167
    v_cvt_pk_bf16_f32 v160, v64, v160
    ds_read_b128 v[48:51], v12 offset:16384
    ds_read_b128 v[52:55], v12 offset:17408
    s_waitcnt lgkmcnt(6)
    v_mfma_f32_32x32x16_bf16 v[112:127], v[16:19], v[28:31], v[112:127]
    s_add_u32 m0, s56, 47104
    s_add_u32 s48, s55, 83968
    buffer_load_dwordx4 v13, s[24:27], s48 offen lds
    v_cvt_pk_bf16_f32 v161, v65, v161
    v_cvt_pk_bf16_f32 v162, v66, v162
    ds_read_b128 v[56:59], v12 offset:18432
    ds_read_b128 v[60:63], v12 offset:19456
    s_waitcnt lgkmcnt(7)
    v_mfma_f32_32x32x16_bf16 v[128:143], v[16:19], v[32:35], v[128:143]
    v_cvt_pk_bf16_f32 v163, v67, v163
    ds_write_b128 v2, v[160:163] offset:8192
    s_waitcnt lgkmcnt(6)
    v_mfma_f32_32x32x16_bf16 v[144:159], v[16:19], v[36:39], v[144:159]
    s_add_u32 m0, s56, 48128
    s_add_u32 s48, s55, 84992
    buffer_load_dwordx4 v13, s[24:27], s48 offen lds
    s_add_u32 m0, s56, 49152
    s_add_u32 s48, s55, 86016
    buffer_load_dwordx4 v13, s[24:27], s48 offen lds
    s_waitcnt lgkmcnt(4)
    v_mfma_f32_32x32x16_bf16 v[80:95], v[40:43], v[44:47], v[80:95]
    v_add_u32 v8, 5120, v8
    v_add_u32 v9, 5120, v9
    v_add_u32 v10, 5120, v10
    v_add_u32 v11, 5120, v11
    v_add_u32 v12, 45056, v12
    s_waitcnt lgkmcnt(0) vmcnt(14)
    s_barrier
    ds_read_b128 v[16:19], v8
    ds_read_b128 v[20:23], v12 offset:0
    v_mfma_f32_32x32x16_bf16 v[96:111], v[40:43], v[48:51], v[96:111]
    ds_read_b128 v[24:27], v12 offset:1024
    ds_read_b128 v[28:31], v12 offset:2048
    v_mfma_f32_32x32x16_bf16 v[112:127], v[40:43], v[52:55], v[112:127]
    ds_read_b128 v[32:35], v12 offset:3072
    ds_read_b128 v[36:39], v12 offset:4096
    v_mfma_f32_32x32x16_bf16 v[128:143], v[40:43], v[56:59], v[128:143]
    v_mfma_f32_32x32x16_bf16 v[144:159], v[40:43], v[60:63], v[144:159]
    s_waitcnt lgkmcnt(4)
    v_mfma_f32_32x32x16_bf16 v[80:95], v[16:19], v[20:23], v[80:95]
    s_waitcnt vmcnt(12)
    v_lshlrev_b32 v64, 16, v208
    ds_read_b128 v[40:43], v9
    ds_read_b128 v[44:47], v12 offset:20480
    s_waitcnt lgkmcnt(5)
    v_mfma_f32_32x32x16_bf16 v[96:111], v[16:19], v[24:27], v[96:111]
    v_lshlrev_b32 v68, 16, v212
    v_lshlrev_b32 v65, 16, v209
    ds_read_b128 v[48:51], v12 offset:21504
    ds_read_b128 v[52:55], v12 offset:22528
    s_waitcnt lgkmcnt(6)
    v_mfma_f32_32x32x16_bf16 v[112:127], v[16:19], v[28:31], v[112:127]
    v_lshlrev_b32 v69, 16, v213
    v_lshlrev_b32 v66, 16, v210
    ds_read_b128 v[56:59], v12 offset:23552
    ds_read_b128 v[60:63], v12 offset:24576
    s_waitcnt lgkmcnt(7)
    v_mfma_f32_32x32x16_bf16 v[128:143], v[16:19], v[32:35], v[128:143]
    v_lshlrev_b32 v70, 16, v214
    v_lshlrev_b32 v67, 16, v211
    s_waitcnt lgkmcnt(6)
    v_mfma_f32_32x32x16_bf16 v[144:159], v[16:19], v[36:39], v[144:159]
    v_lshlrev_b32 v71, 16, v215
    v_and_b32 v208, v72, v208
    s_waitcnt lgkmcnt(4)
    v_mfma_f32_32x32x16_bf16 v[80:95], v[40:43], v[44:47], v[80:95]
    v_and_b32 v209, v72, v209
    v_and_b32 v210, v72, v210
    ds_read_b128 v[16:19], v10
    ds_read_b128 v[20:23], v12 offset:40960
    s_waitcnt lgkmcnt(5)
    v_mfma_f32_32x32x16_bf16 v[96:111], v[40:43], v[48:51], v[96:111]
    v_and_b32 v211, v72, v211
    v_and_b32 v212, v72, v212
    ds_read_b128 v[24:27], v12 offset:41984
    ds_read_b128 v[28:31], v12 offset:43008
    s_waitcnt lgkmcnt(6)
    v_mfma_f32_32x32x16_bf16 v[112:127], v[40:43], v[52:55], v[112:127]
    v_and_b32 v213, v72, v213
    v_and_b32 v214, v72, v214
    ds_read_b128 v[32:35], v12 offset:44032
    ds_read_b128 v[36:39], v12 offset:45056
    s_waitcnt lgkmcnt(7)
    v_mfma_f32_32x32x16_bf16 v[128:143], v[40:43], v[56:59], v[128:143]
    v_and_b32 v215, v72, v215
    v_fmac_f32 v64, s76, v68
    s_waitcnt lgkmcnt(6)
    v_mfma_f32_32x32x16_bf16 v[144:159], v[40:43], v[60:63], v[144:159]
    v_fmac_f32 v65, s76, v69
    v_fmac_f32 v66, s76, v70
    s_waitcnt lgkmcnt(4)
    v_mfma_f32_32x32x16_bf16 v[80:95], v[16:19], v[20:23], v[80:95]
    v_fmac_f32 v67, s76, v71
    v_fmac_f32 v208, s76, v212
    ds_read_b128 v[40:43], v11
    ds_read_b128 v[44:47], v3 offset:0
    s_waitcnt lgkmcnt(5)
    v_mfma_f32_32x32x16_bf16 v[96:111], v[16:19], v[24:27], v[96:111]
    v_fmac_f32 v209, s76, v213
    v_fmac_f32 v210, s76, v214
    ds_read_b128 v[48:51], v3 offset:1024
    ds_read_b128 v[52:55], v3 offset:2048
    s_waitcnt lgkmcnt(6)
    v_mfma_f32_32x32x16_bf16 v[112:127], v[16:19], v[28:31], v[112:127]
    v_fmac_f32 v211, s76, v215
    v_cvt_pk_bf16_f32 v208, v64, v208
    ds_read_b128 v[56:59], v3 offset:3072
    ds_read_b128 v[60:63], v3 offset:4096
    s_waitcnt lgkmcnt(7)
    v_mfma_f32_32x32x16_bf16 v[128:143], v[16:19], v[32:35], v[128:143]
    v_cvt_pk_bf16_f32 v209, v65, v209
    v_cvt_pk_bf16_f32 v210, v66, v210
    s_waitcnt lgkmcnt(6)
    v_mfma_f32_32x32x16_bf16 v[144:159], v[16:19], v[36:39], v[144:159]
    v_cvt_pk_bf16_f32 v211, v67, v211
    ds_write_b128 v2, v[208:211] offset:3072
    s_waitcnt lgkmcnt(4)
    v_mfma_f32_32x32x16_bf16 v[80:95], v[40:43], v[44:47], v[80:95]
    v_add_u32 v8, 4294962176, v8
    v_add_u32 v9, 4294962176, v9
    v_add_u32 v10, 4294962176, v10
    v_add_u32 v11, 4294962176, v11
    v_add_u32 v12, 5120, v12
    s_waitcnt lgkmcnt(0) vmcnt(7)
    s_barrier
    ds_read_b128 v[16:19], v8
    ds_read_b128 v[20:23], v12 offset:0
    v_mfma_f32_32x32x16_bf16 v[96:111], v[40:43], v[48:51], v[96:111]
    ds_read_b128 v[24:27], v12 offset:1024
    ds_read_b128 v[28:31], v12 offset:2048
    v_mfma_f32_32x32x16_bf16 v[112:127], v[40:43], v[52:55], v[112:127]
    ds_read_b128 v[32:35], v12 offset:3072
    ds_read_b128 v[36:39], v12 offset:4096
    v_mfma_f32_32x32x16_bf16 v[128:143], v[40:43], v[56:59], v[128:143]
    v_mfma_f32_32x32x16_bf16 v[144:159], v[40:43], v[60:63], v[144:159]
    s_waitcnt lgkmcnt(4)
    v_mfma_f32_32x32x16_bf16 v[80:95], v[16:19], v[20:23], v[80:95]
    s_waitcnt vmcnt(5)
    v_lshlrev_b32 v64, 16, v224
    ds_read_b128 v[40:43], v9
    ds_read_b128 v[44:47], v12 offset:20480
    s_waitcnt lgkmcnt(5)
    v_mfma_f32_32x32x16_bf16 v[96:111], v[16:19], v[24:27], v[96:111]
    v_lshlrev_b32 v68, 16, v228
    v_lshlrev_b32 v65, 16, v225
    ds_read_b128 v[48:51], v12 offset:21504
    ds_read_b128 v[52:55], v12 offset:22528
    s_waitcnt lgkmcnt(6)
    v_mfma_f32_32x32x16_bf16 v[112:127], v[16:19], v[28:31], v[112:127]
    v_lshlrev_b32 v69, 16, v229
    v_lshlrev_b32 v66, 16, v226
    ds_read_b128 v[56:59], v12 offset:23552
    ds_read_b128 v[60:63], v12 offset:24576
    s_waitcnt lgkmcnt(7)
    v_mfma_f32_32x32x16_bf16 v[128:143], v[16:19], v[32:35], v[128:143]
    v_lshlrev_b32 v70, 16, v230
    v_lshlrev_b32 v67, 16, v227
    s_waitcnt lgkmcnt(6)
    v_mfma_f32_32x32x16_bf16 v[144:159], v[16:19], v[36:39], v[144:159]
    v_lshlrev_b32 v71, 16, v231
    v_and_b32 v224, v72, v224
    s_waitcnt lgkmcnt(4)
    v_mfma_f32_32x32x16_bf16 v[80:95], v[40:43], v[44:47], v[80:95]
    v_and_b32 v225, v72, v225
    v_and_b32 v226, v72, v226
    ds_read_b128 v[16:19], v10
    ds_read_b128 v[20:23], v12 offset:40960
    s_waitcnt lgkmcnt(5)
    v_mfma_f32_32x32x16_bf16 v[96:111], v[40:43], v[48:51], v[96:111]
    v_and_b32 v227, v72, v227
    v_and_b32 v228, v72, v228
    ds_read_b128 v[24:27], v12 offset:41984
    ds_read_b128 v[28:31], v12 offset:43008
    s_waitcnt lgkmcnt(6)
    v_mfma_f32_32x32x16_bf16 v[112:127], v[40:43], v[52:55], v[112:127]
    v_and_b32 v229, v72, v229
    v_and_b32 v230, v72, v230
    ds_read_b128 v[32:35], v12 offset:44032
    ds_read_b128 v[36:39], v12 offset:45056
    s_waitcnt lgkmcnt(7)
    v_mfma_f32_32x32x16_bf16 v[128:143], v[40:43], v[56:59], v[128:143]
    v_and_b32 v231, v72, v231
    v_fmac_f32 v64, s76, v68
    s_waitcnt lgkmcnt(6)
    v_mfma_f32_32x32x16_bf16 v[144:159], v[40:43], v[60:63], v[144:159]
    v_fmac_f32 v65, s76, v69
    v_fmac_f32 v66, s76, v70
    s_waitcnt lgkmcnt(4)
    v_mfma_f32_32x32x16_bf16 v[80:95], v[16:19], v[20:23], v[80:95]
    v_fmac_f32 v67, s76, v71
    v_fmac_f32 v224, s76, v228
    ds_read_b128 v[40:43], v11
    ds_read_b128 v[44:47], v3 offset:5120
    s_waitcnt lgkmcnt(5)
    v_mfma_f32_32x32x16_bf16 v[96:111], v[16:19], v[24:27], v[96:111]
    v_fmac_f32 v225, s76, v229
    v_fmac_f32 v226, s76, v230
    ds_read_b128 v[48:51], v3 offset:6144
    ds_read_b128 v[52:55], v3 offset:7168
    s_waitcnt lgkmcnt(6)
    v_mfma_f32_32x32x16_bf16 v[112:127], v[16:19], v[28:31], v[112:127]
    v_fmac_f32 v227, s76, v231
    v_cvt_pk_bf16_f32 v224, v64, v224
    ds_read_b128 v[56:59], v3 offset:8192
    ds_read_b128 v[60:63], v3 offset:9216
    s_waitcnt lgkmcnt(7)
    v_mfma_f32_32x32x16_bf16 v[128:143], v[16:19], v[32:35], v[128:143]
    v_cvt_pk_bf16_f32 v225, v65, v225
    v_cvt_pk_bf16_f32 v226, v66, v226
    s_waitcnt lgkmcnt(6)
    v_mfma_f32_32x32x16_bf16 v[144:159], v[16:19], v[36:39], v[144:159]
    v_cvt_pk_bf16_f32 v227, v67, v227
    ds_write_b128 v2, v[224:227] offset:8192
    s_waitcnt lgkmcnt(4)
    v_mfma_f32_32x32x16_bf16 v[80:95], v[40:43], v[44:47], v[80:95]
    v_add_u32 v8, 5120, v8
    v_add_u32 v9, 5120, v9
    v_add_u32 v10, 5120, v10
    v_add_u32 v11, 5120, v11
    v_add_u32 v12, 4294941696, v12
    s_waitcnt lgkmcnt(0) vmcnt(0)
    s_barrier
    ds_read_b128 v[16:19], v8
    ds_read_b128 v[20:23], v12 offset:0
    v_mfma_f32_32x32x16_bf16 v[96:111], v[40:43], v[48:51], v[96:111]
    ds_read_b128 v[24:27], v12 offset:1024
    ds_read_b128 v[28:31], v12 offset:2048
    v_mfma_f32_32x32x16_bf16 v[112:127], v[40:43], v[52:55], v[112:127]
    ds_read_b128 v[32:35], v12 offset:3072
    ds_read_b128 v[36:39], v12 offset:4096
    v_mfma_f32_32x32x16_bf16 v[128:143], v[40:43], v[56:59], v[128:143]
    v_mfma_f32_32x32x16_bf16 v[144:159], v[40:43], v[60:63], v[144:159]
    s_waitcnt lgkmcnt(4)
    v_mfma_f32_32x32x16_bf16 v[80:95], v[16:19], v[20:23], v[80:95]
    v_lshrrev_b32 v6, 5, v0
    v_lshlrev_b32 v6, 4, v6
    s_lshl_b32 s48, s44, 7
    s_add_u32 s48, s48, 147456
    v_add_u32 v7, s48, v6
    ds_read_b128 v[64:67], v7 offset:0
    ds_read_b128 v[68:71], v7 offset:32
    ds_read_b128 v[40:43], v9
    ds_read_b128 v[44:47], v12 offset:5120
    s_waitcnt lgkmcnt(5)
    v_mfma_f32_32x32x16_bf16 v[96:111], v[16:19], v[24:27], v[96:111]
    ds_read_b128 v[72:75], v7 offset:64
    ds_read_b128 v[76:79], v7 offset:96
    v_and_b32 v5, 15, v0
    v_lshlrev_b32 v5, 6, v5
    v_bfe_u32 v6, v0, 4, 1
    v_lshl_add_u32 v5, v6, 5, v5
    v_lshrrev_b32 v6, 5, v0
    ds_read_b128 v[48:51], v12 offset:6144
    ds_read_b128 v[52:55], v12 offset:7168
    s_waitcnt lgkmcnt(6)
    v_mfma_f32_32x32x16_bf16 v[112:127], v[16:19], v[28:31], v[112:127]
    v_lshl_add_u32 v5, v6, 4, v5
    s_and_b32 s61, s46, 1
    s_mul_i32 s61, s61, 10
    s_lshr_b32 s48, s46, 1
    s_add_u32 s61, s61, s48
    s_mul_i32 s51, s78, 43136
    s_mul_i32 s48, s46, 10240
    ds_read_b128 v[56:59], v12 offset:8192
    ds_read_b128 v[60:63], v12 offset:9216
    s_waitcnt lgkmcnt(7)
    v_mfma_f32_32x32x16_bf16 v[128:143], v[16:19], v[32:35], v[128:143]
    s_mul_i32 s49, s44, 20480
    s_add_u32 s49, s49, 65536
    v_lshrrev_b32 v1, 5, v0
    v_and_b32 v2, 7, v0
    v_xor_b32 v1, v1, v2
    v_and_b32 v4, 31, v0
    v_lshlrev_b32 v4, 7, v4
    s_waitcnt lgkmcnt(6)
    v_mfma_f32_32x32x16_bf16 v[144:159], v[16:19], v[36:39], v[144:159]
    v_lshl_add_u32 v1, v1, 4, v4
    v_add_u32 v1, s49, v1
    v_lshrrev_b32 v4, 3, v0
    v_xor_b32 v3, v2, v4
    v_lshlrev_b32 v4, 7, v4
    v_lshl_add_u32 v3, v3, 4, v4
    v_add_u32 v3, s49, v3
    s_waitcnt lgkmcnt(4)
    v_mfma_f32_32x32x16_bf16 v[80:95], v[40:43], v[44:47], v[80:95]
    v_xor_b32 v2, 64, v1
    v_lshlrev_b32 v4, 4, v0
    s_add_u32 s51, s51, s48
    s_add_u32 s51, s51, 0x660000
    s_lshl_b32 s59, s46, 4
    s_add_u32 s59, s59, s45
    s_lshl_b32 s59, s59, 7
    ds_read_b128 v[16:19], v10
    ds_read_b128 v[20:23], v12 offset:10240
    s_waitcnt lgkmcnt(5)
    v_mfma_f32_32x32x16_bf16 v[96:111], v[40:43], v[48:51], v[96:111]
    s_add_u32 s59, s59, 0xc000
    v_bfe_u32 v6, v0, 3, 1
    v_cmp_eq_u32 vcc, 0, v6
    v_mov_b32 v6, 0
    v_mov_b32 v13, 0x80008000
    v_cndmask_b32 v6, v6, v13, vcc
    s_waitcnt lgkmcnt(0)
    ds_read_b128 v[24:27], v12 offset:11264
    ds_read_b128 v[28:31], v12 offset:12288
    s_waitcnt lgkmcnt(6)
    v_mfma_f32_32x32x16_bf16 v[112:127], v[40:43], v[52:55], v[112:127]
    v_mul_f32 v176, v176, v64
    v_mul_f32_e64 v192, -v192, v64
    v_mul_f32 v177, v177, v65
    v_mul_f32_e64 v193, -v193, v65
    v_mul_f32 v178, v178, v66
    v_mul_f32_e64 v194, -v194, v66
    v_mul_f32 v179, v179, v67
    ds_read_b128 v[32:35], v12 offset:13312
    ds_read_b128 v[36:39], v12 offset:14336
    s_waitcnt lgkmcnt(7)
    v_mfma_f32_32x32x16_bf16 v[128:143], v[40:43], v[56:59], v[128:143]
    v_mul_f32_e64 v195, -v195, v67
    v_mul_f32 v180, v180, v68
    v_mul_f32_e64 v196, -v196, v68
    v_mul_f32 v181, v181, v69
    v_mul_f32_e64 v197, -v197, v69
    v_mul_f32 v182, v182, v70
    v_mul_f32_e64 v198, -v198, v70
    s_waitcnt lgkmcnt(6)
    v_mfma_f32_32x32x16_bf16 v[144:159], v[40:43], v[60:63], v[144:159]
    v_mul_f32 v183, v183, v71
    v_mul_f32_e64 v199, -v199, v71
    v_mul_f32 v184, v184, v72
    v_mul_f32_e64 v200, -v200, v72
    v_mul_f32 v185, v185, v73
    v_mul_f32_e64 v201, -v201, v73
    v_mul_f32 v186, v186, v74
    s_waitcnt lgkmcnt(4)
    v_mfma_f32_32x32x16_bf16 v[80:95], v[16:19], v[20:23], v[80:95]
    v_mul_f32_e64 v202, -v202, v74
    v_mul_f32 v187, v187, v75
    v_mul_f32_e64 v203, -v203, v75
    v_mul_f32 v188, v188, v76
    v_mul_f32_e64 v204, -v204, v76
    v_mul_f32 v189, v189, v77
    v_mul_f32_e64 v205, -v205, v77
    ds_read_b128 v[40:43], v11
    ds_read_b128 v[44:47], v12 offset:15360
    s_waitcnt lgkmcnt(5)
    v_mfma_f32_32x32x16_bf16 v[96:111], v[16:19], v[24:27], v[96:111]
    v_mul_f32 v190, v190, v78
    v_mul_f32_e64 v206, -v206, v78
    v_mul_f32 v191, v191, v79
    v_mul_f32_e64 v207, -v207, v79
    v_cvt_pk_bf16_f32 v208, v176, v177
    v_cvt_pk_bf16_f32 v216, v192, v193
    v_cvt_pk_bf16_f32 v209, v178, v179
    ds_read_b128 v[48:51], v12 offset:16384
    ds_read_b128 v[52:55], v12 offset:17408
    s_waitcnt lgkmcnt(6)
    v_mfma_f32_32x32x16_bf16 v[112:127], v[16:19], v[28:31], v[112:127]
    v_cvt_pk_bf16_f32 v217, v194, v195
    v_cvt_pk_bf16_f32 v210, v180, v181
    v_cvt_pk_bf16_f32 v218, v196, v197
    v_cvt_pk_bf16_f32 v211, v182, v183
    v_cvt_pk_bf16_f32 v219, v198, v199
    v_cvt_pk_bf16_f32 v212, v184, v185
    v_cvt_pk_bf16_f32 v220, v200, v201
    ds_read_b128 v[56:59], v12 offset:18432
    ds_read_b128 v[60:63], v12 offset:19456
    s_waitcnt lgkmcnt(7)
    v_mfma_f32_32x32x16_bf16 v[128:143], v[16:19], v[32:35], v[128:143]
    v_cvt_pk_bf16_f32 v213, v186, v187
    v_cvt_pk_bf16_f32 v221, v202, v203
    v_cvt_pk_bf16_f32 v214, v188, v189
    v_cvt_pk_bf16_f32 v222, v204, v205
    v_cvt_pk_bf16_f32 v215, v190, v191
    v_cvt_pk_bf16_f32 v223, v206, v207
    v_xor_b32 v176, 0x80008000, v216
    s_waitcnt lgkmcnt(6)
    v_mfma_f32_32x32x16_bf16 v[144:159], v[16:19], v[36:39], v[144:159]
    v_xor_b32 v177, 0x80008000, v217
    v_xor_b32 v178, 0x80008000, v218
    v_xor_b32 v179, 0x80008000, v219
    v_xor_b32 v180, 0x80008000, v220
    v_xor_b32 v181, 0x80008000, v221
    v_xor_b32 v182, 0x80008000, v222
    v_xor_b32 v183, 0x80008000, v223
    s_waitcnt lgkmcnt(4)
    v_mfma_f32_32x32x16_bf16 v[80:95], v[40:43], v[44:47], v[80:95]
    s_waitcnt lgkmcnt(3)
    v_mfma_f32_32x32x16_bf16 v[96:111], v[40:43], v[48:51], v[96:111]
    s_waitcnt lgkmcnt(2)
    v_mfma_f32_32x32x16_bf16 v[112:127], v[40:43], v[52:55], v[112:127]
    s_waitcnt lgkmcnt(1)
    v_mfma_f32_32x32x16_bf16 v[128:143], v[40:43], v[56:59], v[128:143]
    s_waitcnt lgkmcnt(0)
    v_mfma_f32_32x32x16_bf16 v[144:159], v[40:43], v[60:63], v[144:159]
    s_cmp_eq_u32 s46, 0
    s_cbranch_scc1 L_dft_e0
    s_nop 15
    v_xor_b32 v8, 32, v1
    v_xor_b32 v9, 32, v2
    v_cvt_pk_bf16_f32 v48, v80, v81
    v_cvt_pk_bf16_f32 v49, v82, v83
    v_cvt_pk_bf16_f32 v50, v84, v85
    v_cvt_pk_bf16_f32 v51, v86, v87
    v_cvt_pk_bf16_f32 v52, v88, v89
    v_cvt_pk_bf16_f32 v53, v90, v91
    v_cvt_pk_bf16_f32 v54, v92, v93
    v_cvt_pk_bf16_f32 v55, v94, v95
    v_cvt_pk_bf16_f32 v56, v96, v97
    v_cvt_pk_bf16_f32 v57, v98, v99
    v_cvt_pk_bf16_f32 v58, v100, v101
    v_cvt_pk_bf16_f32 v59, v102, v103
    v_cvt_pk_bf16_f32 v60, v104, v105
    v_cvt_pk_bf16_f32 v61, v106, v107
    v_cvt_pk_bf16_f32 v62, v108, v109
    v_cvt_pk_bf16_f32 v63, v110, v111
    s_nop 1
    v_mfma_f32_32x32x16_bf16 v[80:95], v[48:51], v[208:211], 0
    v_cvt_pk_bf16_f32 v64, v112, v113
    v_cvt_pk_bf16_f32 v65, v114, v115
    v_mfma_f32_32x32x16_bf16 v[96:111], v[56:59], v[208:211], 0
    v_cvt_pk_bf16_f32 v66, v116, v117
    v_cvt_pk_bf16_f32 v67, v118, v119
    v_mfma_f32_32x32x16_bf16 v[80:95], v[52:55], v[212:215], v[80:95]
    v_cvt_pk_bf16_f32 v68, v120, v121
    v_cvt_pk_bf16_f32 v69, v122, v123
    v_mfma_f32_32x32x16_bf16 v[96:111], v[60:63], v[212:215], v[96:111]
    v_cvt_pk_bf16_f32 v70, v124, v125
    v_cvt_pk_bf16_f32 v71, v126, v127
    v_mfma_f32_32x32x16_bf16 v[80:95], v[56:59], v[176:179], v[80:95]
    v_cvt_pk_bf16_f32 v72, v128, v129
    v_cvt_pk_bf16_f32 v73, v130, v131
    v_mfma_f32_32x32x16_bf16 v[96:111], v[48:51], v[216:219], v[96:111]
    v_cvt_pk_bf16_f32 v74, v132, v133
    v_cvt_pk_bf16_f32 v75, v134, v135
    v_mfma_f32_32x32x16_bf16 v[80:95], v[60:63], v[180:183], v[80:95]
    v_cvt_pk_bf16_f32 v76, v136, v137
    v_cvt_pk_bf16_f32 v77, v138, v139
    v_mfma_f32_32x32x16_bf16 v[96:111], v[52:55], v[220:223], v[96:111]
    v_cvt_pk_bf16_f32 v78, v140, v141
    v_cvt_pk_bf16_f32 v79, v142, v143
    s_nop 1
    v_mfma_f32_32x32x16_bf16 v[112:127], v[64:67], v[208:211], 0
    v_mfma_f32_32x32x16_bf16 v[128:143], v[72:75], v[208:211], 0
    s_nop 10
    v_cvt_pk_bf16_f32 v240, v80, v81
    v_cvt_pk_bf16_f32 v242, v96, v97
    v_mfma_f32_32x32x16_bf16 v[112:127], v[68:71], v[212:215], v[112:127]
    v_cvt_pk_bf16_f32 v241, v82, v83
    v_cvt_pk_bf16_f32 v243, v98, v99
    ds_write_b128 v1, v[240:243] offset:0
    v_cvt_pk_bf16_f32 v244, v84, v85
    v_mfma_f32_32x32x16_bf16 v[128:143], v[76:79], v[212:215], v[128:143]
    v_cvt_pk_bf16_f32 v246, v100, v101
    v_cvt_pk_bf16_f32 v245, v86, v87
    v_cvt_pk_bf16_f32 v247, v102, v103
    ds_write_b128 v8, v[244:247] offset:0
    v_mfma_f32_32x32x16_bf16 v[112:127], v[72:75], v[176:179], v[112:127]
    v_cvt_pk_bf16_f32 v248, v88, v89
    v_cvt_pk_bf16_f32 v250, v104, v105
    v_cvt_pk_bf16_f32 v249, v90, v91
    v_mfma_f32_32x32x16_bf16 v[128:143], v[64:67], v[216:219], v[128:143]
    v_cvt_pk_bf16_f32 v251, v106, v107
    ds_write_b128 v2, v[248:251] offset:0
    v_cvt_pk_bf16_f32 v252, v92, v93
    v_cvt_pk_bf16_f32 v254, v108, v109
    v_mfma_f32_32x32x16_bf16 v[112:127], v[76:79], v[180:183], v[112:127]
    v_cvt_pk_bf16_f32 v253, v94, v95
    v_cvt_pk_bf16_f32 v255, v110, v111
    ds_write_b128 v9, v[252:255] offset:0
    ds_read_b128 v[80:83], v3 offset:0
    v_mfma_f32_32x32x16_bf16 v[128:143], v[68:71], v[220:223], v[128:143]
    ds_read_b128 v[84:87], v3 offset:1024
    ds_read_b128 v[88:91], v3 offset:2048
    ds_read_b128 v[92:95], v3 offset:3072
    v_cvt_pk_bf16_f32 v48, v144, v145
    v_cvt_pk_bf16_f32 v49, v146, v147
    v_cvt_pk_bf16_f32 v50, v148, v149
    v_cvt_pk_bf16_f32 v51, v150, v151
    v_cvt_pk_bf16_f32 v52, v152, v153
    v_cvt_pk_bf16_f32 v53, v154, v155
    v_cvt_pk_bf16_f32 v54, v156, v157
    v_cvt_pk_bf16_f32 v55, v158, v159
    v_xor_b32_dpp v56, v48, v6 row_ror:8 row_mask:0xf bank_mask:0xf
    v_xor_b32_dpp v57, v49, v6 row_ror:8 row_mask:0xf bank_mask:0xf
    v_xor_b32_dpp v58, v50, v6 row_ror:8 row_mask:0xf bank_mask:0xf
    v_xor_b32_dpp v59, v51, v6 row_ror:8 row_mask:0xf bank_mask:0xf
    v_xor_b32_dpp v60, v52, v6 row_ror:8 row_mask:0xf bank_mask:0xf
    v_xor_b32_dpp v61, v53, v6 row_ror:8 row_mask:0xf bank_mask:0xf
    v_xor_b32_dpp v62, v54, v6 row_ror:8 row_mask:0xf bank_mask:0xf
    v_xor_b32_dpp v63, v55, v6 row_ror:8 row_mask:0xf bank_mask:0xf
    s_add_u32 s48, s51, 0
    s_waitcnt lgkmcnt(3)
    buffer_store_dwordx4 v[80:83], v4, s[20:23], s48 offen offset:0 sc1
    s_waitcnt lgkmcnt(2)
    buffer_store_dwordx4 v[84:87], v4, s[20:23], s48 offen offset:1024 sc1
    s_waitcnt lgkmcnt(1)
    buffer_store_dwordx4 v[88:91], v4, s[20:23], s48 offen offset:2048 sc1
    s_waitcnt lgkmcnt(0)
    buffer_store_dwordx4 v[92:95], v4, s[20:23], s48 offen offset:3072 sc1
    v_mfma_f32_32x32x16_bf16 v[224:239], v[48:51], v[208:211], 0
    v_cvt_pk_bf16_f32 v240, v112, v113
    v_cvt_pk_bf16_f32 v242, v128, v129
    v_cvt_pk_bf16_f32 v241, v114, v115
    v_cvt_pk_bf16_f32 v243, v130, v131
    ds_write_b128 v1, v[240:243] offset:4096
    v_cvt_pk_bf16_f32 v244, v116, v117
    v_mfma_f32_32x32x16_bf16 v[224:239], v[52:55], v[212:215], v[224:239]
    v_cvt_pk_bf16_f32 v246, v132, v133
    v_cvt_pk_bf16_f32 v245, v118, v119
    v_cvt_pk_bf16_f32 v247, v134, v135
    ds_write_b128 v8, v[244:247] offset:4096
    v_cvt_pk_bf16_f32 v248, v120, v121
    v_cvt_pk_bf16_f32 v250, v136, v137
    v_mfma_f32_32x32x16_bf16 v[224:239], v[56:59], v[216:219], v[224:239]
    v_cvt_pk_bf16_f32 v249, v122, v123
    v_cvt_pk_bf16_f32 v251, v138, v139
    ds_write_b128 v2, v[248:251] offset:4096
    v_cvt_pk_bf16_f32 v252, v124, v125
    v_cvt_pk_bf16_f32 v254, v140, v141
    v_cvt_pk_bf16_f32 v253, v126, v127
    v_mfma_f32_32x32x16_bf16 v[224:239], v[60:63], v[220:223], v[224:239]
    v_cvt_pk_bf16_f32 v255, v142, v143
    ds_write_b128 v9, v[252:255] offset:4096
    ds_read_b128 v[112:115], v3 offset:4096
    ds_read_b128 v[116:119], v3 offset:5120
    ds_read_b128 v[120:123], v3 offset:6144
    ds_read_b128 v[124:127], v3 offset:7168
    s_add_u32 s48, s51, 4096
    s_waitcnt lgkmcnt(3)
    buffer_store_dwordx4 v[112:115], v4, s[20:23], s48 offen offset:0 sc1
    s_waitcnt lgkmcnt(2)
    buffer_store_dwordx4 v[116:119], v4, s[20:23], s48 offen offset:1024 sc1
    s_waitcnt lgkmcnt(1)
    buffer_store_dwordx4 v[120:123], v4, s[20:23], s48 offen offset:2048 sc1
    s_waitcnt lgkmcnt(0)
    buffer_store_dwordx4 v[124:127], v4, s[20:23], s48 offen offset:3072 sc1
    s_nop 7
    v_cvt_pk_bf16_f32 v224, v224, v225
    v_cvt_pk_bf16_f32 v225, v226, v227
    v_cvt_pk_bf16_f32 v226, v228, v229
    v_cvt_pk_bf16_f32 v227, v230, v231
    v_cvt_pk_bf16_f32 v228, v232, v233
    v_cvt_pk_bf16_f32 v229, v234, v235
    v_cvt_pk_bf16_f32 v230, v236, v237
    v_cvt_pk_bf16_f32 v231, v238, v239
    s_add_u32 s48, s51, 8192
    s_nop 0
    v_permlane16_swap_b32 v224, v228
    v_permlane16_swap_b32 v225, v229
    v_permlane16_swap_b32 v226, v230
    v_permlane16_swap_b32 v227, v231
    buffer_store_dwordx4 v[224:227], v5, s[20:23], s48 offen offset:0 sc1
    buffer_store_dwordx4 v[228:231], v5, s[20:23], s48 offen offset:1024 sc1
    s_branch L_dft_c
L_dft_e0:
    ds_read_b128 v[32:35], v7 offset:512
    ds_read_b128 v[36:39], v7 offset:544
    ds_read_b128 v[40:43], v7 offset:576
    ds_read_b128 v[44:47], v7 offset:608
    v_and_b32 v15, 31, v0
    v_cmp_eq_u32 vcc, 0, v15
    v_cmp_eq_u32 s[4:5], 8, v15
    v_mov_b32 v13, 0x44200000
    v_cndmask_b32 v14, 0, -1, vcc
    v_cndmask_b32 v15, 0, -1, s[4:5]
    s_nop 15
    v_xor_b32 v8, 32, v1
    v_xor_b32 v9, 32, v2
    v_cvt_pk_bf16_f32 v64, v112, v113
    v_cvt_pk_bf16_f32 v65, v114, v115
    v_cvt_pk_bf16_f32 v66, v116, v117
    v_cvt_pk_bf16_f32 v67, v118, v119
    v_cvt_pk_bf16_f32 v68, v120, v121
    v_cvt_pk_bf16_f32 v69, v122, v123
    v_cvt_pk_bf16_f32 v70, v124, v125
    v_cvt_pk_bf16_f32 v71, v126, v127
    v_cvt_pk_bf16_f32 v72, v128, v129
    v_cvt_pk_bf16_f32 v73, v130, v131
    v_cvt_pk_bf16_f32 v74, v132, v133
    v_cvt_pk_bf16_f32 v75, v134, v135
    v_cvt_pk_bf16_f32 v76, v136, v137
    v_cvt_pk_bf16_f32 v77, v138, v139
    v_cvt_pk_bf16_f32 v78, v140, v141
    v_cvt_pk_bf16_f32 v79, v142, v143
    s_nop 1
    v_mfma_f32_32x32x16_bf16 v[112:127], v[64:67], v[208:211], 0
    s_waitcnt lgkmcnt(0)
    v_and_b32 v7, v13, v14
    v_fma_f32 v80, -v32, v7, v80
    v_fma_f32 v81, -v33, v7, v81
    v_fma_f32 v82, -v34, v7, v82
    v_fma_f32 v83, -v35, v7, v83
    v_fma_f32 v84, -v36, v7, v84
    v_fma_f32 v85, -v37, v7, v85
    v_mfma_f32_32x32x16_bf16 v[128:143], v[72:75], v[208:211], 0
    v_fma_f32 v86, -v38, v7, v86
    v_fma_f32 v87, -v39, v7, v87
    v_fma_f32 v88, -v40, v7, v88
    v_fma_f32 v89, -v41, v7, v89
    v_fma_f32 v90, -v42, v7, v90
    v_fma_f32 v91, -v43, v7, v91
    v_fma_f32 v92, -v44, v7, v92
    v_mfma_f32_32x32x16_bf16 v[112:127], v[68:71], v[212:215], v[112:127]
    v_fma_f32 v93, -v45, v7, v93
    v_fma_f32 v94, -v46, v7, v94
    v_fma_f32 v95, -v47, v7, v95
    v_cvt_pk_bf16_f32 v48, v80, v81
    v_cvt_pk_bf16_f32 v49, v82, v83
    v_cvt_pk_bf16_f32 v50, v84, v85
    v_cvt_pk_bf16_f32 v51, v86, v87
    v_mfma_f32_32x32x16_bf16 v[128:143], v[76:79], v[212:215], v[128:143]
    v_cvt_pk_bf16_f32 v52, v88, v89
    v_cvt_pk_bf16_f32 v53, v90, v91
    v_cvt_pk_bf16_f32 v54, v92, v93
    v_cvt_pk_bf16_f32 v55, v94, v95
    v_cvt_pk_bf16_f32 v56, v96, v97
    v_cvt_pk_bf16_f32 v57, v98, v99
    v_cvt_pk_bf16_f32 v58, v100, v101
    v_mfma_f32_32x32x16_bf16 v[112:127], v[72:75], v[176:179], v[112:127]
    v_cvt_pk_bf16_f32 v59, v102, v103
    v_cvt_pk_bf16_f32 v60, v104, v105
    v_cvt_pk_bf16_f32 v61, v106, v107
    v_cvt_pk_bf16_f32 v62, v108, v109
    v_cvt_pk_bf16_f32 v63, v110, v111
    v_and_b32 v32, v14, v56
    v_and_b32 v33, v14, v57
    v_and_b32 v34, v14, v58
    v_mfma_f32_32x32x16_bf16 v[128:143], v[64:67], v[216:219], v[128:143]
    v_and_b32 v35, v14, v59
    v_and_b32 v36, v14, v60
    v_and_b32 v37, v14, v61
    v_and_b32 v38, v14, v62
    v_and_b32 v39, v14, v63
    v_and_b32_dpp v40, v56, v15 row_ror:8 row_mask:0xf bank_mask:0xf
    v_and_b32_dpp v41, v57, v15 row_ror:8 row_mask:0xf bank_mask:0xf
    v_mfma_f32_32x32x16_bf16 v[112:127], v[76:79], v[180:183], v[112:127]
    v_and_b32_dpp v42, v58, v15 row_ror:8 row_mask:0xf bank_mask:0xf
    v_and_b32_dpp v43, v59, v15 row_ror:8 row_mask:0xf bank_mask:0xf
    v_and_b32_dpp v44, v60, v15 row_ror:8 row_mask:0xf bank_mask:0xf
    v_and_b32_dpp v45, v61, v15 row_ror:8 row_mask:0xf bank_mask:0xf
    v_and_b32_dpp v46, v62, v15 row_ror:8 row_mask:0xf bank_mask:0xf
    v_and_b32_dpp v47, v63, v15 row_ror:8 row_mask:0xf bank_mask:0xf
    v_bfi_b32 v56, v14, 0, v56
    v_mfma_f32_32x32x16_bf16 v[128:143], v[68:71], v[220:223], v[128:143]
    v_bfi_b32 v57, v14, 0, v57
    v_bfi_b32 v58, v14, 0, v58
    v_bfi_b32 v59, v14, 0, v59
    v_bfi_b32 v60, v14, 0, v60
    v_bfi_b32 v61, v14, 0, v61
    v_bfi_b32 v62, v14, 0, v62
    v_bfi_b32 v63, v14, 0, v63
    s_nop 1
    v_mfma_f32_32x32x16_bf16 v[80:95], v[48:51], v[208:211], 0
    v_mfma_f32_32x32x16_bf16 v[96:111], v[56:59], v[208:211], 0
    s_nop 10
    v_cvt_pk_bf16_f32 v240, v112, v113
    v_cvt_pk_bf16_f32 v242, v128, v129
    v_mfma_f32_32x32x16_bf16 v[80:95], v[52:55], v[212:215], v[80:95]
    v_cvt_pk_bf16_f32 v241, v114, v115
    v_cvt_pk_bf16_f32 v243, v130, v131
    ds_write_b128 v1, v[240:243] offset:4096
    v_cvt_pk_bf16_f32 v244, v116, v117
    v_mfma_f32_32x32x16_bf16 v[96:111], v[60:63], v[212:215], v[96:111]
    v_cvt_pk_bf16_f32 v246, v132, v133
    v_cvt_pk_bf16_f32 v245, v118, v119
    v_cvt_pk_bf16_f32 v247, v134, v135
    ds_write_b128 v8, v[244:247] offset:4096
    v_mfma_f32_32x32x16_bf16 v[80:95], v[56:59], v[176:179], v[80:95]
    v_cvt_pk_bf16_f32 v248, v120, v121
    v_cvt_pk_bf16_f32 v250, v136, v137
    v_cvt_pk_bf16_f32 v249, v122, v123
    v_mfma_f32_32x32x16_bf16 v[96:111], v[48:51], v[216:219], v[96:111]
    v_cvt_pk_bf16_f32 v251, v138, v139
    ds_write_b128 v2, v[248:251] offset:4096
    v_cvt_pk_bf16_f32 v252, v124, v125
    v_cvt_pk_bf16_f32 v254, v140, v141
    v_mfma_f32_32x32x16_bf16 v[80:95], v[60:63], v[180:183], v[80:95]
    v_cvt_pk_bf16_f32 v253, v126, v127
    v_cvt_pk_bf16_f32 v255, v142, v143
    ds_write_b128 v9, v[252:255] offset:4096
    ds_read_b128 v[112:115], v3 offset:4096
    v_mfma_f32_32x32x16_bf16 v[96:111], v[52:55], v[220:223], v[96:111]
    ds_read_b128 v[116:119], v3 offset:5120
    ds_read_b128 v[120:123], v3 offset:6144
    ds_read_b128 v[124:127], v3 offset:7168
    v_cvt_pk_bf16_f32 v64, v144, v145
    v_cvt_pk_bf16_f32 v65, v146, v147
    v_cvt_pk_bf16_f32 v66, v148, v149
    v_cvt_pk_bf16_f32 v67, v150, v151
    v_cvt_pk_bf16_f32 v68, v152, v153
    v_cvt_pk_bf16_f32 v69, v154, v155
    v_cvt_pk_bf16_f32 v70, v156, v157
    v_cvt_pk_bf16_f32 v71, v158, v159
    v_xor_b32_dpp v72, v64, v6 row_ror:8 row_mask:0xf bank_mask:0xf
    v_xor_b32_dpp v73, v65, v6 row_ror:8 row_mask:0xf bank_mask:0xf
    v_xor_b32_dpp v74, v66, v6 row_ror:8 row_mask:0xf bank_mask:0xf
    v_xor_b32_dpp v75, v67, v6 row_ror:8 row_mask:0xf bank_mask:0xf
    v_xor_b32_dpp v76, v68, v6 row_ror:8 row_mask:0xf bank_mask:0xf
    v_xor_b32_dpp v77, v69, v6 row_ror:8 row_mask:0xf bank_mask:0xf
    v_xor_b32_dpp v78, v70, v6 row_ror:8 row_mask:0xf bank_mask:0xf
    v_xor_b32_dpp v79, v71, v6 row_ror:8 row_mask:0xf bank_mask:0xf
    s_add_u32 s48, s51, 4096
    s_waitcnt lgkmcnt(3)
    buffer_store_dwordx4 v[112:115], v4, s[20:23], s48 offen offset:0 sc1
    s_waitcnt lgkmcnt(2)
    buffer_store_dwordx4 v[116:119], v4, s[20:23], s48 offen offset:1024 sc1
    s_waitcnt lgkmcnt(1)
    buffer_store_dwordx4 v[120:123], v4, s[20:23], s48 offen offset:2048 sc1
    s_waitcnt lgkmcnt(0)
    buffer_store_dwordx4 v[124:127], v4, s[20:23], s48 offen offset:3072 sc1
    v_mfma_f32_32x32x16_bf16 v[224:239], v[64:67], v[208:211], 0
    v_cvt_pk_bf16_f32 v240, v80, v81
    v_cvt_pk_bf16_f32 v242, v96, v97
    v_cvt_pk_bf16_f32 v241, v82, v83
    v_cvt_pk_bf16_f32 v243, v98, v99
    ds_write_b128 v1, v[240:243] offset:0
    v_cvt_pk_bf16_f32 v244, v84, v85
    v_mfma_f32_32x32x16_bf16 v[224:239], v[68:71], v[212:215], v[224:239]
    v_cvt_pk_bf16_f32 v246, v100, v101
    v_cvt_pk_bf16_f32 v245, v86, v87
    v_cvt_pk_bf16_f32 v247, v102, v103
    ds_write_b128 v8, v[244:247] offset:0
    v_cvt_pk_bf16_f32 v248, v88, v89
    v_cvt_pk_bf16_f32 v250, v104, v105
    v_mfma_f32_32x32x16_bf16 v[224:239], v[72:75], v[216:219], v[224:239]
    v_cvt_pk_bf16_f32 v249, v90, v91
    v_cvt_pk_bf16_f32 v251, v106, v107
    ds_write_b128 v2, v[248:251] offset:0
    v_cvt_pk_bf16_f32 v252, v92, v93
    v_cvt_pk_bf16_f32 v254, v108, v109
    v_cvt_pk_bf16_f32 v253, v94, v95
    v_mfma_f32_32x32x16_bf16 v[224:239], v[76:79], v[220:223], v[224:239]
    v_cvt_pk_bf16_f32 v255, v110, v111
    ds_write_b128 v9, v[252:255] offset:0
    ds_read_b128 v[80:83], v3 offset:0
    ds_read_b128 v[84:87], v3 offset:1024
    ds_read_b128 v[88:91], v3 offset:2048
    ds_read_b128 v[92:95], v3 offset:3072
    v_mfma_f32_32x32x16_bf16 v[240:255], v[32:35], v[208:211], 0
    s_add_u32 s48, s51, 0
    s_waitcnt lgkmcnt(3)
    buffer_store_dwordx4 v[80:83], v4, s[20:23], s48 offen offset:0 sc1
    s_waitcnt lgkmcnt(2)
    buffer_store_dwordx4 v[84:87], v4, s[20:23], s48 offen offset:1024 sc1
    s_waitcnt lgkmcnt(1)
    buffer_store_dwordx4 v[88:91], v4, s[20:23], s48 offen offset:2048 sc1
    s_waitcnt lgkmcnt(0)
    buffer_store_dwordx4 v[92:95], v4, s[20:23], s48 offen offset:3072 sc1
    v_mfma_f32_32x32x16_bf16 v[240:255], v[36:39], v[212:215], v[240:255]
    s_nop 7
    v_mfma_f32_32x32x16_bf16 v[240:255], v[40:43], v[216:219], v[240:255]
    v_cvt_pk_bf16_f32 v224, v224, v225
    v_cvt_pk_bf16_f32 v225, v226, v227
    v_cvt_pk_bf16_f32 v226, v228, v229
    v_cvt_pk_bf16_f32 v227, v230, v231
    v_cvt_pk_bf16_f32 v228, v232, v233
    v_cvt_pk_bf16_f32 v229, v234, v235
    v_cvt_pk_bf16_f32 v230, v236, v237
    v_cvt_pk_bf16_f32 v231, v238, v239
    v_mfma_f32_32x32x16_bf16 v[240:255], v[44:47], v[220:223], v[240:255]
    s_add_u32 s48, s51, 8192
    s_nop 0
    v_permlane16_swap_b32 v224, v228
    v_permlane16_swap_b32 v225, v229
    v_permlane16_swap_b32 v226, v230
    v_permlane16_swap_b32 v227, v231
    buffer_store_dwordx4 v[224:227], v5, s[20:23], s48 offen offset:0 sc1
    buffer_store_dwordx4 v[228:231], v5, s[20:23], s48 offen offset:1024 sc1
    s_nop 15
    v_cvt_pk_bf16_f32 v240, v240, v241
    v_cvt_pk_bf16_f32 v241, v242, v243
    v_cvt_pk_bf16_f32 v242, v244, v245
    v_cvt_pk_bf16_f32 v243, v246, v247
    v_cvt_pk_bf16_f32 v244, v248, v249
    v_cvt_pk_bf16_f32 v245, v250, v251
    v_cvt_pk_bf16_f32 v246, v252, v253
    v_cvt_pk_bf16_f32 v247, v254, v255
    s_add_u32 s48, s51, 40960
    s_nop 0
    v_permlane16_swap_b32 v240, v244
    v_permlane16_swap_b32 v241, v245
    v_permlane16_swap_b32 v242, v246
    v_permlane16_swap_b32 v243, v247
    buffer_store_dwordx4 v[240:243], v5, s[20:23], s48 offen offset:0 sc1
    buffer_store_dwordx4 v[244:247], v5, s[20:23], s48 offen offset:1024 sc1
L_dft_c:
    s_waitcnt vmcnt(0)
    v_mov_b32 v12, 149504
    v_mov_b32 v13, 1
    s_mov_b64 exec, 1
    ds_add_rtn_u32 v13, v12, v13 offset:4
    s_mov_b64 exec, -1
    v_lshlrev_b32 v11, 7, v0
    s_waitcnt lgkmcnt(0)
    v_readfirstlane_b32 s58, v13
    s_cmp_lg_u32 s58, 3
    s_cbranch_scc1 L_noft
    v_mov_b32 v12, s62
    v_mov_b32 v13, 0
    s_mov_b64 exec, 1
    buffer_store_dword v12, v13, s[20:23], s59 offen sc1
    s_mov_b64 exec, -1
    s_sub_u32 s48, s59, 0xc000
    v_cmp_eq_u32 vcc, s48, v11
    v_xor_b32 v12, 128, v11
    v_cndmask_b32 v11, v11, v12, vcc
    s_mov_b32 s48, 0xc000
    buffer_load_dword v48, v11, s[20:23], s48 offen sc1
L_noft:
    s_and_b32 s3, s2, 7
    s_lshl_b32 s60, s3, 2
    s_bfe_u32 s3, s2, 0x20004
    s_add_u32 s60, s60, s3
    s_bfe_u32 s3, s2, 0x10003
    s_mul_i32 s51, s60, 642
    s_mul_i32 s48, s3, 320
    s_add_u32 s51, s51, s48
    s_and_b32 s80, s51, 15
    s_and_b32 s49, s44, 1
    s_lshl_b32 s48, s49, 7
    s_add_u32 s80, s80, s48
    s_add_u32 s80, s80, 0
    s_and_b32 s81, s44, 2
    s_add_u32 s48, s3, s81
    s_mul_i32 s55, s48, 10240
    s_lshl_b32 s48, s49, 12
    s_add_u32 s55, s55, s48
    s_lshl_b32 s48, s60, 7
    s_add_u32 s55, s55, s48
    s_mul_i32 s3, s3, 10
    s_lshl_b32 s49, s49, 2
    s_add_u32 s3, s3, s49
    s_lshr_b32 s48, s44, 1
    s_add_u32 s61, s3, s48
    s_mov_b32 s79, 2
    s_lshl_b32 s56, s44, 12
    s_add_u32 s56, s56, 45056
    s_mul_i32 s71, s44, 20480
    s_add_u32 s71, s71, 80896
    s_branch L_mid
L_dft_l:
    s_mov_b32 s58, 0
    v_lshlrev_b32 v11, 7, v0
    s_and_b32 s3, s2, 7
    s_lshl_b32 s60, s3, 2
    s_bfe_u32 s3, s2, 0x20004
    s_add_u32 s60, s60, s3
    s_bfe_u32 s3, s2, 0x10003
    s_add_u32 s48, s3, 2
    s_cmp_ge_u32 s47, s48
    s_cbranch_scc1 L_dft_l3
    s_mul_i32 s51, s60, 642
    s_mul_i32 s48, s3, 320
    s_add_u32 s51, s51, s48
    s_and_b32 s80, s51, 15
    s_add_u32 s80, s80, 256
    s_lshl_b32 s48, s47, 1
    s_add_u32 s48, s48, s3
    s_mul_i32 s55, s48, 10240
    s_add_u32 s55, s55, 8192
    s_cmp_eq_u32 s47, 2
    s_cselect_b32 s55, 40960, s55
    s_lshl_b32 s48, s60, 6
    s_add_u32 s55, s55, s48
    s_mul_i32 s3, s3, 10
    s_add_u32 s3, s3, 8
    s_add_u32 s61, s3, s47
    s_lshl_b32 s81, s47, 1
    s_cmp_eq_u32 s47, 2
    s_cselect_b32 s81, 64, s81
    s_mov_b32 s79, 1
    s_lshl_b32 s56, s47, 12
    s_add_u32 s56, s56, 149632
L_mid:
    v_lshlrev_b32 v5, 4, v0
    v_and_b32 v9, 3, v0
    v_add_u32 v13, 149632, v5
    ds_read_b128 v[64:67], v13 offset:0
    ds_read_b128 v[68:71], v13 offset:1024
    ds_read_b128 v[72:75], v13 offset:2048
    ds_read_b128 v[76:79], v13 offset:3072
    ds_read_b128 v[80:83], v13 offset:4096
    ds_read_b128 v[84:87], v13 offset:5120
    ds_read_b128 v[88:91], v13 offset:6144
    ds_read_b128 v[92:95], v13 offset:7168
    v_mov_b32 v192, 0
    v_mov_b32 v193, 0
    v_mov_b32 v194, 0
    v_mov_b32 v195, 0
    v_mov_b32 v196, 0
    v_mov_b32 v197, 0
    v_mov_b32 v198, 0
    v_mov_b32 v199, 0
    v_mov_b32 v200, 0
    v_mov_b32 v201, 0
    v_mov_b32 v202, 0
    v_mov_b32 v203, 0
    v_mov_b32 v204, 0
    v_mov_b32 v205, 0
    v_mov_b32 v206, 0
    v_mov_b32 v207, 0
    v_mov_b32 v208, 0
    v_mov_b32 v209, 0
    v_mov_b32 v210, 0
    v_mov_b32 v211, 0
    v_mov_b32 v212, 0
    v_mov_b32 v213, 0
    v_mov_b32 v214, 0
    v_mov_b32 v215, 0
    v_mov_b32 v216, 0
    v_mov_b32 v217, 0
    v_mov_b32 v218, 0
    v_mov_b32 v219, 0
    v_mov_b32 v220, 0
    v_mov_b32 v221, 0
    v_mov_b32 v222, 0
    v_mov_b32 v223, 0
    v_and_b32 v8, 15, v0
    v_lshrrev_b32 v12, 2, v0
    v_lshlrev_b32 v6, 6, v12
    v_lshl_add_u32 v6, v9, 4, v6
    v_add_u32 v6, s56, v6
    v_and_b32 v13, 12, v12
    v_bfe_u32 v14, v0, 3, 1
    v_lshl_add_u32 v13, v14, 4, v13
    v_bfe_u32 v14, v0, 2, 1
    v_lshl_add_u32 v13, v14, 1, v13
    v_mul_u32_u24 v12, 43136, v13
    v_lshl_add_u32 v15, v9, 4, v12
    v_lshrrev_b32 v9, 4, v0
    v_lshlrev_b32 v10, 6, v8
    v_lshl_add_u32 v10, v9, 4, v10
    v_mul_u32_u24 v12, 1344, v9
    v_lshl_add_u32 v12, v8, 2, v12
    s_add_u32 s48, s80, s81
    v_add_u32 v7, s48, v12
    v_bfe_u32 v12, v0, 3, 1
    v_lshlrev_b32 v12, 1, v12
    v_bfe_u32 v13, v0, 4, 1
    v_lshl_add_u32 v12, v13, 4, v12
    v_lshrrev_b32 v14, 5, v0
    v_lshl_add_u32 v12, v14, 2, v12
    v_mul_u32_u24 v12, 43136, v12
    v_bfe_u32 v14, v0, 2, 1
    v_xor_b32 v13, v13, v14
    v_lshl_add_u32 v12, v13, 6, v12
    v_and_b32 v13, 3, v0
    v_lshl_add_u32 v1, v13, 4, v12
    v_lshrrev_b32 v12, 2, v0
    v_lshlrev_b32 v12, 7, v12
    v_lshl_add_u32 v12, v13, 4, v12
    v_bfe_u32 v13, v0, 3, 1
    v_lshl_add_u32 v12, v13, 6, v12
    v_add_u32 v2, s56, v12
    v_xor_b32 v4, 64, v2
    v_add_u32 v8, s71, v12
    v_xor_b32 v9, 64, v8
    s_waitcnt vmcnt(0) lgkmcnt(0)
    s_cmp_lg_u32 s58, 3
    s_cbranch_scc1 L_noft_72
    v_cmp_ne_u32 vcc, s62, v48
    s_cbranch_vccnz L_rare_73
L_back_74:
L_noft_72:
    s_barrier
    s_mul_i32 s51, s60, 86144
    s_lshl_b32 s48, s61, 12
    s_add_u32 s51, s51, s48
    s_add_u32 s51, s51, 0x910000
    s_cmp_eq_u32 s79, 1
    s_cbranch_scc1 L_one_77
    s_add_u32 m0, s56, 0
    s_add_u32 s48, s55, 6684672
    buffer_load_dwordx4 v1, s[20:23], s48 offen sc1 lds
    s_add_u32 m0, s56, 1024
    s_add_u32 s48, s55, 7029760
    buffer_load_dwordx4 v1, s[20:23], s48 offen sc1 lds
    s_add_u32 m0, s56, 2048
    s_add_u32 s48, s55, 8065024
    buffer_load_dwordx4 v1, s[20:23], s48 offen sc1 lds
    s_add_u32 m0, s56, 3072
    s_add_u32 s48, s55, 8410112
    buffer_load_dwordx4 v1, s[20:23], s48 offen sc1 lds
    s_add_u32 m0, s71, 0
    s_add_u32 s48, s55, 6727808
    buffer_load_dwordx4 v1, s[20:23], s48 offen sc1 lds
    s_add_u32 m0, s71, 1024
    s_add_u32 s48, s55, 7072896
    buffer_load_dwordx4 v1, s[20:23], s48 offen sc1 lds
    s_add_u32 m0, s71, 2048
    s_add_u32 s48, s55, 8108160
    buffer_load_dwordx4 v1, s[20:23], s48 offen sc1 lds
    s_add_u32 m0, s71, 3072
    s_add_u32 s48, s55, 8453248
    buffer_load_dwordx4 v1, s[20:23], s48 offen sc1 lds
    v_mov_b32 v12, 149504
    v_mov_b32 v13, 1
    s_mov_b64 exec, 1
    ds_add_u32 v12, v13 offset:8
    s_mov_b64 exec, -1
    s_add_u32 s48, s6, 69632
    buffer_load_dwordx4 v[96:99], v5, s[20:23], s48 offen sc1
    s_add_u32 s48, s6, 1003520
    buffer_load_dwordx4 v[100:103], v5, s[20:23], s48 offen sc1
    s_add_u32 s48, s6, 1052672
    buffer_load_dwordx4 v[104:107], v5, s[20:23], s48 offen sc1
    s_add_u32 s48, s75, 20480
    buffer_load_dwordx4 v[108:111], v5, s[20:23], s48 offen sc1
    s_add_u32 s48, s6, 24576
    buffer_load_dwordx4 v[112:115], v5, s[20:23], s48 offen sc1
    s_add_u32 s48, s6, 73728
    buffer_load_dwordx4 v[116:119], v5, s[20:23], s48 offen sc1
    s_add_u32 s48, s6, 1007616
    buffer_load_dwordx4 v[120:123], v5, s[20:23], s48 offen sc1
    s_add_u32 s48, s6, 1056768
    buffer_load_dwordx4 v[124:127], v5, s[20:23], s48 offen sc1
    v_mov_b32 v224, 0
    v_mov_b32 v225, 0
    v_mov_b32 v226, 0
    v_mov_b32 v227, 0
    v_mov_b32 v228, 0
    v_mov_b32 v229, 0
    v_mov_b32 v230, 0
    v_mov_b32 v231, 0
    v_mov_b32 v232, 0
    v_mov_b32 v233, 0
    v_mov_b32 v234, 0
    v_mov_b32 v235, 0
    v_mov_b32 v236, 0
    v_mov_b32 v237, 0
    v_mov_b32 v238, 0
    v_mov_b32 v239, 0
    v_mov_b32 v240, 0
    v_mov_b32 v241, 0
    v_mov_b32 v242, 0
    v_mov_b32 v243, 0
    v_mov_b32 v244, 0
    v_mov_b32 v245, 0
    v_mov_b32 v246, 0
    v_mov_b32 v247, 0
    v_mov_b32 v248, 0
    v_mov_b32 v249, 0
    v_mov_b32 v250, 0
    v_mov_b32 v251, 0
    v_mov_b32 v252, 0
    v_mov_b32 v253, 0
    v_mov_b32 v254, 0
    v_mov_b32 v255, 0
    ds_read_u16_d16_hi v192, v7 offset:0
    ds_read_u16_d16_hi v208, v7 offset:22272
    ds_read_u16_d16_hi v193, v7 offset:336
    ds_read_u16_d16_hi v209, v7 offset:22608
    ds_read_u16_d16_hi v194, v7 offset:672
    ds_read_u16_d16_hi v210, v7 offset:22944
    ds_read_u16_d16_hi v195, v7 offset:1008
    ds_read_u16_d16_hi v211, v7 offset:23280
    ds_read_u16_d16_hi v196, v7 offset:5376
    ds_read_u16_d16_hi v212, v7 offset:27648
    ds_read_u16_d16_hi v197, v7 offset:5712
    ds_read_u16_d16_hi v213, v7 offset:27984
    ds_read_u16_d16_hi v198, v7 offset:6048
    ds_read_u16_d16_hi v214, v7 offset:28320
    ds_read_u16_d16_hi v199, v7 offset:6384
    ds_read_u16_d16_hi v215, v7 offset:28656
    ds_read_u16_d16_hi v200, v7 offset:10752
    ds_read_u16_d16_hi v216, v7 offset:33024
    ds_read_u16_d16_hi v201, v7 offset:11088
    ds_read_u16_d16_hi v217, v7 offset:33360
    ds_read_u16_d16_hi v202, v7 offset:11424
    ds_read_u16_d16_hi v218, v7 offset:33696
    ds_read_u16_d16_hi v203, v7 offset:11760
    ds_read_u16_d16_hi v219, v7 offset:34032
    ds_read_u16_d16_hi v204, v7 offset:16128
    ds_read_u16_d16_hi v220, v7 offset:38400
    ds_read_u16_d16_hi v205, v7 offset:16464
    ds_read_u16_d16_hi v221, v7 offset:38736
    ds_read_u16_d16_hi v206, v7 offset:16800
    ds_read_u16_d16_hi v222, v7 offset:39072
    ds_read_u16_d16_hi v207, v7 offset:17136
    ds_read_u16_d16_hi v223, v7 offset:39408
    ds_read_u16_d16_hi v224, v7 offset:64
    ds_read_u16_d16_hi v240, v7 offset:22336
    ds_read_u16_d16_hi v225, v7 offset:400
    ds_read_u16_d16_hi v241, v7 offset:22672
    ds_read_u16_d16_hi v226, v7 offset:736
    ds_read_u16_d16_hi v242, v7 offset:23008
    ds_read_u16_d16_hi v227, v7 offset:1072
    ds_read_u16_d16_hi v243, v7 offset:23344
    ds_read_u16_d16_hi v228, v7 offset:5440
    ds_read_u16_d16_hi v244, v7 offset:27712
    ds_read_u16_d16_hi v229, v7 offset:5776
    ds_read_u16_d16_hi v245, v7 offset:28048
    ds_read_u16_d16_hi v230, v7 offset:6112
    ds_read_u16_d16_hi v246, v7 offset:28384
    ds_read_u16_d16_hi v231, v7 offset:6448
    ds_read_u16_d16_hi v247, v7 offset:28720
    ds_read_u16_d16_hi v232, v7 offset:10816
    ds_read_u16_d16_hi v248, v7 offset:33088
    ds_read_u16_d16_hi v233, v7 offset:11152
    ds_read_u16_d16_hi v249, v7 offset:33424
    ds_read_u16_d16_hi v234, v7 offset:11488
    ds_read_u16_d16_hi v250, v7 offset:33760
    ds_read_u16_d16_hi v235, v7 offset:11824
    ds_read_u16_d16_hi v251, v7 offset:34096
    ds_read_u16_d16_hi v236, v7 offset:16192
    ds_read_u16_d16_hi v252, v7 offset:38464
    ds_read_u16_d16_hi v237, v7 offset:16528
    ds_read_u16_d16_hi v253, v7 offset:38800
    ds_read_u16_d16_hi v238, v7 offset:16864
    ds_read_u16_d16_hi v254, v7 offset:39136
    ds_read_u16_d16_hi v239, v7 offset:17200
    ds_read_u16_d16_hi v255, v7 offset:39472
    s_waitcnt vmcnt(8)
    ds_read_b64_tr_b16 v[16:17], v2 offset:0
    ds_read_b64_tr_b16 v[18:19], v2 offset:2048
    ds_read_b64_tr_b16 v[20:21], v8 offset:0
    ds_read_b64_tr_b16 v[22:23], v8 offset:2048
    ds_read_b64_tr_b16 v[24:25], v2 offset:8
    ds_read_b64_tr_b16 v[26:27], v2 offset:2056
    ds_read_b64_tr_b16 v[28:29], v8 offset:8
    ds_read_b64_tr_b16 v[30:31], v8 offset:2056
    s_waitcnt lgkmcnt(0)
    v_xor_b32 v32, 0x80008000, v24
    v_xor_b32 v33, 0x80008000, v25
    v_xor_b32 v34, 0x80008000, v26
    v_xor_b32 v35, 0x80008000, v27
    v_xor_b32 v36, 0x80008000, v28
    v_xor_b32 v37, 0x80008000, v29
    v_xor_b32 v38, 0x80008000, v30
    v_xor_b32 v39, 0x80008000, v31
    v_mfma_f32_16x16x32_bf16 v[128:131], v[64:67], v[16:19], 0
    ds_read_b64_tr_b16 v[40:41], v4 offset:0
    v_mfma_f32_16x16x32_bf16 v[144:147], v[80:83], v[16:19], 0
    v_mfma_f32_16x16x32_bf16 v[136:139], v[68:71], v[20:23], 0
    ds_read_b64_tr_b16 v[42:43], v4 offset:2048
    v_mfma_f32_16x16x32_bf16 v[152:155], v[84:87], v[20:23], 0
    v_mfma_f32_16x16x32_bf16 v[128:131], v[80:83], v[32:35], v[128:131]
    ds_read_b64_tr_b16 v[44:45], v9 offset:0
    v_mfma_f32_16x16x32_bf16 v[144:147], v[64:67], v[24:27], v[144:147]
    v_mfma_f32_16x16x32_bf16 v[136:139], v[84:87], v[36:39], v[136:139]
    ds_read_b64_tr_b16 v[46:47], v9 offset:2048
    v_mfma_f32_16x16x32_bf16 v[152:155], v[68:71], v[28:31], v[152:155]
    v_mfma_f32_16x16x32_bf16 v[132:135], v[72:75], v[16:19], 0
    ds_read_b64_tr_b16 v[48:49], v4 offset:8
    v_mfma_f32_16x16x32_bf16 v[148:151], v[88:91], v[16:19], 0
    v_mfma_f32_16x16x32_bf16 v[140:143], v[76:79], v[20:23], 0
    ds_read_b64_tr_b16 v[50:51], v4 offset:2056
    v_mfma_f32_16x16x32_bf16 v[156:159], v[92:95], v[20:23], 0
    v_mfma_f32_16x16x32_bf16 v[132:135], v[88:91], v[32:35], v[132:135]
    ds_read_b64_tr_b16 v[52:53], v9 offset:8
    v_mfma_f32_16x16x32_bf16 v[148:151], v[72:75], v[24:27], v[148:151]
    v_mfma_f32_16x16x32_bf16 v[140:143], v[92:95], v[36:39], v[140:143]
    ds_read_b64_tr_b16 v[54:55], v9 offset:2056
    v_mfma_f32_16x16x32_bf16 v[156:159], v[76:79], v[28:31], v[156:159]
    s_waitcnt lgkmcnt(0)
    v_xor_b32 v56, 0x80008000, v48
    v_xor_b32 v57, 0x80008000, v49
    v_xor_b32 v58, 0x80008000, v50
    v_xor_b32 v59, 0x80008000, v51
    v_xor_b32 v60, 0x80008000, v52
    v_xor_b32 v61, 0x80008000, v53
    v_xor_b32 v62, 0x80008000, v54
    v_xor_b32 v63, 0x80008000, v55
    v_pk_add_f32 v[128:129], v[128:129], v[136:137]
    v_pk_add_f32 v[130:131], v[130:131], v[138:139]
    v_pk_add_f32 v[144:145], v[144:145], v[152:153]
    v_pk_add_f32 v[146:147], v[146:147], v[154:155]
    v_pk_fma_f32 v[136:137], v[136:137], 2.0, v[128:129] op_sel_hi:[1,0,1] neg_lo:[1,0,0] neg_hi:[1,0,0]
    v_pk_fma_f32 v[138:139], v[138:139], 2.0, v[130:131] op_sel_hi:[1,0,1] neg_lo:[1,0,0] neg_hi:[1,0,0]
    v_pk_fma_f32 v[152:153], v[152:153], 2.0, v[144:145] op_sel_hi:[1,0,1] neg_lo:[1,0,0] neg_hi:[1,0,0]
    v_pk_fma_f32 v[154:155], v[154:155], 2.0, v[146:147] op_sel_hi:[1,0,1] neg_lo:[1,0,0] neg_hi:[1,0,0]
    v_pk_add_f32 v[132:133], v[132:133], v[140:141]
    v_pk_add_f32 v[134:135], v[134:135], v[142:143]
    v_pk_add_f32 v[148:149], v[148:149], v[156:157]
    v_pk_add_f32 v[150:151], v[150:151], v[158:159]
    v_pk_fma_f32 v[140:141], v[140:141], 2.0, v[132:133] op_sel_hi:[1,0,1] neg_lo:[1,0,0] neg_hi:[1,0,0]
    v_pk_fma_f32 v[142:143], v[142:143], 2.0, v[134:135] op_sel_hi:[1,0,1] neg_lo:[1,0,0] neg_hi:[1,0,0]
    v_pk_fma_f32 v[156:157], v[156:157], 2.0, v[148:149] op_sel_hi:[1,0,1] neg_lo:[1,0,0] neg_hi:[1,0,0]
    v_pk_fma_f32 v[158:159], v[158:159], 2.0, v[150:151] op_sel_hi:[1,0,1] neg_lo:[1,0,0] neg_hi:[1,0,0]
    v_pk_mul_f32 v[12:13], v[144:145], v[208:209]
    v_pk_mul_f32 v[8:9], v[146:147], v[210:211]
    v_pk_mul_f32 v[208:209], v[128:129], v[208:209]
    v_pk_mul_f32 v[210:211], v[130:131], v[210:211]
    v_pk_fma_f32 v[208:209], v[144:145], v[192:193], v[208:209]
    v_pk_fma_f32 v[210:211], v[146:147], v[194:195], v[210:211]
    v_pk_fma_f32 v[192:193], v[128:129], v[192:193], v[12:13] neg_lo:[0,0,1] neg_hi:[0,0,1]
    v_pk_fma_f32 v[194:195], v[130:131], v[194:195], v[8:9] neg_lo:[0,0,1] neg_hi:[0,0,1]
    v_pk_mul_f32 v[12:13], v[148:149], v[212:213]
    v_pk_mul_f32 v[8:9], v[150:151], v[214:215]
    v_pk_mul_f32 v[212:213], v[132:133], v[212:213]
    v_pk_mul_f32 v[214:215], v[134:135], v[214:215]
    v_pk_fma_f32 v[212:213], v[148:149], v[196:197], v[212:213]
    v_pk_fma_f32 v[214:215], v[150:151], v[198:199], v[214:215]
    v_pk_fma_f32 v[196:197], v[132:133], v[196:197], v[12:13] neg_lo:[0,0,1] neg_hi:[0,0,1]
    v_pk_fma_f32 v[198:199], v[134:135], v[198:199], v[8:9] neg_lo:[0,0,1] neg_hi:[0,0,1]
    v_pk_mul_f32 v[12:13], v[152:153], v[216:217]
    v_pk_mul_f32 v[8:9], v[154:155], v[218:219]
    v_pk_mul_f32 v[216:217], v[136:137], v[216:217]
    v_pk_mul_f32 v[218:219], v[138:139], v[218:219]
    v_pk_fma_f32 v[216:217], v[152:153], v[200:201], v[216:217]
    v_pk_fma_f32 v[218:219], v[154:155], v[202:203], v[218:219]
    v_pk_fma_f32 v[200:201], v[136:137], v[200:201], v[12:13] neg_lo:[0,0,1] neg_hi:[0,0,1]
    v_pk_fma_f32 v[202:203], v[138:139], v[202:203], v[8:9] neg_lo:[0,0,1] neg_hi:[0,0,1]
    v_pk_mul_f32 v[12:13], v[156:157], v[220:221]
    v_pk_mul_f32 v[8:9], v[158:159], v[222:223]
    v_pk_mul_f32 v[220:221], v[140:141], v[220:221]
    v_pk_mul_f32 v[222:223], v[142:143], v[222:223]
    v_pk_fma_f32 v[220:221], v[156:157], v[204:205], v[220:221]
    v_pk_fma_f32 v[222:223], v[158:159], v[206:207], v[222:223]
    v_pk_fma_f32 v[204:205], v[140:141], v[204:205], v[12:13] neg_lo:[0,0,1] neg_hi:[0,0,1]
    v_pk_fma_f32 v[206:207], v[142:143], v[206:207], v[8:9] neg_lo:[0,0,1] neg_hi:[0,0,1]
    v_mfma_f32_16x16x32_bf16 v[160:163], v[64:67], v[40:43], 0
    v_cvt_pk_bf16_f32 v24, v208, v210
    v_mfma_f32_16x16x32_bf16 v[176:179], v[80:83], v[40:43], 0
    v_cvt_pk_bf16_f32 v16, v192, v194
    v_mfma_f32_16x16x32_bf16 v[168:171], v[68:71], v[44:47], 0
    v_cvt_pk_bf16_f32 v28, v209, v211
    v_cvt_pk_bf16_f32 v20, v193, v195
    v_mfma_f32_16x16x32_bf16 v[184:187], v[84:87], v[44:47], 0
    v_xor_b32 v32, 0x80008000, v16
    v_mfma_f32_16x16x32_bf16 v[160:163], v[80:83], v[56:59], v[160:163]
    v_xor_b32 v36, 0x80008000, v20
    v_cvt_pk_bf16_f32 v25, v212, v214
    v_mfma_f32_16x16x32_bf16 v[176:179], v[64:67], v[48:51], v[176:179]
    v_cvt_pk_bf16_f32 v17, v196, v198
    v_cvt_pk_bf16_f32 v29, v213, v215
    v_mfma_f32_16x16x32_bf16 v[168:171], v[84:87], v[60:63], v[168:171]
    v_cvt_pk_bf16_f32 v21, v197, v199
    v_mfma_f32_16x16x32_bf16 v[184:187], v[68:71], v[52:55], v[184:187]
    v_xor_b32 v33, 0x80008000, v17
    v_xor_b32 v37, 0x80008000, v21
    v_mfma_f32_16x16x32_bf16 v[164:167], v[72:75], v[40:43], 0
    v_cvt_pk_bf16_f32 v26, v216, v218
    v_mfma_f32_16x16x32_bf16 v[180:183], v[88:91], v[40:43], 0
    v_cvt_pk_bf16_f32 v18, v200, v202
    v_cvt_pk_bf16_f32 v30, v217, v219
    v_mfma_f32_16x16x32_bf16 v[172:175], v[76:79], v[44:47], 0
    v_cvt_pk_bf16_f32 v22, v201, v203
    v_xor_b32 v34, 0x80008000, v18
    v_mfma_f32_16x16x32_bf16 v[188:191], v[92:95], v[44:47], 0
    v_xor_b32 v38, 0x80008000, v22
    v_mfma_f32_16x16x32_bf16 v[164:167], v[88:91], v[56:59], v[164:167]
    v_cvt_pk_bf16_f32 v27, v220, v222
    v_cvt_pk_bf16_f32 v19, v204, v206
    v_mfma_f32_16x16x32_bf16 v[180:183], v[72:75], v[48:51], v[180:183]
    v_cvt_pk_bf16_f32 v31, v221, v223
    v_mfma_f32_16x16x32_bf16 v[172:175], v[92:95], v[60:63], v[172:175]
    v_cvt_pk_bf16_f32 v23, v205, v207
    v_xor_b32 v35, 0x80008000, v19
    v_mfma_f32_16x16x32_bf16 v[188:191], v[76:79], v[52:55], v[188:191]
    v_xor_b32 v39, 0x80008000, v23
    s_waitcnt lgkmcnt(0)
    s_nop 6
    v_pk_add_f32 v[160:161], v[160:161], v[168:169]
    v_pk_add_f32 v[162:163], v[162:163], v[170:171]
    v_pk_add_f32 v[176:177], v[176:177], v[184:185]
    v_pk_add_f32 v[178:179], v[178:179], v[186:187]
    v_pk_fma_f32 v[168:169], v[168:169], 2.0, v[160:161] op_sel_hi:[1,0,1] neg_lo:[1,0,0] neg_hi:[1,0,0]
    v_pk_fma_f32 v[170:171], v[170:171], 2.0, v[162:163] op_sel_hi:[1,0,1] neg_lo:[1,0,0] neg_hi:[1,0,0]
    v_pk_fma_f32 v[184:185], v[184:185], 2.0, v[176:177] op_sel_hi:[1,0,1] neg_lo:[1,0,0] neg_hi:[1,0,0]
    v_pk_fma_f32 v[186:187], v[186:187], 2.0, v[178:179] op_sel_hi:[1,0,1] neg_lo:[1,0,0] neg_hi:[1,0,0]
    v_pk_add_f32 v[164:165], v[164:165], v[172:173]
    v_pk_add_f32 v[166:167], v[166:167], v[174:175]
    v_pk_add_f32 v[180:181], v[180:181], v[188:189]
    v_pk_add_f32 v[182:183], v[182:183], v[190:191]
    v_pk_fma_f32 v[172:173], v[172:173], 2.0, v[164:165] op_sel_hi:[1,0,1] neg_lo:[1,0,0] neg_hi:[1,0,0]
    v_pk_fma_f32 v[174:175], v[174:175], 2.0, v[166:167] op_sel_hi:[1,0,1] neg_lo:[1,0,0] neg_hi:[1,0,0]
    v_pk_fma_f32 v[188:189], v[188:189], 2.0, v[180:181] op_sel_hi:[1,0,1] neg_lo:[1,0,0] neg_hi:[1,0,0]
    v_pk_fma_f32 v[190:191], v[190:191], 2.0, v[182:183] op_sel_hi:[1,0,1] neg_lo:[1,0,0] neg_hi:[1,0,0]
    v_pk_mul_f32 v[12:13], v[176:177], v[240:241]
    v_pk_mul_f32 v[8:9], v[178:179], v[242:243]
    v_pk_mul_f32 v[240:241], v[160:161], v[240:241]
    v_pk_mul_f32 v[242:243], v[162:163], v[242:243]
    v_pk_fma_f32 v[240:241], v[176:177], v[224:225], v[240:241]
    v_pk_fma_f32 v[242:243], v[178:179], v[226:227], v[242:243]
    v_pk_fma_f32 v[224:225], v[160:161], v[224:225], v[12:13] neg_lo:[0,0,1] neg_hi:[0,0,1]
    v_pk_fma_f32 v[226:227], v[162:163], v[226:227], v[8:9] neg_lo:[0,0,1] neg_hi:[0,0,1]
    v_pk_mul_f32 v[12:13], v[180:181], v[244:245]
    v_pk_mul_f32 v[8:9], v[182:183], v[246:247]
    v_pk_mul_f32 v[244:245], v[164:165], v[244:245]
    v_pk_mul_f32 v[246:247], v[166:167], v[246:247]
    v_pk_fma_f32 v[244:245], v[180:181], v[228:229], v[244:245]
    v_pk_fma_f32 v[246:247], v[182:183], v[230:231], v[246:247]
    v_pk_fma_f32 v[228:229], v[164:165], v[228:229], v[12:13] neg_lo:[0,0,1] neg_hi:[0,0,1]
    v_pk_fma_f32 v[230:231], v[166:167], v[230:231], v[8:9] neg_lo:[0,0,1] neg_hi:[0,0,1]
    v_pk_mul_f32 v[12:13], v[184:185], v[248:249]
    v_pk_mul_f32 v[8:9], v[186:187], v[250:251]
    v_pk_mul_f32 v[248:249], v[168:169], v[248:249]
    v_pk_mul_f32 v[250:251], v[170:171], v[250:251]
    v_pk_fma_f32 v[248:249], v[184:185], v[232:233], v[248:249]
    v_pk_fma_f32 v[250:251], v[186:187], v[234:235], v[250:251]
    v_pk_fma_f32 v[232:233], v[168:169], v[232:233], v[12:13] neg_lo:[0,0,1] neg_hi:[0,0,1]
    v_pk_fma_f32 v[234:235], v[170:171], v[234:235], v[8:9] neg_lo:[0,0,1] neg_hi:[0,0,1]
    v_pk_mul_f32 v[12:13], v[188:189], v[252:253]
    v_pk_mul_f32 v[8:9], v[190:191], v[254:255]
    v_pk_mul_f32 v[252:253], v[172:173], v[252:253]
    v_pk_mul_f32 v[254:255], v[174:175], v[254:255]
    v_pk_fma_f32 v[252:253], v[188:189], v[236:237], v[252:253]
    v_pk_fma_f32 v[254:255], v[190:191], v[238:239], v[254:255]
    v_pk_fma_f32 v[236:237], v[172:173], v[236:237], v[12:13] neg_lo:[0,0,1] neg_hi:[0,0,1]
    v_pk_fma_f32 v[238:239], v[174:175], v[238:239], v[8:9] neg_lo:[0,0,1] neg_hi:[0,0,1]
    v_mfma_f32_16x16x32_bf16 v[128:131], v[16:19], v[64:67], 0
    v_cvt_pk_bf16_f32 v48, v240, v242
    v_mfma_f32_16x16x32_bf16 v[144:147], v[24:27], v[64:67], 0
    v_cvt_pk_bf16_f32 v40, v224, v226
    v_mfma_f32_16x16x32_bf16 v[136:139], v[20:23], v[68:71], 0
    v_cvt_pk_bf16_f32 v52, v241, v243
    v_cvt_pk_bf16_f32 v44, v225, v227
    v_mfma_f32_16x16x32_bf16 v[152:155], v[28:31], v[68:71], 0
    v_xor_b32 v56, 0x80008000, v40
    v_mfma_f32_16x16x32_bf16 v[128:131], v[24:27], v[80:83], v[128:131]
    v_xor_b32 v60, 0x80008000, v44
    v_cvt_pk_bf16_f32 v49, v244, v246
    v_mfma_f32_16x16x32_bf16 v[144:147], v[32:35], v[80:83], v[144:147]
    v_cvt_pk_bf16_f32 v41, v228, v230
    v_cvt_pk_bf16_f32 v53, v245, v247
    v_mfma_f32_16x16x32_bf16 v[136:139], v[28:31], v[84:87], v[136:139]
    v_cvt_pk_bf16_f32 v45, v229, v231
    v_mfma_f32_16x16x32_bf16 v[152:155], v[36:39], v[84:87], v[152:155]
    v_xor_b32 v57, 0x80008000, v41
    v_xor_b32 v61, 0x80008000, v45
    v_mfma_f32_16x16x32_bf16 v[132:135], v[16:19], v[72:75], 0
    v_cvt_pk_bf16_f32 v50, v248, v250
    v_mfma_f32_16x16x32_bf16 v[148:151], v[24:27], v[72:75], 0
    v_cvt_pk_bf16_f32 v42, v232, v234
    v_cvt_pk_bf16_f32 v54, v249, v251
    v_mfma_f32_16x16x32_bf16 v[140:143], v[20:23], v[76:79], 0
    v_cvt_pk_bf16_f32 v46, v233, v235
    v_xor_b32 v58, 0x80008000, v42
    v_mfma_f32_16x16x32_bf16 v[156:159], v[28:31], v[76:79], 0
    v_xor_b32 v62, 0x80008000, v46
    v_mfma_f32_16x16x32_bf16 v[132:135], v[24:27], v[88:91], v[132:135]
    v_cvt_pk_bf16_f32 v51, v252, v254
    v_cvt_pk_bf16_f32 v43, v236, v238
    v_mfma_f32_16x16x32_bf16 v[148:151], v[32:35], v[88:91], v[148:151]
    v_cvt_pk_bf16_f32 v55, v253, v255
    v_mfma_f32_16x16x32_bf16 v[140:143], v[28:31], v[92:95], v[140:143]
    v_cvt_pk_bf16_f32 v47, v237, v239
    v_xor_b32 v59, 0x80008000, v43
    v_mfma_f32_16x16x32_bf16 v[156:159], v[36:39], v[92:95], v[156:159]
    v_xor_b32 v63, 0x80008000, v47
    s_nop 6
    v_pk_add_f32 v[128:129], v[128:129], v[136:137]
    v_pk_add_f32 v[130:131], v[130:131], v[138:139]
    v_pk_add_f32 v[144:145], v[144:145], v[152:153]
    v_pk_add_f32 v[146:147], v[146:147], v[154:155]
    v_pk_fma_f32 v[136:137], v[136:137], 2.0, v[128:129] op_sel_hi:[1,0,1] neg_lo:[1,0,0] neg_hi:[1,0,0]
    v_pk_fma_f32 v[138:139], v[138:139], 2.0, v[130:131] op_sel_hi:[1,0,1] neg_lo:[1,0,0] neg_hi:[1,0,0]
    v_pk_fma_f32 v[152:153], v[152:153], 2.0, v[144:145] op_sel_hi:[1,0,1] neg_lo:[1,0,0] neg_hi:[1,0,0]
    v_pk_fma_f32 v[154:155], v[154:155], 2.0, v[146:147] op_sel_hi:[1,0,1] neg_lo:[1,0,0] neg_hi:[1,0,0]
    v_pk_add_f32 v[132:133], v[132:133], v[140:141]
    v_pk_add_f32 v[134:135], v[134:135], v[142:143]
    v_pk_add_f32 v[148:149], v[148:149], v[156:157]
    v_pk_add_f32 v[150:151], v[150:151], v[158:159]
    v_pk_fma_f32 v[140:141], v[140:141], 2.0, v[132:133] op_sel_hi:[1,0,1] neg_lo:[1,0,0] neg_hi:[1,0,0]
    v_pk_fma_f32 v[142:143], v[142:143], 2.0, v[134:135] op_sel_hi:[1,0,1] neg_lo:[1,0,0] neg_hi:[1,0,0]
    v_pk_fma_f32 v[156:157], v[156:157], 2.0, v[148:149] op_sel_hi:[1,0,1] neg_lo:[1,0,0] neg_hi:[1,0,0]
    v_pk_fma_f32 v[158:159], v[158:159], 2.0, v[150:151] op_sel_hi:[1,0,1] neg_lo:[1,0,0] neg_hi:[1,0,0]
    v_mfma_f32_16x16x32_bf16 v[160:163], v[40:43], v[64:67], 0
    v_cvt_pk_bf16_f32 v128, v128, v129
    v_mfma_f32_16x16x32_bf16 v[176:179], v[48:51], v[64:67], 0
    v_cvt_pk_bf16_f32 v129, v130, v131
    v_mfma_f32_16x16x32_bf16 v[168:171], v[44:47], v[68:71], 0
    v_cvt_pk_bf16_f32 v130, v144, v145
    v_mfma_f32_16x16x32_bf16 v[184:187], v[52:55], v[68:71], 0
    v_cvt_pk_bf16_f32 v131, v146, v147
    buffer_store_dwordx4 v[128:131], v10, s[20:23], s51 offen offset:0 sc1
    v_mfma_f32_16x16x32_bf16 v[160:163], v[48:51], v[80:83], v[160:163]
    v_cvt_pk_bf16_f32 v132, v132, v133
    v_mfma_f32_16x16x32_bf16 v[176:179], v[56:59], v[80:83], v[176:179]
    v_cvt_pk_bf16_f32 v133, v134, v135
    v_mfma_f32_16x16x32_bf16 v[168:171], v[52:55], v[84:87], v[168:171]
    v_cvt_pk_bf16_f32 v134, v148, v149
    v_cvt_pk_bf16_f32 v135, v150, v151
    v_mfma_f32_16x16x32_bf16 v[184:187], v[60:63], v[84:87], v[184:187]
    buffer_store_dwordx4 v[132:135], v10, s[20:23], s51 offen offset:1024 sc1
    v_mfma_f32_16x16x32_bf16 v[164:167], v[40:43], v[72:75], 0
    v_cvt_pk_bf16_f32 v136, v136, v137
    v_mfma_f32_16x16x32_bf16 v[180:183], v[48:51], v[72:75], 0
    v_cvt_pk_bf16_f32 v137, v138, v139
    v_cvt_pk_bf16_f32 v138, v152, v153
    v_mfma_f32_16x16x32_bf16 v[172:175], v[44:47], v[76:79], 0
    v_cvt_pk_bf16_f32 v139, v154, v155
    v_mfma_f32_16x16x32_bf16 v[188:191], v[52:55], v[76:79], 0
    buffer_store_dwordx4 v[136:139], v10, s[20:23], s51 offen offset:2048 sc1
    v_mfma_f32_16x16x32_bf16 v[164:167], v[48:51], v[88:91], v[164:167]
    v_cvt_pk_bf16_f32 v140, v140, v141
    v_cvt_pk_bf16_f32 v141, v142, v143
    v_mfma_f32_16x16x32_bf16 v[180:183], v[56:59], v[88:91], v[180:183]
    v_cvt_pk_bf16_f32 v142, v156, v157
    v_mfma_f32_16x16x32_bf16 v[172:175], v[52:55], v[92:95], v[172:175]
    v_cvt_pk_bf16_f32 v143, v158, v159
    v_mfma_f32_16x16x32_bf16 v[188:191], v[60:63], v[92:95], v[188:191]
    buffer_store_dwordx4 v[140:143], v10, s[20:23], s51 offen offset:3072 sc1
    s_nop 7
    v_pk_add_f32 v[160:161], v[160:161], v[168:169]
    v_pk_add_f32 v[162:163], v[162:163], v[170:171]
    v_pk_add_f32 v[176:177], v[176:177], v[184:185]
    v_pk_add_f32 v[178:179], v[178:179], v[186:187]
    v_pk_fma_f32 v[168:169], v[168:169], 2.0, v[160:161] op_sel_hi:[1,0,1] neg_lo:[1,0,0] neg_hi:[1,0,0]
    v_pk_fma_f32 v[170:171], v[170:171], 2.0, v[162:163] op_sel_hi:[1,0,1] neg_lo:[1,0,0] neg_hi:[1,0,0]
    v_pk_fma_f32 v[184:185], v[184:185], 2.0, v[176:177] op_sel_hi:[1,0,1] neg_lo:[1,0,0] neg_hi:[1,0,0]
    v_pk_fma_f32 v[186:187], v[186:187], 2.0, v[178:179] op_sel_hi:[1,0,1] neg_lo:[1,0,0] neg_hi:[1,0,0]
    v_pk_add_f32 v[164:165], v[164:165], v[172:173]
    v_pk_add_f32 v[166:167], v[166:167], v[174:175]
    v_pk_add_f32 v[180:181], v[180:181], v[188:189]
    v_pk_add_f32 v[182:183], v[182:183], v[190:191]
    v_pk_fma_f32 v[172:173], v[172:173], 2.0, v[164:165] op_sel_hi:[1,0,1] neg_lo:[1,0,0] neg_hi:[1,0,0]
    v_pk_fma_f32 v[174:175], v[174:175], 2.0, v[166:167] op_sel_hi:[1,0,1] neg_lo:[1,0,0] neg_hi:[1,0,0]
    v_pk_fma_f32 v[188:189], v[188:189], 2.0, v[180:181] op_sel_hi:[1,0,1] neg_lo:[1,0,0] neg_hi:[1,0,0]
    v_pk_fma_f32 v[190:191], v[190:191], 2.0, v[182:183] op_sel_hi:[1,0,1] neg_lo:[1,0,0] neg_hi:[1,0,0]
    s_add_u32 s51, s51, 8192
    v_cvt_pk_bf16_f32 v160, v160, v161
    v_cvt_pk_bf16_f32 v161, v162, v163
    v_cvt_pk_bf16_f32 v162, v176, v177
    v_cvt_pk_bf16_f32 v163, v178, v179
    buffer_store_dwordx4 v[160:163], v10, s[20:23], s51 offen offset:0 sc1
    v_cvt_pk_bf16_f32 v164, v164, v165
    v_cvt_pk_bf16_f32 v165, v166, v167
    v_cvt_pk_bf16_f32 v166, v180, v181
    v_cvt_pk_bf16_f32 v167, v182, v183
    buffer_store_dwordx4 v[164:167], v10, s[20:23], s51 offen offset:1024 sc1
    v_cvt_pk_bf16_f32 v168, v168, v169
    v_cvt_pk_bf16_f32 v169, v170, v171
    v_cvt_pk_bf16_f32 v170, v184, v185
    v_cvt_pk_bf16_f32 v171, v186, v187
    buffer_store_dwordx4 v[168:171], v10, s[20:23], s51 offen offset:2048 sc1
    v_cvt_pk_bf16_f32 v172, v172, v173
    v_cvt_pk_bf16_f32 v173, v174, v175
    v_cvt_pk_bf16_f32 v174, v188, v189
    v_cvt_pk_bf16_f32 v175, v190, v191
    buffer_store_dwordx4 v[172:175], v10, s[20:23], s51 offen offset:3072 sc1
    s_branch L_midd_78
L_one_77:
    s_add_u32 m0, s56, 0
    s_add_u32 s48, s55, 6684672
    buffer_load_dwordx4 v15, s[20:23], s48 offen sc1 lds
    s_add_u32 m0, s56, 1024
    s_add_u32 s48, s55, 8065024
    buffer_load_dwordx4 v15, s[20:23], s48 offen sc1 lds
    s_add_u32 m0, s56, 2048
    s_add_u32 s48, s55, 6727808
    buffer_load_dwordx4 v15, s[20:23], s48 offen sc1 lds
    s_add_u32 m0, s56, 3072
    s_add_u32 s48, s55, 8108160
    buffer_load_dwordx4 v15, s[20:23], s48 offen sc1 lds
    v_mov_b32 v12, 149504
    v_mov_b32 v13, 1
    s_mov_b64 exec, 1
    ds_add_u32 v12, v13 offset:8
    s_mov_b64 exec, -1
    ds_read_u16_d16_hi v192, v7 offset:0
    ds_read_u16_d16_hi v208, v7 offset:22272
    ds_read_u16_d16_hi v193, v7 offset:336
    ds_read_u16_d16_hi v209, v7 offset:22608
    ds_read_u16_d16_hi v194, v7 offset:672
    ds_read_u16_d16_hi v210, v7 offset:22944
    ds_read_u16_d16_hi v195, v7 offset:1008
    ds_read_u16_d16_hi v211, v7 offset:23280
    ds_read_u16_d16_hi v196, v7 offset:5376
    ds_read_u16_d16_hi v212, v7 offset:27648
    ds_read_u16_d16_hi v197, v7 offset:5712
    ds_read_u16_d16_hi v213, v7 offset:27984
    ds_read_u16_d16_hi v198, v7 offset:6048
    ds_read_u16_d16_hi v214, v7 offset:28320
    ds_read_u16_d16_hi v199, v7 offset:6384
    ds_read_u16_d16_hi v215, v7 offset:28656
    ds_read_u16_d16_hi v200, v7 offset:10752
    ds_read_u16_d16_hi v216, v7 offset:33024
    ds_read_u16_d16_hi v201, v7 offset:11088
    ds_read_u16_d16_hi v217, v7 offset:33360
    ds_read_u16_d16_hi v202, v7 offset:11424
    ds_read_u16_d16_hi v218, v7 offset:33696
    ds_read_u16_d16_hi v203, v7 offset:11760
    ds_read_u16_d16_hi v219, v7 offset:34032
    ds_read_u16_d16_hi v204, v7 offset:16128
    ds_read_u16_d16_hi v220, v7 offset:38400
    ds_read_u16_d16_hi v205, v7 offset:16464
    ds_read_u16_d16_hi v221, v7 offset:38736
    ds_read_u16_d16_hi v206, v7 offset:16800
    ds_read_u16_d16_hi v222, v7 offset:39072
    ds_read_u16_d16_hi v207, v7 offset:17136
    ds_read_u16_d16_hi v223, v7 offset:39408
    s_waitcnt vmcnt(0)
    ds_read_b64_tr_b16 v[16:17], v6 offset:0
    ds_read_b64_tr_b16 v[18:19], v6 offset:1024
    ds_read_b64_tr_b16 v[20:21], v6 offset:2048
    ds_read_b64_tr_b16 v[22:23], v6 offset:3072
    ds_read_b64_tr_b16 v[24:25], v6 offset:8
    ds_read_b64_tr_b16 v[26:27], v6 offset:1032
    ds_read_b64_tr_b16 v[28:29], v6 offset:2056
    ds_read_b64_tr_b16 v[30:31], v6 offset:3080
    s_waitcnt lgkmcnt(0)
    v_xor_b32 v32, 0x80008000, v24
    v_xor_b32 v33, 0x80008000, v25
    v_xor_b32 v34, 0x80008000, v26
    v_xor_b32 v35, 0x80008000, v27
    v_xor_b32 v36, 0x80008000, v28
    v_xor_b32 v37, 0x80008000, v29
    v_xor_b32 v38, 0x80008000, v30
    v_xor_b32 v39, 0x80008000, v31
    s_nop 0
    v_mfma_f32_16x16x32_bf16 v[128:131], v[64:67], v[16:19], 0
    v_mfma_f32_16x16x32_bf16 v[144:147], v[80:83], v[16:19], 0
    v_mfma_f32_16x16x32_bf16 v[136:139], v[68:71], v[20:23], 0
    v_mfma_f32_16x16x32_bf16 v[152:155], v[84:87], v[20:23], 0
    v_mfma_f32_16x16x32_bf16 v[128:131], v[80:83], v[32:35], v[128:131]
    v_mfma_f32_16x16x32_bf16 v[144:147], v[64:67], v[24:27], v[144:147]
    v_mfma_f32_16x16x32_bf16 v[136:139], v[84:87], v[36:39], v[136:139]
    v_mfma_f32_16x16x32_bf16 v[152:155], v[68:71], v[28:31], v[152:155]
    v_mfma_f32_16x16x32_bf16 v[132:135], v[72:75], v[16:19], 0
    v_mfma_f32_16x16x32_bf16 v[148:151], v[88:91], v[16:19], 0
    v_mfma_f32_16x16x32_bf16 v[140:143], v[76:79], v[20:23], 0
    v_mfma_f32_16x16x32_bf16 v[156:159], v[92:95], v[20:23], 0
    v_mfma_f32_16x16x32_bf16 v[132:135], v[88:91], v[32:35], v[132:135]
    v_mfma_f32_16x16x32_bf16 v[148:151], v[72:75], v[24:27], v[148:151]
    v_mfma_f32_16x16x32_bf16 v[140:143], v[92:95], v[36:39], v[140:143]
    v_mfma_f32_16x16x32_bf16 v[156:159], v[76:79], v[28:31], v[156:159]
    s_waitcnt lgkmcnt(0)
    s_nop 6
    v_pk_add_f32 v[128:129], v[128:129], v[136:137]
    v_pk_add_f32 v[130:131], v[130:131], v[138:139]
    v_pk_add_f32 v[144:145], v[144:145], v[152:153]
    v_pk_add_f32 v[146:147], v[146:147], v[154:155]
    v_pk_fma_f32 v[136:137], v[136:137], 2.0, v[128:129] op_sel_hi:[1,0,1] neg_lo:[1,0,0] neg_hi:[1,0,0]
    v_pk_fma_f32 v[138:139], v[138:139], 2.0, v[130:131] op_sel_hi:[1,0,1] neg_lo:[1,0,0] neg_hi:[1,0,0]
    v_pk_fma_f32 v[152:153], v[152:153], 2.0, v[144:145] op_sel_hi:[1,0,1] neg_lo:[1,0,0] neg_hi:[1,0,0]
    v_pk_fma_f32 v[154:155], v[154:155], 2.0, v[146:147] op_sel_hi:[1,0,1] neg_lo:[1,0,0] neg_hi:[1,0,0]
    v_pk_add_f32 v[132:133], v[132:133], v[140:141]
    v_pk_add_f32 v[134:135], v[134:135], v[142:143]
    v_pk_add_f32 v[148:149], v[148:149], v[156:157]
    v_pk_add_f32 v[150:151], v[150:151], v[158:159]
    v_pk_fma_f32 v[140:141], v[140:141], 2.0, v[132:133] op_sel_hi:[1,0,1] neg_lo:[1,0,0] neg_hi:[1,0,0]
    v_pk_fma_f32 v[142:143], v[142:143], 2.0, v[134:135] op_sel_hi:[1,0,1] neg_lo:[1,0,0] neg_hi:[1,0,0]
    v_pk_fma_f32 v[156:157], v[156:157], 2.0, v[148:149] op_sel_hi:[1,0,1] neg_lo:[1,0,0] neg_hi:[1,0,0]
    v_pk_fma_f32 v[158:159], v[158:159], 2.0, v[150:151] op_sel_hi:[1,0,1] neg_lo:[1,0,0] neg_hi:[1,0,0]
    v_pk_mul_f32 v[12:13], v[144:145], v[208:209]
    v_pk_mul_f32 v[8:9], v[146:147], v[210:211]
    v_pk_mul_f32 v[208:209], v[128:129], v[208:209]
    v_pk_mul_f32 v[210:211], v[130:131], v[210:211]
    v_pk_fma_f32 v[208:209], v[144:145], v[192:193], v[208:209]
    v_pk_fma_f32 v[210:211], v[146:147], v[194:195], v[210:211]
    v_pk_fma_f32 v[192:193], v[128:129], v[192:193], v[12:13] neg_lo:[0,0,1] neg_hi:[0,0,1]
    v_pk_fma_f32 v[194:195], v[130:131], v[194:195], v[8:9] neg_lo:[0,0,1] neg_hi:[0,0,1]
    v_pk_mul_f32 v[12:13], v[148:149], v[212:213]
    v_pk_mul_f32 v[8:9], v[150:151], v[214:215]
    v_pk_mul_f32 v[212:213], v[132:133], v[212:213]
    v_pk_mul_f32 v[214:215], v[134:135], v[214:215]
    v_pk_fma_f32 v[212:213], v[148:149], v[196:197], v[212:213]
    v_pk_fma_f32 v[214:215], v[150:151], v[198:199], v[214:215]
    v_pk_fma_f32 v[196:197], v[132:133], v[196:197], v[12:13] neg_lo:[0,0,1] neg_hi:[0,0,1]
    v_pk_fma_f32 v[198:199], v[134:135], v[198:199], v[8:9] neg_lo:[0,0,1] neg_hi:[0,0,1]
    v_pk_mul_f32 v[12:13], v[152:153], v[216:217]
    v_pk_mul_f32 v[8:9], v[154:155], v[218:219]
    v_pk_mul_f32 v[216:217], v[136:137], v[216:217]
    v_pk_mul_f32 v[218:219], v[138:139], v[218:219]
    v_pk_fma_f32 v[216:217], v[152:153], v[200:201], v[216:217]
    v_pk_fma_f32 v[218:219], v[154:155], v[202:203], v[218:219]
    v_pk_fma_f32 v[200:201], v[136:137], v[200:201], v[12:13] neg_lo:[0,0,1] neg_hi:[0,0,1]
    v_pk_fma_f32 v[202:203], v[138:139], v[202:203], v[8:9] neg_lo:[0,0,1] neg_hi:[0,0,1]
    v_pk_mul_f32 v[12:13], v[156:157], v[220:221]
    v_pk_mul_f32 v[8:9], v[158:159], v[222:223]
    v_pk_mul_f32 v[220:221], v[140:141], v[220:221]
    v_pk_mul_f32 v[222:223], v[142:143], v[222:223]
    v_pk_fma_f32 v[220:221], v[156:157], v[204:205], v[220:221]
    v_pk_fma_f32 v[222:223], v[158:159], v[206:207], v[222:223]
    v_pk_fma_f32 v[204:205], v[140:141], v[204:205], v[12:13] neg_lo:[0,0,1] neg_hi:[0,0,1]
    v_pk_fma_f32 v[206:207], v[142:143], v[206:207], v[8:9] neg_lo:[0,0,1] neg_hi:[0,0,1]
    v_cvt_pk_bf16_f32 v24, v208, v210
    v_cvt_pk_bf16_f32 v16, v192, v194
    v_cvt_pk_bf16_f32 v28, v209, v211
    v_cvt_pk_bf16_f32 v20, v193, v195
    v_xor_b32 v32, 0x80008000, v16
    v_xor_b32 v36, 0x80008000, v20
    v_cvt_pk_bf16_f32 v25, v212, v214
    v_cvt_pk_bf16_f32 v17, v196, v198
    v_cvt_pk_bf16_f32 v29, v213, v215
    v_cvt_pk_bf16_f32 v21, v197, v199
    v_xor_b32 v33, 0x80008000, v17
    v_xor_b32 v37, 0x80008000, v21
    v_cvt_pk_bf16_f32 v26, v216, v218
    v_cvt_pk_bf16_f32 v18, v200, v202
    v_cvt_pk_bf16_f32 v30, v217, v219
    v_cvt_pk_bf16_f32 v22, v201, v203
    v_xor_b32 v34, 0x80008000, v18
    v_xor_b32 v38, 0x80008000, v22
    v_cvt_pk_bf16_f32 v27, v220, v222
    v_cvt_pk_bf16_f32 v19, v204, v206
    v_cvt_pk_bf16_f32 v31, v221, v223
    v_cvt_pk_bf16_f32 v23, v205, v207
    v_xor_b32 v35, 0x80008000, v19
    v_xor_b32 v39, 0x80008000, v23
    s_nop 1
    v_mfma_f32_16x16x32_bf16 v[128:131], v[16:19], v[64:67], 0
    v_mfma_f32_16x16x32_bf16 v[144:147], v[24:27], v[64:67], 0
    v_mfma_f32_16x16x32_bf16 v[136:139], v[20:23], v[68:71], 0
    v_mfma_f32_16x16x32_bf16 v[152:155], v[28:31], v[68:71], 0
    v_mfma_f32_16x16x32_bf16 v[128:131], v[24:27], v[80:83], v[128:131]
    v_mfma_f32_16x16x32_bf16 v[144:147], v[32:35], v[80:83], v[144:147]
    v_mfma_f32_16x16x32_bf16 v[136:139], v[28:31], v[84:87], v[136:139]
    v_mfma_f32_16x16x32_bf16 v[152:155], v[36:39], v[84:87], v[152:155]
    v_mfma_f32_16x16x32_bf16 v[132:135], v[16:19], v[72:75], 0
    v_mfma_f32_16x16x32_bf16 v[148:151], v[24:27], v[72:75], 0
    v_mfma_f32_16x16x32_bf16 v[140:143], v[20:23], v[76:79], 0
    v_mfma_f32_16x16x32_bf16 v[156:159], v[28:31], v[76:79], 0
    v_mfma_f32_16x16x32_bf16 v[132:135], v[24:27], v[88:91], v[132:135]
    v_mfma_f32_16x16x32_bf16 v[148:151], v[32:35], v[88:91], v[148:151]
    v_mfma_f32_16x16x32_bf16 v[140:143], v[28:31], v[92:95], v[140:143]
    v_mfma_f32_16x16x32_bf16 v[156:159], v[36:39], v[92:95], v[156:159]
    s_nop 7
    v_pk_add_f32 v[128:129], v[128:129], v[136:137]
    v_pk_add_f32 v[130:131], v[130:131], v[138:139]
    v_pk_add_f32 v[144:145], v[144:145], v[152:153]
    v_pk_add_f32 v[146:147], v[146:147], v[154:155]
    v_pk_fma_f32 v[136:137], v[136:137], 2.0, v[128:129] op_sel_hi:[1,0,1] neg_lo:[1,0,0] neg_hi:[1,0,0]
    v_pk_fma_f32 v[138:139], v[138:139], 2.0, v[130:131] op_sel_hi:[1,0,1] neg_lo:[1,0,0] neg_hi:[1,0,0]
    v_pk_fma_f32 v[152:153], v[152:153], 2.0, v[144:145] op_sel_hi:[1,0,1] neg_lo:[1,0,0] neg_hi:[1,0,0]
    v_pk_fma_f32 v[154:155], v[154:155], 2.0, v[146:147] op_sel_hi:[1,0,1] neg_lo:[1,0,0] neg_hi:[1,0,0]
    v_pk_add_f32 v[132:133], v[132:133], v[140:141]
    v_pk_add_f32 v[134:135], v[134:135], v[142:143]
    v_pk_add_f32 v[148:149], v[148:149], v[156:157]
    v_pk_add_f32 v[150:151], v[150:151], v[158:159]
    v_pk_fma_f32 v[140:141], v[140:141], 2.0, v[132:133] op_sel_hi:[1,0,1] neg_lo:[1,0,0] neg_hi:[1,0,0]
    v_pk_fma_f32 v[142:143], v[142:143], 2.0, v[134:135] op_sel_hi:[1,0,1] neg_lo:[1,0,0] neg_hi:[1,0,0]
    v_pk_fma_f32 v[156:157], v[156:157], 2.0, v[148:149] op_sel_hi:[1,0,1] neg_lo:[1,0,0] neg_hi:[1,0,0]
    v_pk_fma_f32 v[158:159], v[158:159], 2.0, v[150:151] op_sel_hi:[1,0,1] neg_lo:[1,0,0] neg_hi:[1,0,0]
    v_cvt_pk_bf16_f32 v128, v128, v129
    v_cvt_pk_bf16_f32 v129, v130, v131
    v_cvt_pk_bf16_f32 v130, v144, v145
    v_cvt_pk_bf16_f32 v131, v146, v147
    buffer_store_dwordx4 v[128:131], v10, s[20:23], s51 offen offset:0 sc1
    v_cvt_pk_bf16_f32 v132, v132, v133
    v_cvt_pk_bf16_f32 v133, v134, v135
    v_cvt_pk_bf16_f32 v134, v148, v149
    v_cvt_pk_bf16_f32 v135, v150, v151
    buffer_store_dwordx4 v[132:135], v10, s[20:23], s51 offen offset:1024 sc1
    v_cvt_pk_bf16_f32 v136, v136, v137
    v_cvt_pk_bf16_f32 v137, v138, v139
    v_cvt_pk_bf16_f32 v138, v152, v153
    v_cvt_pk_bf16_f32 v139, v154, v155
    buffer_store_dwordx4 v[136:139], v10, s[20:23], s51 offen offset:2048 sc1
    v_cvt_pk_bf16_f32 v140, v140, v141
    v_cvt_pk_bf16_f32 v141, v142, v143
    v_cvt_pk_bf16_f32 v142, v156, v157
    v_cvt_pk_bf16_f32 v143, v158, v159
    buffer_store_dwordx4 v[140:143], v10, s[20:23], s51 offen offset:3072 sc1
L_midd_78:
    s_cmp_ge_u32 s44, 4
    s_cbranch_scc1 L_dft_l2
    v_lshlrev_b32 v1, 4, v0
    s_add_u32 s48, s44, 0
    s_bfe_u32 s49, s48, 0x10001
    s_mul_i32 s49, s49, 98304
    s_and_b32 s48, s48, 1
    s_lshl_b32 s48, s48, 10
    s_add_u32 s48, s48, s49
    s_add_u32 s48, s48, s66
    s_add_u32 s50, s48, 393216
    s_add_u32 s48, s44, 1
    s_bfe_u32 s49, s48, 0x10001
    s_mul_i32 s49, s49, 98304
    s_and_b32 s48, s48, 1
    s_lshl_b32 s48, s48, 10
    s_add_u32 s48, s48, s49
    s_add_u32 s48, s48, s66
    s_add_u32 s51, s48, 393216
    s_add_u32 s48, s44, 2
    s_bfe_u32 s49, s48, 0x10001
    s_mul_i32 s49, s49, 98304
    s_and_b32 s48, s48, 1
    s_lshl_b32 s48, s48, 10
    s_add_u32 s48, s48, s49
    s_add_u32 s48, s48, s66
    s_add_u32 s52, s48, 393216
    s_add_u32 s48, s44, 3
    s_bfe_u32 s49, s48, 0x10001
    s_mul_i32 s49, s49, 98304
    s_and_b32 s48, s48, 1
    s_lshl_b32 s48, s48, 10
    s_add_u32 s48, s48, s49
    s_add_u32 s48, s48, s66
    s_add_u32 s53, s48, 393216
    s_and_b32 s82, s65, 3
    s_mul_i32 s82, s82, 0
    s_and_b32 s48, s64, 7
    s_mul_i32 s48, s48, 0
    s_add_u32 s82, s82, s48
    s_mov_b32 s79, 0
    s_lshl_b32 s48, s64, 1
    s_lshr_b32 s49, s44, 1
    s_add_u32 s48, s48, s49
    s_mul_i32 s48, s48, 12
    v_min_u32 v5, 11, v0
    v_add_u32 v5, s48, v5
    v_lshlrev_b32 v3, 7, v5
    s_mov_b32 s48, 0x10000
    buffer_load_dword v7, v3, s[20:23], s48 offen sc1
    s_waitcnt vmcnt(0)
L_eh1:
    s_barrier
    s_cmp_lg_u32 s44, 0
    s_cbranch_scc1 L_nofu
    s_lshl_b32 s59, s2, 7
    s_add_u32 s59, s59, 32768
    v_mov_b32 v12, s62
    v_mov_b32 v13, 0
    s_mov_b64 exec, 1
    buffer_store_dword v12, v13, s[20:23], s59 offen sc1
    s_mov_b64 exec, -1
L_nofu:
L_p3c:
    s_lshl_b32 s48, s64, 1
    s_lshr_b32 s49, s44, 1
    s_add_u32 s48, s48, s49
    s_mul_i32 s48, s48, 12
    v_min_u32 v5, 11, v0
    v_add_u32 v5, s48, v5
    v_lshlrev_b32 v3, 7, v5
    s_mul_i32 s48, s44, 20480
    s_add_u32 s48, s48, 65536
    v_add_u32 v4, s48, v1
    s_cmp_ge_u32 s2, 192
    s_cbranch_scc1 L_nofh_79
    v_mov_b32 v7, 149504
    v_mov_b32 v172, 1
    s_waitcnt vmcnt(0)
    v_mov_b32 v5, s62
    v_mov_b32 v6, 0
    s_mov_b64 exec, 1
    buffer_store_dword v5, v6, s[20:23], s59 offen sc1
    s_mov_b64 exec, -1
    s_mov_b64 exec, 1
    ds_add_u32 v7, v172 offset:4
    s_mov_b64 exec, -1
    s_mov_b32 s48, 0x10000
    buffer_load_dword v7, v3, s[20:23], s48 offen sc1
    s_waitcnt vmcnt(0)
L_nofh_79:
    s_lshl_b32 s48, s44, 2
    s_add_u32 s48, s48, 149520
    v_mov_b32 v5, s48
    v_cmp_ne_u32 vcc, s62, v7
    s_cbranch_vccnz L_hlate_80
L_hearly_82:
    s_mov_b32 s79, 1
    s_add_u32 s83, s82, 0
    s_cmp_ge_u32 s83, 12
    s_cselect_b32 s48, 12, 0
    s_sub_u32 s83, s83, s48
    s_lshl_b32 s83, s83, 12
    s_lshl_b32 s83, s83, 1
    s_add_u32 s48, s50, s83
    buffer_load_dwordx4 v[8:11], v1, s[20:23], s48 offen sc1
    s_add_u32 s48, s51, s83
    buffer_load_dwordx4 v[12:15], v1, s[20:23], s48 offen sc1
    s_add_u32 s48, s52, s83
    buffer_load_dwordx4 v[16:19], v1, s[20:23], s48 offen sc1
    s_add_u32 s48, s53, s83
    buffer_load_dwordx4 v[20:23], v1, s[20:23], s48 offen sc1
    s_add_u32 s83, s82, 1
    s_cmp_ge_u32 s83, 12
    s_cselect_b32 s48, 12, 0
    s_sub_u32 s83, s83, s48
    s_lshl_b32 s83, s83, 12
    s_lshl_b32 s83, s83, 1
    s_add_u32 s48, s50, s83
    buffer_load_dwordx4 v[24:27], v1, s[20:23], s48 offen sc1
    s_add_u32 s48, s51, s83
    buffer_load_dwordx4 v[28:31], v1, s[20:23], s48 offen sc1
    s_add_u32 s48, s52, s83
    buffer_load_dwordx4 v[32:35], v1, s[20:23], s48 offen sc1
    s_add_u32 s48, s53, s83
    buffer_load_dwordx4 v[36:39], v1, s[20:23], s48 offen sc1
    s_add_u32 s83, s82, 2
    s_cmp_ge_u32 s83, 12
    s_cselect_b32 s48, 12, 0
    s_sub_u32 s83, s83, s48
    s_lshl_b32 s83, s83, 12
    s_lshl_b32 s83, s83, 1
    s_add_u32 s48, s50, s83
    buffer_load_dwordx4 v[40:43], v1, s[20:23], s48 offen sc1
    s_add_u32 s48, s51, s83
    buffer_load_dwordx4 v[44:47], v1, s[20:23], s48 offen sc1
    s_add_u32 s48, s52, s83
    buffer_load_dwordx4 v[48:51], v1, s[20:23], s48 offen sc1
    s_add_u32 s48, s53, s83
    buffer_load_dwordx4 v[52:55], v1, s[20:23], s48 offen sc1
    s_add_u32 s83, s82, 3
    s_cmp_ge_u32 s83, 12
    s_cselect_b32 s48, 12, 0
    s_sub_u32 s83, s83, s48
    s_lshl_b32 s83, s83, 12
    s_lshl_b32 s83, s83, 1
    s_add_u32 s48, s50, s83
    buffer_load_dwordx4 v[56:59], v1, s[20:23], s48 offen sc1
    s_add_u32 s48, s51, s83
    buffer_load_dwordx4 v[60:63], v1, s[20:23], s48 offen sc1
    s_add_u32 s48, s52, s83
    buffer_load_dwordx4 v[64:67], v1, s[20:23], s48 offen sc1
    s_add_u32 s48, s53, s83
    buffer_load_dwordx4 v[68:71], v1, s[20:23], s48 offen sc1
    s_branch L_hjoin_81
L_hlate_80:
    s_mov_b32 s79, 0
    s_add_u32 s67, s82, 4
    s_cmp_ge_u32 s67, 12
    s_cselect_b32 s48, 12, 0
    s_sub_u32 s67, s67, s48
    s_lshl_b32 s67, s67, 12
    s_add_u32 s49, s67, s6
    s_add_u32 s48, s49, 0
    buffer_load_dwordx4 v[72:75], v1, s[20:23], s48 offen sc1
    s_add_u32 s48, s49, 49152
    buffer_load_dwordx4 v[76:79], v1, s[20:23], s48 offen sc1
    s_add_u32 s48, s49, 983040
    buffer_load_dwordx4 v[80:83], v1, s[20:23], s48 offen sc1
    s_add_u32 s48, s49, 1032192
    buffer_load_dwordx4 v[84:87], v1, s[20:23], s48 offen sc1
    s_add_u32 s48, s67, s75
    buffer_load_dwordx4 v[88:91], v1, s[20:23], s48 offen sc1
    s_add_u32 s67, s82, 5
    s_cmp_ge_u32 s67, 12
    s_cselect_b32 s48, 12, 0
    s_sub_u32 s67, s67, s48
    s_lshl_b32 s67, s67, 12
    s_add_u32 s49, s67, s6
    s_add_u32 s48, s49, 0
    buffer_load_dwordx4 v[92:95], v1, s[20:23], s48 offen sc1
    s_add_u32 s48, s49, 49152
    buffer_load_dwordx4 v[96:99], v1, s[20:23], s48 offen sc1
    s_add_u32 s48, s49, 983040
    buffer_load_dwordx4 v[100:103], v1, s[20:23], s48 offen sc1
    s_add_u32 s48, s49, 1032192
    buffer_load_dwordx4 v[104:107], v1, s[20:23], s48 offen sc1
    s_add_u32 s48, s67, s75
    buffer_load_dwordx4 v[108:111], v1, s[20:23], s48 offen sc1
    s_add_u32 s67, s82, 6
    s_cmp_ge_u32 s67, 12
    s_cselect_b32 s48, 12, 0
    s_sub_u32 s67, s67, s48
    s_lshl_b32 s67, s67, 12
    s_add_u32 s49, s67, s6
    s_add_u32 s48, s49, 0
    buffer_load_dwordx4 v[112:115], v1, s[20:23], s48 offen sc1
    s_add_u32 s48, s49, 49152
    buffer_load_dwordx4 v[116:119], v1, s[20:23], s48 offen sc1
    s_add_u32 s48, s49, 983040
    buffer_load_dwordx4 v[120:123], v1, s[20:23], s48 offen sc1
    s_add_u32 s48, s49, 1032192
    buffer_load_dwordx4 v[124:127], v1, s[20:23], s48 offen sc1
    s_add_u32 s48, s67, s75
    buffer_load_dwordx4 v[128:131], v1, s[20:23], s48 offen sc1
    s_add_u32 s67, s82, 7
    s_cmp_ge_u32 s67, 12
    s_cselect_b32 s48, 12, 0
    s_sub_u32 s67, s67, s48
    s_lshl_b32 s67, s67, 12
    s_add_u32 s49, s67, s6
    s_add_u32 s48, s49, 0
    buffer_load_dwordx4 v[132:135], v1, s[20:23], s48 offen sc1
    s_add_u32 s48, s49, 49152
    buffer_load_dwordx4 v[136:139], v1, s[20:23], s48 offen sc1
    s_add_u32 s48, s49, 983040
    buffer_load_dwordx4 v[140:143], v1, s[20:23], s48 offen sc1
    s_add_u32 s48, s49, 1032192
    buffer_load_dwordx4 v[144:147], v1, s[20:23], s48 offen sc1
    s_add_u32 s48, s67, s75
    buffer_load_dwordx4 v[148:151], v1, s[20:23], s48 offen sc1
    v_cmp_ne_u32 vcc, s62, v7
    s_cbranch_vccnz L_rare_83
L_back_84:
    s_add_u32 s83, s82, 0
    s_cmp_ge_u32 s83, 12
    s_cselect_b32 s48, 12, 0
    s_sub_u32 s83, s83, s48
    s_lshl_b32 s83, s83, 12
    s_lshl_b32 s83, s83, 1
    s_add_u32 s48, s50, s83
    buffer_load_dwordx4 v[8:11], v1, s[20:23], s48 offen sc1
    s_add_u32 s48, s51, s83
    buffer_load_dwordx4 v[12:15], v1, s[20:23], s48 offen sc1
    s_add_u32 s48, s52, s83
    buffer_load_dwordx4 v[16:19], v1, s[20:23], s48 offen sc1
    s_add_u32 s48, s53, s83
    buffer_load_dwordx4 v[20:23], v1, s[20:23], s48 offen sc1
    s_add_u32 s83, s82, 1
    s_cmp_ge_u32 s83, 12
    s_cselect_b32 s48, 12, 0
    s_sub_u32 s83, s83, s48
    s_lshl_b32 s83, s83, 12
    s_lshl_b32 s83, s83, 1
    s_add_u32 s48, s50, s83
    buffer_load_dwordx4 v[24:27], v1, s[20:23], s48 offen sc1
    s_add_u32 s48, s51, s83
    buffer_load_dwordx4 v[28:31], v1, s[20:23], s48 offen sc1
    s_add_u32 s48, s52, s83
    buffer_load_dwordx4 v[32:35], v1, s[20:23], s48 offen sc1
    s_add_u32 s48, s53, s83
    buffer_load_dwordx4 v[36:39], v1, s[20:23], s48 offen sc1
    s_add_u32 s83, s82, 2
    s_cmp_ge_u32 s83, 12
    s_cselect_b32 s48, 12, 0
    s_sub_u32 s83, s83, s48
    s_lshl_b32 s83, s83, 12
    s_lshl_b32 s83, s83, 1
    s_add_u32 s48, s50, s83
    buffer_load_dwordx4 v[40:43], v1, s[20:23], s48 offen sc1
    s_add_u32 s48, s51, s83
    buffer_load_dwordx4 v[44:47], v1, s[20:23], s48 offen sc1
    s_add_u32 s48, s52, s83
    buffer_load_dwordx4 v[48:51], v1, s[20:23], s48 offen sc1
    s_add_u32 s48, s53, s83
    buffer_load_dwordx4 v[52:55], v1, s[20:23], s48 offen sc1
    s_add_u32 s83, s82, 3
    s_cmp_ge_u32 s83, 12
    s_cselect_b32 s48, 12, 0
    s_sub_u32 s83, s83, s48
    s_lshl_b32 s83, s83, 12
    s_lshl_b32 s83, s83, 1
    s_add_u32 s48, s50, s83
    buffer_load_dwordx4 v[56:59], v1, s[20:23], s48 offen sc1
    s_add_u32 s48, s51, s83
    buffer_load_dwordx4 v[60:63], v1, s[20:23], s48 offen sc1
    s_add_u32 s48, s52, s83
    buffer_load_dwordx4 v[64:67], v1, s[20:23], s48 offen sc1
    s_add_u32 s48, s53, s83
    buffer_load_dwordx4 v[68:71], v1, s[20:23], s48 offen sc1
L_hjoin_81:
    s_cmp_ge_u32 s2, 192
    s_cbranch_scc1 L_wsk_88
L_wst_87:
    ds_read_b32 v6, v5
    s_waitcnt lgkmcnt(0)
    v_cmp_eq_u32 vcc, 0, v6
    s_cbranch_vccnz L_wst_87
L_wsk_88:
    ds_read_b128 v[152:155], v4 offset:0
    ds_read_b128 v[156:159], v4 offset:1024
    ds_read_b128 v[160:163], v4 offset:2048
    ds_read_b128 v[164:167], v4 offset:3072
    ds_read_b128 v[168:171], v4 offset:4096
    s_cmp_eq_u32 s79, 0
    s_cbranch_scc1 L_w3_89
    s_cmp_ge_u32 s2, 192
    s_cbranch_scc1 L_w3_91
    s_waitcnt vmcnt(12)
    s_branch L_w3_90
L_w3_91:
    s_waitcnt vmcnt(12)
    s_branch L_w3_90
L_w3_89:
    s_waitcnt vmcnt(12)
L_w3_90:
    s_waitcnt lgkmcnt(4)
    v_mfma_f32_16x16x32_bf16 v[176:179], v[152:155], v[8:11], 0
    v_mfma_f32_16x16x32_bf16 v[180:183], v[152:155], v[12:15], 0
    v_mfma_f32_16x16x32_bf16 v[184:187], v[152:155], v[16:19], 0
    v_mfma_f32_16x16x32_bf16 v[188:191], v[152:155], v[20:23], 0
    ds_read_b128 v[152:155], v4 offset:5120
    s_waitcnt lgkmcnt(4)
    v_mfma_f32_16x16x32_bf16 v[192:195], v[156:159], v[8:11], 0
    v_mfma_f32_16x16x32_bf16 v[196:199], v[156:159], v[12:15], 0
    v_mfma_f32_16x16x32_bf16 v[200:203], v[156:159], v[16:19], 0
    v_mfma_f32_16x16x32_bf16 v[204:207], v[156:159], v[20:23], 0
    ds_read_b128 v[156:159], v4 offset:6144
    s_waitcnt lgkmcnt(4)
    v_mfma_f32_16x16x32_bf16 v[208:211], v[160:163], v[8:11], 0
    v_mfma_f32_16x16x32_bf16 v[212:215], v[160:163], v[12:15], 0
    v_mfma_f32_16x16x32_bf16 v[216:219], v[160:163], v[16:19], 0
    v_mfma_f32_16x16x32_bf16 v[220:223], v[160:163], v[20:23], 0
    ds_read_b128 v[160:163], v4 offset:7168
    s_waitcnt lgkmcnt(4)
    v_mfma_f32_16x16x32_bf16 v[224:227], v[164:167], v[8:11], 0
    v_mfma_f32_16x16x32_bf16 v[228:231], v[164:167], v[12:15], 0
    v_mfma_f32_16x16x32_bf16 v[232:235], v[164:167], v[16:19], 0
    v_mfma_f32_16x16x32_bf16 v[236:239], v[164:167], v[20:23], 0
    ds_read_b128 v[164:167], v4 offset:8192
    s_waitcnt lgkmcnt(4)
    v_mfma_f32_16x16x32_bf16 v[240:243], v[168:171], v[8:11], 0
    v_mfma_f32_16x16x32_bf16 v[244:247], v[168:171], v[12:15], 0
    v_mfma_f32_16x16x32_bf16 v[248:251], v[168:171], v[16:19], 0
    v_mfma_f32_16x16x32_bf16 v[252:255], v[168:171], v[20:23], 0
    ds_read_b128 v[168:171], v4 offset:9216
    s_cmp_eq_u32 s79, 0
    s_cbranch_scc1 L_w4_92
    s_add_u32 s67, s82, 4
    s_cmp_ge_u32 s67, 12
    s_cselect_b32 s48, 12, 0
    s_sub_u32 s67, s67, s48
    s_lshl_b32 s67, s67, 12
    s_add_u32 s49, s67, s6
    s_add_u32 s48, s49, 0
    buffer_load_dwordx4 v[72:75], v1, s[20:23], s48 offen sc1
    s_add_u32 s48, s49, 49152
    buffer_load_dwordx4 v[76:79], v1, s[20:23], s48 offen sc1
    s_add_u32 s48, s49, 983040
    buffer_load_dwordx4 v[80:83], v1, s[20:23], s48 offen sc1
    s_add_u32 s48, s49, 1032192
    buffer_load_dwordx4 v[84:87], v1, s[20:23], s48 offen sc1
    s_add_u32 s48, s67, s75
    buffer_load_dwordx4 v[88:91], v1, s[20:23], s48 offen sc1
L_w4_92:
    s_add_u32 s83, s82, 4
    s_cmp_ge_u32 s83, 12
    s_cselect_b32 s48, 12, 0
    s_sub_u32 s83, s83, s48
    s_lshl_b32 s83, s83, 12
    s_lshl_b32 s83, s83, 1
    s_add_u32 s48, s50, s83
    buffer_load_dwordx4 v[8:11], v1, s[20:23], s48 offen sc1
    s_add_u32 s48, s51, s83
    buffer_load_dwordx4 v[12:15], v1, s[20:23], s48 offen sc1
    s_add_u32 s48, s52, s83
    buffer_load_dwordx4 v[16:19], v1, s[20:23], s48 offen sc1
    s_add_u32 s48, s53, s83
    buffer_load_dwordx4 v[20:23], v1, s[20:23], s48 offen sc1
    s_cmp_eq_u32 s79, 0
    s_cbranch_scc1 L_w3_93
    s_cmp_ge_u32 s2, 192
    s_cbranch_scc1 L_w3_95
    s_waitcnt vmcnt(17)
    s_branch L_w3_94
L_w3_95:
    s_waitcnt vmcnt(17)
    s_branch L_w3_94
L_w3_93:
    s_waitcnt vmcnt(12)
L_w3_94:
    s_waitcnt lgkmcnt(4)
    v_mfma_f32_16x16x32_bf16 v[176:179], v[152:155], v[24:27], v[176:179]
    v_mfma_f32_16x16x32_bf16 v[180:183], v[152:155], v[28:31], v[180:183]
    v_mfma_f32_16x16x32_bf16 v[184:187], v[152:155], v[32:35], v[184:187]
    v_mfma_f32_16x16x32_bf16 v[188:191], v[152:155], v[36:39], v[188:191]
    ds_read_b128 v[152:155], v4 offset:10240
    s_waitcnt lgkmcnt(4)
    v_mfma_f32_16x16x32_bf16 v[192:195], v[156:159], v[24:27], v[192:195]
    v_mfma_f32_16x16x32_bf16 v[196:199], v[156:159], v[28:31], v[196:199]
    v_mfma_f32_16x16x32_bf16 v[200:203], v[156:159], v[32:35], v[200:203]
    v_mfma_f32_16x16x32_bf16 v[204:207], v[156:159], v[36:39], v[204:207]
    ds_read_b128 v[156:159], v4 offset:11264
    s_waitcnt lgkmcnt(4)
    v_mfma_f32_16x16x32_bf16 v[208:211], v[160:163], v[24:27], v[208:211]
    v_mfma_f32_16x16x32_bf16 v[212:215], v[160:163], v[28:31], v[212:215]
    v_mfma_f32_16x16x32_bf16 v[216:219], v[160:163], v[32:35], v[216:219]
    v_mfma_f32_16x16x32_bf16 v[220:223], v[160:163], v[36:39], v[220:223]
    ds_read_b128 v[160:163], v4 offset:12288
    s_waitcnt lgkmcnt(4)
    v_mfma_f32_16x16x32_bf16 v[224:227], v[164:167], v[24:27], v[224:227]
    v_mfma_f32_16x16x32_bf16 v[228:231], v[164:167], v[28:31], v[228:231]
    v_mfma_f32_16x16x32_bf16 v[232:235], v[164:167], v[32:35], v[232:235]
    v_mfma_f32_16x16x32_bf16 v[236:239], v[164:167], v[36:39], v[236:239]
    ds_read_b128 v[164:167], v4 offset:13312
    s_waitcnt lgkmcnt(4)
    v_mfma_f32_16x16x32_bf16 v[240:243], v[168:171], v[24:27], v[240:243]
    v_mfma_f32_16x16x32_bf16 v[244:247], v[168:171], v[28:31], v[244:247]
    v_mfma_f32_16x16x32_bf16 v[248:251], v[168:171], v[32:35], v[248:251]
    v_mfma_f32_16x16x32_bf16 v[252:255], v[168:171], v[36:39], v[252:255]
    ds_read_b128 v[168:171], v4 offset:14336
    s_cmp_eq_u32 s79, 0
    s_cbranch_scc1 L_w4_96
    s_add_u32 s67, s82, 5
    s_cmp_ge_u32 s67, 12
    s_cselect_b32 s48, 12, 0
    s_sub_u32 s67, s67, s48
    s_lshl_b32 s67, s67, 12
    s_add_u32 s49, s67, s6
    s_add_u32 s48, s49, 0
    buffer_load_dwordx4 v[92:95], v1, s[20:23], s48 offen sc1
    s_cmp_ge_u32 s2, 192
    s_cbranch_scc1 L_w4_96
    s_add_u32 s48, s49, 49152
    buffer_load_dwordx4 v[96:99], v1, s[20:23], s48 offen sc1
    s_add_u32 s48, s49, 983040
    buffer_load_dwordx4 v[100:103], v1, s[20:23], s48 offen sc1
    s_add_u32 s48, s49, 1032192
    buffer_load_dwordx4 v[104:107], v1, s[20:23], s48 offen sc1
    s_add_u32 s48, s67, s75
    buffer_load_dwordx4 v[108:111], v1, s[20:23], s48 offen sc1
L_w4_96:
    s_add_u32 s83, s82, 5
    s_cmp_ge_u32 s83, 12
    s_cselect_b32 s48, 12, 0
    s_sub_u32 s83, s83, s48
    s_lshl_b32 s83, s83, 12
    s_lshl_b32 s83, s83, 1
    s_add_u32 s48, s50, s83
    buffer_load_dwordx4 v[24:27], v1, s[20:23], s48 offen sc1
    s_add_u32 s48, s51, s83
    buffer_load_dwordx4 v[28:31], v1, s[20:23], s48 offen sc1
    s_add_u32 s48, s52, s83
    buffer_load_dwordx4 v[32:35], v1, s[20:23], s48 offen sc1
    s_add_u32 s48, s53, s83
    buffer_load_dwordx4 v[36:39], v1, s[20:23], s48 offen sc1
    s_cmp_eq_u32 s79, 0
    s_cbranch_scc1 L_w3_97
    s_cmp_ge_u32 s2, 192
    s_cbranch_scc1 L_w3_99
    s_waitcnt vmcnt(22)
    s_branch L_w3_98
L_w3_99:
    s_waitcnt vmcnt(18)
    s_branch L_w3_98
L_w3_97:
    s_waitcnt vmcnt(12)
L_w3_98:
    s_cmp_ge_u32 s2, 192
    s_cbranch_scc0 L_wsk_101
L_wst_100:
    ds_read_b32 v6, v5
    s_waitcnt lgkmcnt(0)
    v_cmp_eq_u32 vcc, 0, v6
    s_cbranch_vccnz L_wst_100
L_wsk_101:
    s_waitcnt lgkmcnt(4)
    v_mfma_f32_16x16x32_bf16 v[176:179], v[152:155], v[40:43], v[176:179]
    v_mfma_f32_16x16x32_bf16 v[180:183], v[152:155], v[44:47], v[180:183]
    v_mfma_f32_16x16x32_bf16 v[184:187], v[152:155], v[48:51], v[184:187]
    v_mfma_f32_16x16x32_bf16 v[188:191], v[152:155], v[52:55], v[188:191]
    ds_read_b128 v[152:155], v4 offset:15360
    s_waitcnt lgkmcnt(4)
    v_mfma_f32_16x16x32_bf16 v[192:195], v[156:159], v[40:43], v[192:195]
    v_mfma_f32_16x16x32_bf16 v[196:199], v[156:159], v[44:47], v[196:199]
    v_mfma_f32_16x16x32_bf16 v[200:203], v[156:159], v[48:51], v[200:203]
    v_mfma_f32_16x16x32_bf16 v[204:207], v[156:159], v[52:55], v[204:207]
    ds_read_b128 v[156:159], v4 offset:16384
    s_waitcnt lgkmcnt(4)
    v_mfma_f32_16x16x32_bf16 v[208:211], v[160:163], v[40:43], v[208:211]
    v_mfma_f32_16x16x32_bf16 v[212:215], v[160:163], v[44:47], v[212:215]
    v_mfma_f32_16x16x32_bf16 v[216:219], v[160:163], v[48:51], v[216:219]
    v_mfma_f32_16x16x32_bf16 v[220:223], v[160:163], v[52:55], v[220:223]
    ds_read_b128 v[160:163], v4 offset:17408
    s_waitcnt lgkmcnt(4)
    v_mfma_f32_16x16x32_bf16 v[224:227], v[164:167], v[40:43], v[224:227]
    v_mfma_f32_16x16x32_bf16 v[228:231], v[164:167], v[44:47], v[228:231]
    v_mfma_f32_16x16x32_bf16 v[232:235], v[164:167], v[48:51], v[232:235]
    v_mfma_f32_16x16x32_bf16 v[236:239], v[164:167], v[52:55], v[236:239]
    ds_read_b128 v[164:167], v4 offset:18432
    s_waitcnt lgkmcnt(4)
    v_mfma_f32_16x16x32_bf16 v[240:243], v[168:171], v[40:43], v[240:243]
    v_mfma_f32_16x16x32_bf16 v[244:247], v[168:171], v[44:47], v[244:247]
    v_mfma_f32_16x16x32_bf16 v[248:251], v[168:171], v[48:51], v[248:251]
    v_mfma_f32_16x16x32_bf16 v[252:255], v[168:171], v[52:55], v[252:255]
    ds_read_b128 v[168:171], v4 offset:19456
    s_cmp_eq_u32 s79, 0
    s_cbranch_scc1 L_w4_102
    s_add_u32 s67, s82, 6
    s_cmp_ge_u32 s67, 12
    s_cselect_b32 s48, 12, 0
    s_sub_u32 s67, s67, s48
    s_lshl_b32 s67, s67, 12
    s_add_u32 s49, s67, s6
    s_add_u32 s48, s67, s75
    buffer_load_dwordx4 v[128:131], v1, s[20:23], s48 offen sc1
    s_cmp_ge_u32 s2, 192
    s_cbranch_scc1 L_w4_102
    s_add_u32 s48, s49, 0
    buffer_load_dwordx4 v[112:115], v1, s[20:23], s48 offen sc1
    s_add_u32 s48, s49, 49152
    buffer_load_dwordx4 v[116:119], v1, s[20:23], s48 offen sc1
    s_add_u32 s48, s49, 983040
    buffer_load_dwordx4 v[120:123], v1, s[20:23], s48 offen sc1
    s_add_u32 s48, s49, 1032192
    buffer_load_dwordx4 v[124:127], v1, s[20:23], s48 offen sc1
L_w4_102:
    s_add_u32 s83, s82, 6
    s_cmp_ge_u32 s83, 12
    s_cselect_b32 s48, 12, 0
    s_sub_u32 s83, s83, s48
    s_lshl_b32 s83, s83, 12
    s_lshl_b32 s83, s83, 1
    s_add_u32 s48, s50, s83
    buffer_load_dwordx4 v[40:43], v1, s[20:23], s48 offen sc1
    s_add_u32 s48, s51, s83
    buffer_load_dwordx4 v[44:47], v1, s[20:23], s48 offen sc1
    s_add_u32 s48, s52, s83
    buffer_load_dwordx4 v[48:51], v1, s[20:23], s48 offen sc1
    s_add_u32 s48, s53, s83
    buffer_load_dwordx4 v[52:55], v1, s[20:23], s48 offen sc1
    s_cmp_eq_u32 s79, 0
    s_cbranch_scc1 L_w3_103
    s_cmp_ge_u32 s2, 192
    s_cbranch_scc1 L_w3_105
    s_waitcnt vmcnt(27)
    s_branch L_w3_104
L_w3_105:
    s_waitcnt vmcnt(19)
    s_branch L_w3_104
L_w3_103:
    s_waitcnt vmcnt(12)
L_w3_104:
    s_waitcnt lgkmcnt(4)
    v_mfma_f32_16x16x32_bf16 v[176:179], v[152:155], v[56:59], v[176:179]
    v_mfma_f32_16x16x32_bf16 v[180:183], v[152:155], v[60:63], v[180:183]
    v_mfma_f32_16x16x32_bf16 v[184:187], v[152:155], v[64:67], v[184:187]
    v_mfma_f32_16x16x32_bf16 v[188:191], v[152:155], v[68:71], v[188:191]
    v_lshrrev_b32 v6, 2, v0
    v_mul_u32_u24 v6, 81920, v6
    v_lshrrev_b32 v7, 4, v0
    v_xor_b32 v7, v7, v0
    v_and_b32 v7, 3, v7
    v_lshl_add_u32 v2, v7, 4, v6
    v_bfe_u32 v6, v0, 1, 4
    v_mul_u32_u24 v6, 81920, v6
    v_and_b32 v7, 1, v0
    v_lshl_add_u32 v172, v7, 4, v6
    s_mul_i32 s55, s44, 20480
    s_add_u32 s55, s55, 80896
    v_and_b32 v6, 15, v0
    v_lshrrev_b32 v7, 4, v0
    v_lshlrev_b32 v175, 5, v6
    v_lshl_add_u32 v175, v7, 3, v175
    v_add_u32 v175, s55, v175
    v_lshlrev_b32 v6, 6, v6
    v_and_b32 v7, 1, v7
    v_lshl_add_u32 v6, v7, 3, v6
    v_lshrrev_b32 v7, 5, v0
    v_bfe_u32 v173, v0, 2, 2
    v_xor_b32 v7, v7, v173
    v_lshl_add_u32 v6, v7, 4, v6
    v_add_u32 v173, s55, v6
    v_xor_b32 v174, 32, v173
    s_waitcnt lgkmcnt(3)
    v_mfma_f32_16x16x32_bf16 v[192:195], v[156:159], v[56:59], v[192:195]
    v_mfma_f32_16x16x32_bf16 v[196:199], v[156:159], v[60:63], v[196:199]
    v_mfma_f32_16x16x32_bf16 v[200:203], v[156:159], v[64:67], v[200:203]
    v_mfma_f32_16x16x32_bf16 v[204:207], v[156:159], v[68:71], v[204:207]
    s_waitcnt lgkmcnt(2)
    v_mfma_f32_16x16x32_bf16 v[208:211], v[160:163], v[56:59], v[208:211]
    v_mfma_f32_16x16x32_bf16 v[212:215], v[160:163], v[60:63], v[212:215]
    v_mfma_f32_16x16x32_bf16 v[216:219], v[160:163], v[64:67], v[216:219]
    v_mfma_f32_16x16x32_bf16 v[220:223], v[160:163], v[68:71], v[220:223]
    s_waitcnt lgkmcnt(1)
    v_mfma_f32_16x16x32_bf16 v[224:227], v[164:167], v[56:59], v[224:227]
    v_mfma_f32_16x16x32_bf16 v[228:231], v[164:167], v[60:63], v[228:231]
    v_mfma_f32_16x16x32_bf16 v[232:235], v[164:167], v[64:67], v[232:235]
    v_mfma_f32_16x16x32_bf16 v[236:239], v[164:167], v[68:71], v[236:239]
    s_waitcnt lgkmcnt(0)
    v_mfma_f32_16x16x32_bf16 v[240:243], v[168:171], v[56:59], v[240:243]
    v_mfma_f32_16x16x32_bf16 v[244:247], v[168:171], v[60:63], v[244:247]
    v_mfma_f32_16x16x32_bf16 v[248:251], v[168:171], v[64:67], v[248:251]
    v_mfma_f32_16x16x32_bf16 v[252:255], v[168:171], v[68:71], v[252:255]
    s_cmp_eq_u32 s79, 0
    s_cbranch_scc1 L_w4_106
    s_add_u32 s67, s82, 7
    s_cmp_ge_u32 s67, 12
    s_cselect_b32 s48, 12, 0
    s_sub_u32 s67, s67, s48
    s_lshl_b32 s67, s67, 12
    s_add_u32 s49, s67, s6
    s_add_u32 s48, s49, 0
    buffer_load_dwordx4 v[132:135], v1, s[20:23], s48 offen sc1
    s_add_u32 s48, s49, 49152
    buffer_load_dwordx4 v[136:139], v1, s[20:23], s48 offen sc1
    s_add_u32 s48, s49, 983040
    buffer_load_dwordx4 v[140:143], v1, s[20:23], s48 offen sc1
    s_add_u32 s48, s49, 1032192
    buffer_load_dwordx4 v[144:147], v1, s[20:23], s48 offen sc1
    s_add_u32 s48, s67, s75
    buffer_load_dwordx4 v[148:151], v1, s[20:23], s48 offen sc1
L_w4_106:
    s_add_u32 s83, s82, 7
    s_cmp_ge_u32 s83, 12
    s_cselect_b32 s48, 12, 0
    s_sub_u32 s83, s83, s48
    s_lshl_b32 s83, s83, 12
    s_lshl_b32 s83, s83, 1
    s_add_u32 s48, s50, s83
    buffer_load_dwordx4 v[56:59], v1, s[20:23], s48 offen sc1
    s_add_u32 s48, s51, s83
    buffer_load_dwordx4 v[60:63], v1, s[20:23], s48 offen sc1
    s_add_u32 s48, s52, s83
    buffer_load_dwordx4 v[64:67], v1, s[20:23], s48 offen sc1
    s_add_u32 s48, s53, s83
    buffer_load_dwordx4 v[68:71], v1, s[20:23], s48 offen sc1
    s_cmp_eq_u32 s79, 0
    s_cbranch_scc1 L_w3_107
    s_cmp_ge_u32 s2, 192
    s_cbranch_scc1 L_w3_109
    s_waitcnt vmcnt(27)
    s_branch L_w3_108
L_w3_109:
    s_waitcnt vmcnt(19)
    s_branch L_w3_108
L_w3_107:
    s_waitcnt vmcnt(12)
L_w3_108:
    v_mfma_f32_16x16x32_bf16 v[176:179], v[72:75], v[8:11], v[176:179]
    v_mfma_f32_16x16x32_bf16 v[180:183], v[72:75], v[12:15], v[180:183]
    v_mfma_f32_16x16x32_bf16 v[184:187], v[72:75], v[16:19], v[184:187]
    v_mfma_f32_16x16x32_bf16 v[188:191], v[72:75], v[20:23], v[188:191]
    s_add_u32 s67, s82, 8
    s_cmp_ge_u32 s67, 12
    s_cselect_b32 s48, 12, 0
    s_sub_u32 s67, s67, s48
    s_lshl_b32 s67, s67, 12
    s_add_u32 s49, s67, s6
    s_add_u32 s48, s49, 0
    buffer_load_dwordx4 v[72:75], v1, s[20:23], s48 offen sc1
    v_mfma_f32_16x16x32_bf16 v[192:195], v[76:79], v[8:11], v[192:195]
    v_mfma_f32_16x16x32_bf16 v[196:199], v[76:79], v[12:15], v[196:199]
    v_mfma_f32_16x16x32_bf16 v[200:203], v[76:79], v[16:19], v[200:203]
    v_mfma_f32_16x16x32_bf16 v[204:207], v[76:79], v[20:23], v[204:207]
    s_add_u32 s48, s49, 49152
    buffer_load_dwordx4 v[76:79], v1, s[20:23], s48 offen sc1
    v_mfma_f32_16x16x32_bf16 v[208:211], v[80:83], v[8:11], v[208:211]
    v_mfma_f32_16x16x32_bf16 v[212:215], v[80:83], v[12:15], v[212:215]
    v_mfma_f32_16x16x32_bf16 v[216:219], v[80:83], v[16:19], v[216:219]
    v_mfma_f32_16x16x32_bf16 v[220:223], v[80:83], v[20:23], v[220:223]
    s_add_u32 s48, s49, 983040
    buffer_load_dwordx4 v[80:83], v1, s[20:23], s48 offen sc1
    s_add_u32 m0, s55, 0
    buffer_load_dwordx4 v2, s[8:11], s72 offen offset:0 lds
    v_mfma_f32_16x16x32_bf16 v[224:227], v[84:87], v[8:11], v[224:227]
    v_mfma_f32_16x16x32_bf16 v[228:231], v[84:87], v[12:15], v[228:231]
    v_mfma_f32_16x16x32_bf16 v[232:235], v[84:87], v[16:19], v[232:235]
    v_mfma_f32_16x16x32_bf16 v[236:239], v[84:87], v[20:23], v[236:239]
    s_add_u32 s48, s49, 1032192
    buffer_load_dwordx4 v[84:87], v1, s[20:23], s48 offen sc1
    s_add_u32 m0, s55, 1024
    s_add_u32 s48, s72, 640
    buffer_load_dwordx4 v2, s[8:11], s48 offen lds
    v_mfma_f32_16x16x32_bf16 v[240:243], v[88:91], v[8:11], v[240:243]
    v_mfma_f32_16x16x32_bf16 v[244:247], v[88:91], v[12:15], v[244:247]
    v_mfma_f32_16x16x32_bf16 v[248:251], v[88:91], v[16:19], v[248:251]
    v_mfma_f32_16x16x32_bf16 v[252:255], v[88:91], v[20:23], v[252:255]
    s_add_u32 s48, s67, s75
    buffer_load_dwordx4 v[88:91], v1, s[20:23], s48 offen sc1
    s_add_u32 m0, s55, 2048
    s_mov_b32 exec_hi, 0
    buffer_load_dwordx4 v172, s[8:11], s73 offen lds
    s_mov_b32 exec_hi, -1
    s_add_u32 s83, s82, 8
    s_cmp_ge_u32 s83, 12
    s_cselect_b32 s48, 12, 0
    s_sub_u32 s83, s83, s48
    s_lshl_b32 s83, s83, 12
    s_lshl_b32 s83, s83, 1
    s_add_u32 s48, s50, s83
    buffer_load_dwordx4 v[8:11], v1, s[20:23], s48 offen sc1
    s_add_u32 s48, s51, s83
    buffer_load_dwordx4 v[12:15], v1, s[20:23], s48 offen sc1
    s_add_u32 s48, s52, s83
    buffer_load_dwordx4 v[16:19], v1, s[20:23], s48 offen sc1
    s_add_u32 s48, s53, s83
    buffer_load_dwordx4 v[20:23], v1, s[20:23], s48 offen sc1
    s_cmp_eq_u32 s79, 0
    s_cbranch_scc1 L_w3_110
    s_cmp_ge_u32 s2, 192
    s_cbranch_scc1 L_w3_112
    s_waitcnt vmcnt(30)
    s_branch L_w3_111
L_w3_112:
    s_waitcnt vmcnt(26)
    s_branch L_w3_111
L_w3_110:
    s_waitcnt vmcnt(20)
L_w3_111:
    v_mfma_f32_16x16x32_bf16 v[176:179], v[92:95], v[24:27], v[176:179]
    v_mfma_f32_16x16x32_bf16 v[180:183], v[92:95], v[28:31], v[180:183]
    v_mfma_f32_16x16x32_bf16 v[184:187], v[92:95], v[32:35], v[184:187]
    v_mfma_f32_16x16x32_bf16 v[188:191], v[92:95], v[36:39], v[188:191]
    s_add_u32 s67, s82, 9
    s_cmp_ge_u32 s67, 12
    s_cselect_b32 s48, 12, 0
    s_sub_u32 s67, s67, s48
    s_lshl_b32 s67, s67, 12
    s_add_u32 s49, s67, s6
    s_add_u32 s48, s49, 0
    buffer_load_dwordx4 v[92:95], v1, s[20:23], s48 offen sc1
    v_mfma_f32_16x16x32_bf16 v[192:195], v[96:99], v[24:27], v[192:195]
    v_mfma_f32_16x16x32_bf16 v[196:199], v[96:99], v[28:31], v[196:199]
    v_mfma_f32_16x16x32_bf16 v[200:203], v[96:99], v[32:35], v[200:203]
    v_mfma_f32_16x16x32_bf16 v[204:207], v[96:99], v[36:39], v[204:207]
    s_add_u32 s48, s49, 49152
    buffer_load_dwordx4 v[96:99], v1, s[20:23], s48 offen sc1
    v_mfma_f32_16x16x32_bf16 v[208:211], v[100:103], v[24:27], v[208:211]
    v_mfma_f32_16x16x32_bf16 v[212:215], v[100:103], v[28:31], v[212:215]
    v_mfma_f32_16x16x32_bf16 v[216:219], v[100:103], v[32:35], v[216:219]
    v_mfma_f32_16x16x32_bf16 v[220:223], v[100:103], v[36:39], v[220:223]
    s_add_u32 s48, s49, 983040
    buffer_load_dwordx4 v[100:103], v1, s[20:23], s48 offen sc1
    v_mfma_f32_16x16x32_bf16 v[224:227], v[104:107], v[24:27], v[224:227]
    v_mfma_f32_16x16x32_bf16 v[228:231], v[104:107], v[28:31], v[228:231]
    v_mfma_f32_16x16x32_bf16 v[232:235], v[104:107], v[32:35], v[232:235]
    v_mfma_f32_16x16x32_bf16 v[236:239], v[104:107], v[36:39], v[236:239]
    s_add_u32 s48, s49, 1032192
    buffer_load_dwordx4 v[104:107], v1, s[20:23], s48 offen sc1
    v_mfma_f32_16x16x32_bf16 v[240:243], v[108:111], v[24:27], v[240:243]
    v_mfma_f32_16x16x32_bf16 v[244:247], v[108:111], v[28:31], v[244:247]
    v_mfma_f32_16x16x32_bf16 v[248:251], v[108:111], v[32:35], v[248:251]
    v_mfma_f32_16x16x32_bf16 v[252:255], v[108:111], v[36:39], v[252:255]
    s_add_u32 s48, s67, s75
    buffer_load_dwordx4 v[108:111], v1, s[20:23], s48 offen sc1
    s_add_u32 s83, s82, 9
    s_cmp_ge_u32 s83, 12
    s_cselect_b32 s48, 12, 0
    s_sub_u32 s83, s83, s48
    s_lshl_b32 s83, s83, 12
    s_lshl_b32 s83, s83, 1
    s_add_u32 s48, s50, s83
    buffer_load_dwordx4 v[24:27], v1, s[20:23], s48 offen sc1
    s_add_u32 s48, s51, s83
    buffer_load_dwordx4 v[28:31], v1, s[20:23], s48 offen sc1
    s_add_u32 s48, s52, s83
    buffer_load_dwordx4 v[32:35], v1, s[20:23], s48 offen sc1
    s_add_u32 s48, s53, s83
    buffer_load_dwordx4 v[36:39], v1, s[20:23], s48 offen sc1
    s_cmp_eq_u32 s79, 0
    s_cbranch_scc1 L_w3_113
    s_cmp_ge_u32 s2, 192
    s_cbranch_scc1 L_w3_115
    s_waitcnt vmcnt(30)
    s_branch L_w3_114
L_w3_115:
    s_waitcnt vmcnt(30)
    s_branch L_w3_114
L_w3_113:
    s_waitcnt vmcnt(25)
L_w3_114:
    v_mfma_f32_16x16x32_bf16 v[176:179], v[112:115], v[40:43], v[176:179]
    v_mfma_f32_16x16x32_bf16 v[180:183], v[112:115], v[44:47], v[180:183]
    v_mfma_f32_16x16x32_bf16 v[184:187], v[112:115], v[48:51], v[184:187]
    v_mfma_f32_16x16x32_bf16 v[188:191], v[112:115], v[52:55], v[188:191]
    s_add_u32 s67, s82, 10
    s_cmp_ge_u32 s67, 12
    s_cselect_b32 s48, 12, 0
    s_sub_u32 s67, s67, s48
    s_lshl_b32 s67, s67, 12
    s_add_u32 s49, s67, s6
    s_add_u32 s48, s49, 0
    buffer_load_dwordx4 v[112:115], v1, s[20:23], s48 offen sc1
    v_mfma_f32_16x16x32_bf16 v[192:195], v[116:119], v[40:43], v[192:195]
    v_mfma_f32_16x16x32_bf16 v[196:199], v[116:119], v[44:47], v[196:199]
    v_mfma_f32_16x16x32_bf16 v[200:203], v[116:119], v[48:51], v[200:203]
    v_mfma_f32_16x16x32_bf16 v[204:207], v[116:119], v[52:55], v[204:207]
    s_add_u32 s48, s49, 49152
    buffer_load_dwordx4 v[116:119], v1, s[20:23], s48 offen sc1
    v_mfma_f32_16x16x32_bf16 v[208:211], v[120:123], v[40:43], v[208:211]
    v_mfma_f32_16x16x32_bf16 v[212:215], v[120:123], v[44:47], v[212:215]
    v_mfma_f32_16x16x32_bf16 v[216:219], v[120:123], v[48:51], v[216:219]
    v_mfma_f32_16x16x32_bf16 v[220:223], v[120:123], v[52:55], v[220:223]
    s_add_u32 s48, s49, 983040
    buffer_load_dwordx4 v[120:123], v1, s[20:23], s48 offen sc1
    v_mfma_f32_16x16x32_bf16 v[224:227], v[124:127], v[40:43], v[224:227]
    v_mfma_f32_16x16x32_bf16 v[228:231], v[124:127], v[44:47], v[228:231]
    v_mfma_f32_16x16x32_bf16 v[232:235], v[124:127], v[48:51], v[232:235]
    v_mfma_f32_16x16x32_bf16 v[236:239], v[124:127], v[52:55], v[236:239]
    s_add_u32 s48, s49, 1032192
    buffer_load_dwordx4 v[124:127], v1, s[20:23], s48 offen sc1
    v_mfma_f32_16x16x32_bf16 v[240:243], v[128:131], v[40:43], v[240:243]
    v_mfma_f32_16x16x32_bf16 v[244:247], v[128:131], v[44:47], v[244:247]
    v_mfma_f32_16x16x32_bf16 v[248:251], v[128:131], v[48:51], v[248:251]
    v_mfma_f32_16x16x32_bf16 v[252:255], v[128:131], v[52:55], v[252:255]
    s_add_u32 s48, s67, s75
    buffer_load_dwordx4 v[128:131], v1, s[20:23], s48 offen sc1
    s_add_u32 s83, s82, 10
    s_cmp_ge_u32 s83, 12
    s_cselect_b32 s48, 12, 0
    s_sub_u32 s83, s83, s48
    s_lshl_b32 s83, s83, 12
    s_lshl_b32 s83, s83, 1
    s_add_u32 s48, s50, s83
    buffer_load_dwordx4 v[40:43], v1, s[20:23], s48 offen sc1
    s_add_u32 s48, s51, s83
    buffer_load_dwordx4 v[44:47], v1, s[20:23], s48 offen sc1
    s_add_u32 s48, s52, s83
    buffer_load_dwordx4 v[48:51], v1, s[20:23], s48 offen sc1
    s_add_u32 s48, s53, s83
    buffer_load_dwordx4 v[52:55], v1, s[20:23], s48 offen sc1
    s_cmp_eq_u32 s79, 0
    s_cbranch_scc1 L_w3_116
    s_cmp_ge_u32 s2, 192
    s_cbranch_scc1 L_w3_118
    s_waitcnt vmcnt(30)
    s_branch L_w3_117
L_w3_118:
    s_waitcnt vmcnt(30)
    s_branch L_w3_117
L_w3_116:
    s_waitcnt vmcnt(30)
L_w3_117:
    v_mfma_f32_16x16x32_bf16 v[176:179], v[132:135], v[56:59], v[176:179]
    v_mfma_f32_16x16x32_bf16 v[180:183], v[132:135], v[60:63], v[180:183]
    v_mfma_f32_16x16x32_bf16 v[184:187], v[132:135], v[64:67], v[184:187]
    v_mfma_f32_16x16x32_bf16 v[188:191], v[132:135], v[68:71], v[188:191]
    s_add_u32 s67, s82, 11
    s_cmp_ge_u32 s67, 12
    s_cselect_b32 s48, 12, 0
    s_sub_u32 s67, s67, s48
    s_lshl_b32 s67, s67, 12
    s_add_u32 s49, s67, s6
    s_add_u32 s48, s49, 0
    buffer_load_dwordx4 v[132:135], v1, s[20:23], s48 offen sc1
    v_mfma_f32_16x16x32_bf16 v[192:195], v[136:139], v[56:59], v[192:195]
    v_mfma_f32_16x16x32_bf16 v[196:199], v[136:139], v[60:63], v[196:199]
    v_mfma_f32_16x16x32_bf16 v[200:203], v[136:139], v[64:67], v[200:203]
    v_mfma_f32_16x16x32_bf16 v[204:207], v[136:139], v[68:71], v[204:207]
    s_add_u32 s48, s49, 49152
    buffer_load_dwordx4 v[136:139], v1, s[20:23], s48 offen sc1
    v_mfma_f32_16x16x32_bf16 v[208:211], v[140:143], v[56:59], v[208:211]
    v_mfma_f32_16x16x32_bf16 v[212:215], v[140:143], v[60:63], v[212:215]
    v_mfma_f32_16x16x32_bf16 v[216:219], v[140:143], v[64:67], v[216:219]
    v_mfma_f32_16x16x32_bf16 v[220:223], v[140:143], v[68:71], v[220:223]
    s_add_u32 s48, s49, 983040
    buffer_load_dwordx4 v[140:143], v1, s[20:23], s48 offen sc1
    v_mfma_f32_16x16x32_bf16 v[224:227], v[144:147], v[56:59], v[224:227]
    v_mfma_f32_16x16x32_bf16 v[228:231], v[144:147], v[60:63], v[228:231]
    v_mfma_f32_16x16x32_bf16 v[232:235], v[144:147], v[64:67], v[232:235]
    v_mfma_f32_16x16x32_bf16 v[236:239], v[144:147], v[68:71], v[236:239]
    s_add_u32 s48, s49, 1032192
    buffer_load_dwordx4 v[144:147], v1, s[20:23], s48 offen sc1
    v_mfma_f32_16x16x32_bf16 v[240:243], v[148:151], v[56:59], v[240:243]
    v_mfma_f32_16x16x32_bf16 v[244:247], v[148:151], v[60:63], v[244:247]
    v_mfma_f32_16x16x32_bf16 v[248:251], v[148:151], v[64:67], v[248:251]
    v_mfma_f32_16x16x32_bf16 v[252:255], v[148:151], v[68:71], v[252:255]
    s_add_u32 s48, s67, s75
    buffer_load_dwordx4 v[148:151], v1, s[20:23], s48 offen sc1
    s_add_u32 s83, s82, 11
    s_cmp_ge_u32 s83, 12
    s_cselect_b32 s48, 12, 0
    s_sub_u32 s83, s83, s48
    s_lshl_b32 s83, s83, 12
    s_lshl_b32 s83, s83, 1
    s_add_u32 s48, s50, s83
    buffer_load_dwordx4 v[56:59], v1, s[20:23], s48 offen sc1
    s_add_u32 s48, s51, s83
    buffer_load_dwordx4 v[60:63], v1, s[20:23], s48 offen sc1
    s_add_u32 s48, s52, s83
    buffer_load_dwordx4 v[64:67], v1, s[20:23], s48 offen sc1
    s_add_u32 s48, s53, s83
    buffer_load_dwordx4 v[68:71], v1, s[20:23], s48 offen sc1
    s_waitcnt vmcnt(27)
    v_mfma_f32_16x16x32_bf16 v[176:179], v[72:75], v[8:11], v[176:179]
    v_mfma_f32_16x16x32_bf16 v[180:183], v[72:75], v[12:15], v[180:183]
    v_mfma_f32_16x16x32_bf16 v[184:187], v[72:75], v[16:19], v[184:187]
    v_mfma_f32_16x16x32_bf16 v[188:191], v[72:75], v[20:23], v[188:191]
    v_mfma_f32_16x16x32_bf16 v[192:195], v[76:79], v[8:11], v[192:195]
    v_mfma_f32_16x16x32_bf16 v[196:199], v[76:79], v[12:15], v[196:199]
    v_mfma_f32_16x16x32_bf16 v[200:203], v[76:79], v[16:19], v[200:203]
    v_mfma_f32_16x16x32_bf16 v[204:207], v[76:79], v[20:23], v[204:207]
    v_mfma_f32_16x16x32_bf16 v[208:211], v[80:83], v[8:11], v[208:211]
    v_mfma_f32_16x16x32_bf16 v[212:215], v[80:83], v[12:15], v[212:215]
    v_mfma_f32_16x16x32_bf16 v[216:219], v[80:83], v[16:19], v[216:219]
    v_mfma_f32_16x16x32_bf16 v[220:223], v[80:83], v[20:23], v[220:223]
    v_mfma_f32_16x16x32_bf16 v[224:227], v[84:87], v[8:11], v[224:227]
    v_mfma_f32_16x16x32_bf16 v[228:231], v[84:87], v[12:15], v[228:231]
    v_mfma_f32_16x16x32_bf16 v[232:235], v[84:87], v[16:19], v[232:235]
    v_mfma_f32_16x16x32_bf16 v[236:239], v[84:87], v[20:23], v[236:239]
    v_mfma_f32_16x16x32_bf16 v[240:243], v[88:91], v[8:11], v[240:243]
    v_mfma_f32_16x16x32_bf16 v[244:247], v[88:91], v[12:15], v[244:247]
    v_mfma_f32_16x16x32_bf16 v[248:251], v[88:91], v[16:19], v[248:251]
    v_mfma_f32_16x16x32_bf16 v[252:255], v[88:91], v[20:23], v[252:255]
    s_waitcnt vmcnt(18)
    v_mfma_f32_16x16x32_bf16 v[176:179], v[92:95], v[24:27], v[176:179]
    v_mfma_f32_16x16x32_bf16 v[180:183], v[92:95], v[28:31], v[180:183]
    v_mfma_f32_16x16x32_bf16 v[184:187], v[92:95], v[32:35], v[184:187]
    v_mfma_f32_16x16x32_bf16 v[188:191], v[92:95], v[36:39], v[188:191]
    v_mfma_f32_16x16x32_bf16 v[192:195], v[96:99], v[24:27], v[192:195]
    v_mfma_f32_16x16x32_bf16 v[196:199], v[96:99], v[28:31], v[196:199]
    v_mfma_f32_16x16x32_bf16 v[200:203], v[96:99], v[32:35], v[200:203]
    v_mfma_f32_16x16x32_bf16 v[204:207], v[96:99], v[36:39], v[204:207]
    v_mfma_f32_16x16x32_bf16 v[208:211], v[100:103], v[24:27], v[208:211]
    v_mfma_f32_16x16x32_bf16 v[212:215], v[100:103], v[28:31], v[212:215]
    v_mfma_f32_16x16x32_bf16 v[216:219], v[100:103], v[32:35], v[216:219]
    v_mfma_f32_16x16x32_bf16 v[220:223], v[100:103], v[36:39], v[220:223]
    v_mfma_f32_16x16x32_bf16 v[224:227], v[104:107], v[24:27], v[224:227]
    v_mfma_f32_16x16x32_bf16 v[228:231], v[104:107], v[28:31], v[228:231]
    v_mfma_f32_16x16x32_bf16 v[232:235], v[104:107], v[32:35], v[232:235]
    v_mfma_f32_16x16x32_bf16 v[236:239], v[104:107], v[36:39], v[236:239]
    v_mfma_f32_16x16x32_bf16 v[240:243], v[108:111], v[24:27], v[240:243]
    v_mfma_f32_16x16x32_bf16 v[244:247], v[108:111], v[28:31], v[244:247]
    v_mfma_f32_16x16x32_bf16 v[248:251], v[108:111], v[32:35], v[248:251]
    v_mfma_f32_16x16x32_bf16 v[252:255], v[108:111], v[36:39], v[252:255]
    s_waitcnt vmcnt(9)
    ds_read_b64 v[8:9], v173 offset:0
    ds_read_b64 v[10:11], v174 offset:0
    ds_read_b64 v[12:13], v173 offset:1024
    ds_read_b64 v[14:15], v174 offset:1024
    ds_read_b64 v[16:17], v175 offset:2048
    v_mfma_f32_16x16x32_bf16 v[176:179], v[112:115], v[40:43], v[176:179]
    v_mfma_f32_16x16x32_bf16 v[180:183], v[112:115], v[44:47], v[180:183]
    v_mfma_f32_16x16x32_bf16 v[184:187], v[112:115], v[48:51], v[184:187]
    v_mfma_f32_16x16x32_bf16 v[188:191], v[112:115], v[52:55], v[188:191]
    v_mfma_f32_16x16x32_bf16 v[192:195], v[116:119], v[40:43], v[192:195]
    v_mfma_f32_16x16x32_bf16 v[196:199], v[116:119], v[44:47], v[196:199]
    v_mfma_f32_16x16x32_bf16 v[200:203], v[116:119], v[48:51], v[200:203]
    v_mfma_f32_16x16x32_bf16 v[204:207], v[116:119], v[52:55], v[204:207]
    v_mfma_f32_16x16x32_bf16 v[208:211], v[120:123], v[40:43], v[208:211]
    v_mfma_f32_16x16x32_bf16 v[212:215], v[120:123], v[44:47], v[212:215]
    v_mfma_f32_16x16x32_bf16 v[216:219], v[120:123], v[48:51], v[216:219]
    v_mfma_f32_16x16x32_bf16 v[220:223], v[120:123], v[52:55], v[220:223]
    v_mfma_f32_16x16x32_bf16 v[224:227], v[124:127], v[40:43], v[224:227]
    v_mfma_f32_16x16x32_bf16 v[228:231], v[124:127], v[44:47], v[228:231]
    v_mfma_f32_16x16x32_bf16 v[232:235], v[124:127], v[48:51], v[232:235]
    v_mfma_f32_16x16x32_bf16 v[236:239], v[124:127], v[52:55], v[236:239]
    v_mfma_f32_16x16x32_bf16 v[240:243], v[128:131], v[40:43], v[240:243]
    v_mfma_f32_16x16x32_bf16 v[244:247], v[128:131], v[44:47], v[244:247]
    v_mfma_f32_16x16x32_bf16 v[248:251], v[128:131], v[48:51], v[248:251]
    v_mfma_f32_16x16x32_bf16 v[252:255], v[128:131], v[52:55], v[252:255]
    s_waitcnt vmcnt(0)
    s_waitcnt lgkmcnt(0)
    v_mfma_f32_16x16x32_bf16 v[176:179], v[132:135], v[56:59], v[176:179]
    v_mfma_f32_16x16x32_bf16 v[180:183], v[132:135], v[60:63], v[180:183]
    v_mfma_f32_16x16x32_bf16 v[184:187], v[132:135], v[64:67], v[184:187]
    v_mfma_f32_16x16x32_bf16 v[188:191], v[132:135], v[68:71], v[188:191]
    v_mfma_f32_16x16x32_bf16 v[192:195], v[136:139], v[56:59], v[192:195]
    v_mfma_f32_16x16x32_bf16 v[196:199], v[136:139], v[60:63], v[196:199]
    v_mfma_f32_16x16x32_bf16 v[200:203], v[136:139], v[64:67], v[200:203]
    v_mfma_f32_16x16x32_bf16 v[204:207], v[136:139], v[68:71], v[204:207]
    v_mfma_f32_16x16x32_bf16 v[208:211], v[140:143], v[56:59], v[208:211]
    v_mfma_f32_16x16x32_bf16 v[212:215], v[140:143], v[60:63], v[212:215]
    v_mfma_f32_16x16x32_bf16 v[216:219], v[140:143], v[64:67], v[216:219]
    v_mfma_f32_16x16x32_bf16 v[220:223], v[140:143], v[68:71], v[220:223]
    ds_write_b128 v4, v[180:183] offset:0
    ds_write_b128 v4, v[184:187] offset:5120
    ds_write_b128 v4, v[188:191] offset:10240
    v_mfma_f32_16x16x32_bf16 v[224:227], v[144:147], v[56:59], v[224:227]
    v_mfma_f32_16x16x32_bf16 v[228:231], v[144:147], v[60:63], v[228:231]
    v_mfma_f32_16x16x32_bf16 v[232:235], v[144:147], v[64:67], v[232:235]
    v_mfma_f32_16x16x32_bf16 v[236:239], v[144:147], v[68:71], v[236:239]
    ds_write_b128 v4, v[196:199] offset:1024
    ds_write_b128 v4, v[200:203] offset:6144
    ds_write_b128 v4, v[204:207] offset:11264
    v_mfma_f32_16x16x32_bf16 v[240:243], v[148:151], v[56:59], v[240:243]
    v_mfma_f32_16x16x32_bf16 v[244:247], v[148:151], v[60:63], v[244:247]
    v_mfma_f32_16x16x32_bf16 v[248:251], v[148:151], v[64:67], v[248:251]
    v_mfma_f32_16x16x32_bf16 v[252:255], v[148:151], v[68:71], v[252:255]
    ds_write_b128 v4, v[212:215] offset:2048
    ds_write_b128 v4, v[216:219] offset:7168
    ds_write_b128 v4, v[220:223] offset:12288
    s_sub_u32 s48, s44, 1
    s_and_b32 s48, s48, 3
    s_mul_i32 s48, s48, 20480
    s_add_u32 s48, s48, 65536
    v_add_u32 v41, s48, v1
    s_sub_u32 s48, s44, 2
    s_and_b32 s48, s48, 3
    s_mul_i32 s48, s48, 20480
    s_add_u32 s48, s48, 70656
    v_add_u32 v42, s48, v1
    s_sub_u32 s48, s44, 3
    s_and_b32 s48, s48, 3
    s_mul_i32 s48, s48, 20480
    s_add_u32 s48, s48, 75776
    v_add_u32 v43, s48, v1
    ds_write_b128 v4, v[228:231] offset:3072
    ds_write_b128 v4, v[232:235] offset:8192
    ds_write_b128 v4, v[236:239] offset:13312
    ds_write_b128 v4, v[244:247] offset:4096
    ds_write_b128 v4, v[248:251] offset:9216
    ds_write_b128 v4, v[252:255] offset:14336
    s_lshl_b32 s48, s44, 10
    v_add_u32 v40, s48, v1
    s_waitcnt vmcnt(0)
    v_lshlrev_b32 v20, 16, v8
    v_and_b32 v21, 0xffff0000, v8
    v_lshlrev_b32 v22, 16, v9
    v_and_b32 v23, 0xffff0000, v9
    v_pk_add_f32 v[176:177], v[176:177], v[20:21]
    v_pk_add_f32 v[178:179], v[178:179], v[22:23]
    v_lshlrev_b32 v24, 16, v10
    v_and_b32 v25, 0xffff0000, v10
    v_lshlrev_b32 v26, 16, v11
    v_and_b32 v27, 0xffff0000, v11
    v_pk_add_f32 v[192:193], v[192:193], v[24:25]
    v_pk_add_f32 v[194:195], v[194:195], v[26:27]
    v_lshlrev_b32 v28, 16, v12
    v_and_b32 v29, 0xffff0000, v12
    v_lshlrev_b32 v30, 16, v13
    v_and_b32 v31, 0xffff0000, v13
    v_pk_add_f32 v[208:209], v[208:209], v[28:29]
    v_pk_add_f32 v[210:211], v[210:211], v[30:31]
    v_lshlrev_b32 v32, 16, v14
    v_and_b32 v33, 0xffff0000, v14
    v_lshlrev_b32 v34, 16, v15
    v_and_b32 v35, 0xffff0000, v15
    v_pk_add_f32 v[224:225], v[224:225], v[32:33]
    v_pk_add_f32 v[226:227], v[226:227], v[34:35]
    v_lshlrev_b32 v36, 16, v16
    v_and_b32 v37, 0xffff0000, v16
    v_lshlrev_b32 v38, 16, v17
    v_and_b32 v39, 0xffff0000, v17
    v_pk_add_f32 v[240:241], v[240:241], v[36:37]
    v_pk_add_f32 v[242:243], v[242:243], v[38:39]
    s_waitcnt lgkmcnt(0)
    s_barrier
    ds_read_b128 v[48:51], v40 offset:0
    ds_read_b128 v[52:55], v40 offset:16384
    ds_read_b128 v[56:59], v40 offset:32768
    ds_read_b128 v[60:63], v40 offset:49152
    ds_read_b128 v[64:67], v40 offset:4096
    ds_read_b128 v[68:71], v40 offset:20480
    ds_read_b128 v[72:75], v40 offset:36864
    ds_read_b128 v[76:79], v40 offset:53248
    ds_read_b128 v[80:83], v40 offset:8192
    ds_read_b128 v[84:87], v40 offset:24576
    ds_read_b128 v[88:91], v40 offset:40960
    ds_read_b128 v[92:95], v40 offset:57344
    ds_read_b128 v[180:183], v41 offset:0
    ds_read_b128 v[184:187], v42 offset:0
    ds_read_b128 v[188:191], v43 offset:0
    ds_read_b128 v[196:199], v41 offset:1024
    ds_read_b128 v[200:203], v42 offset:1024
    ds_read_b128 v[204:207], v43 offset:1024
    ds_read_b128 v[212:215], v41 offset:2048
    ds_read_b128 v[216:219], v42 offset:2048
    ds_read_b128 v[220:223], v43 offset:2048
    ds_read_b128 v[228:231], v41 offset:3072
    ds_read_b128 v[232:235], v42 offset:3072
    ds_read_b128 v[236:239], v43 offset:3072
    ds_read_b128 v[244:247], v41 offset:4096
    ds_read_b128 v[248:251], v42 offset:4096
    ds_read_b128 v[252:255], v43 offset:4096
    s_waitcnt lgkmcnt(15)
    v_pk_add_f32 v[48:49], v[48:49], v[56:57]
    v_pk_add_f32 v[52:53], v[52:53], v[60:61]
    v_pk_add_f32 v[50:51], v[50:51], v[58:59]
    v_pk_add_f32 v[54:55], v[54:55], v[62:63]
    v_pk_add_f32 v[56:57], v[48:49], v[52:53] neg_lo:[0,1] neg_hi:[0,1]
    v_pk_add_f32 v[48:49], v[48:49], v[52:53]
    v_pk_add_f32 v[58:59], v[50:51], v[54:55] neg_lo:[0,1] neg_hi:[0,1]
    v_pk_add_f32 v[50:51], v[50:51], v[54:55]
    v_pk_add_f32 v[64:65], v[64:65], v[72:73]
    v_pk_add_f32 v[68:69], v[68:69], v[76:77]
    v_pk_add_f32 v[66:67], v[66:67], v[74:75]
    v_pk_add_f32 v[70:71], v[70:71], v[78:79]
    v_pk_add_f32 v[72:73], v[64:65], v[68:69] neg_lo:[0,1] neg_hi:[0,1]
    v_pk_add_f32 v[64:65], v[64:65], v[68:69]
    v_pk_add_f32 v[74:75], v[66:67], v[70:71] neg_lo:[0,1] neg_hi:[0,1]
    v_pk_add_f32 v[66:67], v[66:67], v[70:71]
    v_pk_add_f32 v[80:81], v[80:81], v[88:89]
    v_pk_add_f32 v[84:85], v[84:85], v[92:93]
    v_pk_add_f32 v[82:83], v[82:83], v[90:91]
    v_pk_add_f32 v[86:87], v[86:87], v[94:95]
    v_pk_add_f32 v[80:81], v[80:81], v[84:85]
    v_pk_add_f32 v[82:83], v[82:83], v[86:87]
    s_waitcnt lgkmcnt(12)
    v_pk_add_f32 v[176:177], v[176:177], v[48:49]
    v_pk_add_f32 v[180:181], v[180:181], v[184:185]
    v_pk_add_f32 v[178:179], v[178:179], v[50:51]
    v_pk_add_f32 v[182:183], v[182:183], v[186:187]
    v_pk_add_f32 v[176:177], v[176:177], v[188:189]
    v_pk_add_f32 v[178:179], v[178:179], v[190:191]
    v_pk_add_f32 v[176:177], v[176:177], v[180:181]
    v_pk_add_f32 v[178:179], v[178:179], v[182:183]
    v_cvt_pk_bf16_f32 v184, v176, v177
    v_cvt_pk_bf16_f32 v185, v178, v179
    ds_write_b64 v173, v[184:185] offset:2560
    s_waitcnt lgkmcnt(10)
    v_pk_add_f32 v[192:193], v[192:193], v[64:65]
    v_pk_add_f32 v[196:197], v[196:197], v[200:201]
    v_pk_add_f32 v[194:195], v[194:195], v[66:67]
    v_pk_add_f32 v[198:199], v[198:199], v[202:203]
    v_pk_add_f32 v[192:193], v[192:193], v[204:205]
    v_pk_add_f32 v[194:195], v[194:195], v[206:207]
    v_pk_add_f32 v[192:193], v[192:193], v[196:197]
    v_pk_add_f32 v[194:195], v[194:195], v[198:199]
    v_cvt_pk_bf16_f32 v200, v192, v193
    v_cvt_pk_bf16_f32 v201, v194, v195
    ds_write_b64 v174, v[200:201] offset:2560
    ds_read_b128 v[8:11], v4 offset:17920
    s_waitcnt lgkmcnt(9)
    v_pk_add_f32 v[208:209], v[208:209], v[56:57]
    v_pk_add_f32 v[212:213], v[212:213], v[216:217]
    v_pk_add_f32 v[210:211], v[210:211], v[58:59]
    v_pk_add_f32 v[214:215], v[214:215], v[218:219]
    v_pk_add_f32 v[208:209], v[208:209], v[220:221]
    v_pk_add_f32 v[210:211], v[210:211], v[222:223]
    v_pk_add_f32 v[208:209], v[208:209], v[212:213]
    v_pk_add_f32 v[210:211], v[210:211], v[214:215]
    v_cvt_pk_bf16_f32 v216, v208, v209
    v_cvt_pk_bf16_f32 v217, v210, v211
    ds_write_b64 v173, v[216:217] offset:3584
    s_waitcnt lgkmcnt(7)
    v_pk_add_f32 v[224:225], v[224:225], v[72:73]
    v_pk_add_f32 v[228:229], v[228:229], v[232:233]
    v_pk_add_f32 v[226:227], v[226:227], v[74:75]
    v_pk_add_f32 v[230:231], v[230:231], v[234:235]
    v_pk_add_f32 v[224:225], v[224:225], v[236:237]
    v_pk_add_f32 v[226:227], v[226:227], v[238:239]
    v_pk_add_f32 v[224:225], v[224:225], v[228:229]
    v_pk_add_f32 v[226:227], v[226:227], v[230:231]
    v_cvt_pk_bf16_f32 v232, v224, v225
    v_cvt_pk_bf16_f32 v233, v226, v227
    ds_write_b64 v174, v[232:233] offset:3584
    ds_read_b128 v[12:15], v4 offset:18944
    s_waitcnt lgkmcnt(3)
    buffer_store_dwordx4 v[8:11], v2, s[40:43], s72 offen
    s_waitcnt lgkmcnt(6)
    v_pk_add_f32 v[240:241], v[240:241], v[80:81]
    v_pk_add_f32 v[244:245], v[244:245], v[248:249]
    v_pk_add_f32 v[242:243], v[242:243], v[82:83]
    v_pk_add_f32 v[246:247], v[246:247], v[250:251]
    v_pk_add_f32 v[240:241], v[240:241], v[252:253]
    v_pk_add_f32 v[242:243], v[242:243], v[254:255]
    v_pk_add_f32 v[240:241], v[240:241], v[244:245]
    v_pk_add_f32 v[242:243], v[242:243], v[246:247]
    v_cvt_pk_bf16_f32 v248, v240, v241
    v_cvt_pk_bf16_f32 v249, v242, v243
    ds_write_b64 v175, v[248:249] offset:4608
    ds_read_b128 v[16:19], v4 offset:19968
    s_waitcnt lgkmcnt(2)
    buffer_store_dwordx4 v[12:15], v2, s[40:43], s72 offen offset:640
    s_waitcnt lgkmcnt(0)
    s_mov_b32 exec_hi, 0
    buffer_store_dwordx4 v[16:19], v172, s[40:43], s73 offen
    s_mov_b32 exec_hi, -1
    s_lshl_b32 s48, s2, 3
    s_add_u32 s48, s48, s44
    s_cmp_eq_u32 s48, 0
    s_cbranch_scc0 L_noep_119
    s_mov_b32 s48, 0x0
    v_mov_b32 v5, s62
    v_mov_b32 v6, 0
    s_mov_b64 exec, 1
    buffer_store_dword v5, v6, s[20:23], s48 offen sc1
    s_mov_b64 exec, -1
L_noep_119:
    s_branch L_fin
L_dft_l3:
    v_lshlrev_b32 v5, 4, v0
    s_waitcnt vmcnt(0)
    v_cmp_ne_u32 vcc, s62, v41
    s_cbranch_vccnz L_rare_120
L_back_121:
    s_barrier
    v_mov_b32 v12, 149504
    s_add_u32 s3, s3, 6
L_dft_l8:
    ds_read_b32 v13, v12 offset:8
    s_waitcnt lgkmcnt(0)
    v_cmp_ne_u32 vcc, s3, v13
    s_cbranch_vccnz L_dft_l8
    s_cmp_lg_u32 s47, 3
    s_cbranch_scc1 L_dft_l7
    s_and_b32 s82, s65, 3
    s_mul_i32 s82, s82, 0
    s_and_b32 s48, s64, 7
    s_mul_i32 s48, s48, 0
    s_add_u32 s82, s82, s48
    s_add_u32 s67, s82, 0
    s_cmp_ge_u32 s67, 12
    s_cselect_b32 s48, 12, 0
    s_sub_u32 s67, s67, s48
    s_lshl_b32 s67, s67, 12
    s_add_u32 s50, s67, 4294964224
    s_add_u32 s49, s50, s6
    s_mov_b32 m0, 65536
    s_add_u32 s48, s49, 0
    buffer_load_dwordx4 v5, s[20:23], s48 offen sc1 lds
    s_mov_b32 m0, 66560
    s_add_u32 s48, s49, 49152
    buffer_load_dwordx4 v5, s[20:23], s48 offen sc1 lds
    s_mov_b32 m0, 67584
    s_add_u32 s48, s49, 983040
    buffer_load_dwordx4 v5, s[20:23], s48 offen sc1 lds
    s_mov_b32 m0, 68608
    s_add_u32 s48, s49, 1032192
    buffer_load_dwordx4 v5, s[20:23], s48 offen sc1 lds
    s_mov_b32 m0, 69632
    s_add_u32 s48, s50, s75
    buffer_load_dwordx4 v5, s[20:23], s48 offen sc1 lds
    s_add_u32 s50, s67, 4294965248
    s_add_u32 s49, s50, s6
    s_mov_b32 m0, 86016
    s_add_u32 s48, s49, 0
    buffer_load_dwordx4 v5, s[20:23], s48 offen sc1 lds
    s_mov_b32 m0, 87040
    s_add_u32 s48, s49, 49152
    buffer_load_dwordx4 v5, s[20:23], s48 offen sc1 lds
    s_mov_b32 m0, 88064
    s_add_u32 s48, s49, 983040
    buffer_load_dwordx4 v5, s[20:23], s48 offen sc1 lds
    s_mov_b32 m0, 89088
    s_add_u32 s48, s49, 1032192
    buffer_load_dwordx4 v5, s[20:23], s48 offen sc1 lds
    s_mov_b32 m0, 90112
    s_add_u32 s48, s50, s75
    buffer_load_dwordx4 v5, s[20:23], s48 offen sc1 lds
    s_add_u32 s50, s67, 4294966272
    s_add_u32 s49, s50, s6
    s_mov_b32 m0, 106496
    s_add_u32 s48, s49, 0
    buffer_load_dwordx4 v5, s[20:23], s48 offen sc1 lds
    s_mov_b32 m0, 107520
    s_add_u32 s48, s49, 49152
    buffer_load_dwordx4 v5, s[20:23], s48 offen sc1 lds
    s_mov_b32 m0, 108544
    s_add_u32 s48, s49, 983040
    buffer_load_dwordx4 v5, s[20:23], s48 offen sc1 lds
    s_mov_b32 m0, 109568
    s_add_u32 s48, s49, 1032192
    buffer_load_dwordx4 v5, s[20:23], s48 offen sc1 lds
    s_mov_b32 m0, 110592
    s_add_u32 s48, s50, s75
    buffer_load_dwordx4 v5, s[20:23], s48 offen sc1 lds
    s_add_u32 s50, s67, 0
    s_add_u32 s49, s50, s6
    s_mov_b32 m0, 126976
    s_add_u32 s48, s49, 0
    buffer_load_dwordx4 v5, s[20:23], s48 offen sc1 lds
    s_mov_b32 m0, 128000
    s_add_u32 s48, s49, 49152
    buffer_load_dwordx4 v5, s[20:23], s48 offen sc1 lds
    s_mov_b32 m0, 129024
    s_add_u32 s48, s49, 983040
    buffer_load_dwordx4 v5, s[20:23], s48 offen sc1 lds
    s_mov_b32 m0, 130048
    s_add_u32 s48, s49, 1032192
    buffer_load_dwordx4 v5, s[20:23], s48 offen sc1 lds
    s_mov_b32 m0, 131072
    s_add_u32 s48, s50, s75
    buffer_load_dwordx4 v5, s[20:23], s48 offen sc1 lds
    s_add_u32 s67, s82, 1
    s_cmp_ge_u32 s67, 12
    s_cselect_b32 s48, 12, 0
    s_sub_u32 s67, s67, s48
    s_lshl_b32 s67, s67, 12
    s_add_u32 s50, s67, 4294964224
    s_add_u32 s49, s50, s6
    s_mov_b32 m0, 70656
    s_add_u32 s48, s49, 0
    buffer_load_dwordx4 v5, s[20:23], s48 offen sc1 lds
    s_mov_b32 m0, 71680
    s_add_u32 s48, s49, 49152
    buffer_load_dwordx4 v5, s[20:23], s48 offen sc1 lds
    s_mov_b32 m0, 72704
    s_add_u32 s48, s49, 983040
    buffer_load_dwordx4 v5, s[20:23], s48 offen sc1 lds
    s_mov_b32 m0, 73728
    s_add_u32 s48, s49, 1032192
    buffer_load_dwordx4 v5, s[20:23], s48 offen sc1 lds
    s_mov_b32 m0, 74752
    s_add_u32 s48, s50, s75
    buffer_load_dwordx4 v5, s[20:23], s48 offen sc1 lds
    s_add_u32 s50, s67, 4294965248
    s_add_u32 s49, s50, s6
    s_mov_b32 m0, 91136
    s_add_u32 s48, s49, 0
    buffer_load_dwordx4 v5, s[20:23], s48 offen sc1 lds
    s_mov_b32 m0, 92160
    s_add_u32 s48, s49, 49152
    buffer_load_dwordx4 v5, s[20:23], s48 offen sc1 lds
    s_mov_b32 m0, 93184
    s_add_u32 s48, s49, 983040
    buffer_load_dwordx4 v5, s[20:23], s48 offen sc1 lds
    s_mov_b32 m0, 94208
    s_add_u32 s48, s49, 1032192
    buffer_load_dwordx4 v5, s[20:23], s48 offen sc1 lds
    s_mov_b32 m0, 95232
    s_add_u32 s48, s50, s75
    buffer_load_dwordx4 v5, s[20:23], s48 offen sc1 lds
    s_add_u32 s50, s67, 4294966272
    s_add_u32 s49, s50, s6
    s_mov_b32 m0, 111616
    s_add_u32 s48, s49, 0
    buffer_load_dwordx4 v5, s[20:23], s48 offen sc1 lds
    s_mov_b32 m0, 112640
    s_add_u32 s48, s49, 49152
    buffer_load_dwordx4 v5, s[20:23], s48 offen sc1 lds
    s_mov_b32 m0, 113664
    s_add_u32 s48, s49, 983040
    buffer_load_dwordx4 v5, s[20:23], s48 offen sc1 lds
    s_mov_b32 m0, 114688
    s_add_u32 s48, s49, 1032192
    buffer_load_dwordx4 v5, s[20:23], s48 offen sc1 lds
    s_mov_b32 m0, 115712
    s_add_u32 s48, s50, s75
    buffer_load_dwordx4 v5, s[20:23], s48 offen sc1 lds
    s_add_u32 s50, s67, 0
    s_add_u32 s49, s50, s6
    s_mov_b32 m0, 132096
    s_add_u32 s48, s49, 0
    buffer_load_dwordx4 v5, s[20:23], s48 offen sc1 lds
    s_mov_b32 m0, 133120
    s_add_u32 s48, s49, 49152
    buffer_load_dwordx4 v5, s[20:23], s48 offen sc1 lds
    s_mov_b32 m0, 134144
    s_add_u32 s48, s49, 983040
    buffer_load_dwordx4 v5, s[20:23], s48 offen sc1 lds
    s_mov_b32 m0, 135168
    s_add_u32 s48, s49, 1032192
    buffer_load_dwordx4 v5, s[20:23], s48 offen sc1 lds
    s_mov_b32 m0, 136192
    s_add_u32 s48, s50, s75
    buffer_load_dwordx4 v5, s[20:23], s48 offen sc1 lds
    s_add_u32 s67, s82, 2
    s_cmp_ge_u32 s67, 12
    s_cselect_b32 s48, 12, 0
    s_sub_u32 s67, s67, s48
    s_lshl_b32 s67, s67, 12
    s_add_u32 s50, s67, 4294964224
    s_add_u32 s49, s50, s6
    s_mov_b32 m0, 75776
    s_add_u32 s48, s49, 0
    buffer_load_dwordx4 v5, s[20:23], s48 offen sc1 lds
    s_mov_b32 m0, 76800
    s_add_u32 s48, s49, 49152
    buffer_load_dwordx4 v5, s[20:23], s48 offen sc1 lds
    s_mov_b32 m0, 77824
    s_add_u32 s48, s49, 983040
    buffer_load_dwordx4 v5, s[20:23], s48 offen sc1 lds
    s_mov_b32 m0, 78848
    s_add_u32 s48, s49, 1032192
    buffer_load_dwordx4 v5, s[20:23], s48 offen sc1 lds
    s_mov_b32 m0, 79872
    s_add_u32 s48, s50, s75
    buffer_load_dwordx4 v5, s[20:23], s48 offen sc1 lds
    s_add_u32 s50, s67, 4294965248
    s_add_u32 s49, s50, s6
    s_mov_b32 m0, 96256
    s_add_u32 s48, s49, 0
    buffer_load_dwordx4 v5, s[20:23], s48 offen sc1 lds
    s_mov_b32 m0, 97280
    s_add_u32 s48, s49, 49152
    buffer_load_dwordx4 v5, s[20:23], s48 offen sc1 lds
    s_mov_b32 m0, 98304
    s_add_u32 s48, s49, 983040
    buffer_load_dwordx4 v5, s[20:23], s48 offen sc1 lds
    s_mov_b32 m0, 99328
    s_add_u32 s48, s49, 1032192
    buffer_load_dwordx4 v5, s[20:23], s48 offen sc1 lds
    s_mov_b32 m0, 100352
    s_add_u32 s48, s50, s75
    buffer_load_dwordx4 v5, s[20:23], s48 offen sc1 lds
    s_add_u32 s50, s67, 4294966272
    s_add_u32 s49, s50, s6
    s_mov_b32 m0, 116736
    s_add_u32 s48, s49, 0
    buffer_load_dwordx4 v5, s[20:23], s48 offen sc1 lds
    s_mov_b32 m0, 117760
    s_add_u32 s48, s49, 49152
    buffer_load_dwordx4 v5, s[20:23], s48 offen sc1 lds
    s_mov_b32 m0, 118784
    s_add_u32 s48, s49, 983040
    buffer_load_dwordx4 v5, s[20:23], s48 offen sc1 lds
    s_mov_b32 m0, 119808
    s_add_u32 s48, s49, 1032192
    buffer_load_dwordx4 v5, s[20:23], s48 offen sc1 lds
    s_mov_b32 m0, 120832
    s_add_u32 s48, s50, s75
    buffer_load_dwordx4 v5, s[20:23], s48 offen sc1 lds
    s_add_u32 s50, s67, 0
    s_add_u32 s49, s50, s6
    s_mov_b32 m0, 137216
    s_add_u32 s48, s49, 0
    buffer_load_dwordx4 v5, s[20:23], s48 offen sc1 lds
    s_mov_b32 m0, 138240
    s_add_u32 s48, s49, 49152
    buffer_load_dwordx4 v5, s[20:23], s48 offen sc1 lds
    s_mov_b32 m0, 139264
    s_add_u32 s48, s49, 983040
    buffer_load_dwordx4 v5, s[20:23], s48 offen sc1 lds
    s_mov_b32 m0, 140288
    s_add_u32 s48, s49, 1032192
    buffer_load_dwordx4 v5, s[20:23], s48 offen sc1 lds
    s_mov_b32 m0, 141312
    s_add_u32 s48, s50, s75
    buffer_load_dwordx4 v5, s[20:23], s48 offen sc1 lds
L_dft_l7:
    v_mov_b32 v146, v136
    v_cos_f32 v148, v146
    v_sin_f32_e64 v152, -v146
    v_add_f32 v146, v146, v142
    v_cos_f32 v149, v146
    v_sin_f32_e64 v153, -v146
    v_add_f32 v146, v146, v142
    v_cos_f32 v150, v146
    v_sin_f32_e64 v154, -v146
    v_add_f32 v146, v146, v142
    v_cos_f32 v151, v146
    v_sin_f32_e64 v155, -v146
    v_mul_f32 v148, v145, v148
    v_cvt_pk_bf16_f32 v64, v148, v149
    v_cvt_pk_bf16_f32 v65, v150, v151
    v_cvt_pk_bf16_f32 v66, v152, v153
    v_cvt_pk_bf16_f32 v67, v154, v155
    v_mov_b32 v146, v137
    v_cos_f32 v148, v146
    v_sin_f32_e64 v152, -v146
    v_add_f32 v146, v146, v143
    v_cos_f32 v149, v146
    v_sin_f32_e64 v153, -v146
    v_add_f32 v146, v146, v143
    v_cos_f32 v150, v146
    v_sin_f32_e64 v154, -v146
    v_add_f32 v146, v146, v143
    v_cos_f32 v151, v146
    v_sin_f32_e64 v155, -v146
    v_mul_f32 v148, v145, v148
    v_cvt_pk_bf16_f32 v68, v148, v149
    v_cvt_pk_bf16_f32 v69, v150, v151
    v_cvt_pk_bf16_f32 v70, v152, v153
    v_cvt_pk_bf16_f32 v71, v154, v155
    v_mov_b32 v146, v138
    v_cos_f32 v148, v146
    v_sin_f32_e64 v152, -v146
    v_add_f32 v146, v146, v144
    v_cos_f32 v149, v146
    v_sin_f32_e64 v153, -v146
    v_add_f32 v146, v146, v144
    v_cos_f32 v150, v146
    v_sin_f32_e64 v154, -v146
    v_add_f32 v146, v146, v144
    v_cos_f32 v151, v146
    v_sin_f32_e64 v155, -v146
    v_mul_f32 v148, v145, v148
    v_cvt_pk_bf16_f32 v72, v148, v149
    v_cvt_pk_bf16_f32 v73, v150, v151
    v_cvt_pk_bf16_f32 v74, v152, v153
    v_cvt_pk_bf16_f32 v75, v154, v155
    v_fma_f32 v146, 1.0, v139, v136
    v_cos_f32 v148, v146
    v_sin_f32_e64 v152, -v146
    v_add_f32 v146, v146, v142
    v_cos_f32 v149, v146
    v_sin_f32_e64 v153, -v146
    v_add_f32 v146, v146, v142
    v_cos_f32 v150, v146
    v_sin_f32_e64 v154, -v146
    v_add_f32 v146, v146, v142
    v_cos_f32 v151, v146
    v_sin_f32_e64 v155, -v146
    v_cvt_pk_bf16_f32 v76, v148, v149
    v_cvt_pk_bf16_f32 v77, v150, v151
    v_cvt_pk_bf16_f32 v78, v152, v153
    v_cvt_pk_bf16_f32 v79, v154, v155
    v_fma_f32 v146, 1.0, v140, v137
    v_cos_f32 v148, v146
    v_sin_f32_e64 v152, -v146
    v_add_f32 v146, v146, v143
    v_cos_f32 v149, v146
    v_sin_f32_e64 v153, -v146
    v_add_f32 v146, v146, v143
    v_cos_f32 v150, v146
    v_sin_f32_e64 v154, -v146
    v_add_f32 v146, v146, v143
    v_cos_f32 v151, v146
    v_sin_f32_e64 v155, -v146
    v_cvt_pk_bf16_f32 v80, v148, v149
    v_cvt_pk_bf16_f32 v81, v150, v151
    v_cvt_pk_bf16_f32 v82, v152, v153
    v_cvt_pk_bf16_f32 v83, v154, v155
    v_fma_f32 v146, 1.0, v141, v138
    v_cos_f32 v148, v146
    v_sin_f32_e64 v152, -v146
    v_add_f32 v146, v146, v144
    v_cos_f32 v149, v146
    v_sin_f32_e64 v153, -v146
    v_add_f32 v146, v146, v144
    v_cos_f32 v150, v146
    v_sin_f32_e64 v154, -v146
    v_add_f32 v146, v146, v144
    v_cos_f32 v151, v146
    v_sin_f32_e64 v155, -v146
    v_cvt_pk_bf16_f32 v84, v148, v149
    v_cvt_pk_bf16_f32 v85, v150, v151
    v_cvt_pk_bf16_f32 v86, v152, v153
    v_cvt_pk_bf16_f32 v87, v154, v155
    v_fma_f32 v146, 2.0, v139, v136
    v_cos_f32 v148, v146
    v_sin_f32_e64 v152, -v146
    v_add_f32 v146, v146, v142
    v_cos_f32 v149, v146
    v_sin_f32_e64 v153, -v146
    v_add_f32 v146, v146, v142
    v_cos_f32 v150, v146
    v_sin_f32_e64 v154, -v146
    v_add_f32 v146, v146, v142
    v_cos_f32 v151, v146
    v_sin_f32_e64 v155, -v146
    v_cvt_pk_bf16_f32 v88, v148, v149
    v_cvt_pk_bf16_f32 v89, v150, v151
    v_cvt_pk_bf16_f32 v90, v152, v153
    v_cvt_pk_bf16_f32 v91, v154, v155
    v_fma_f32 v146, 2.0, v140, v137
    v_cos_f32 v148, v146
    v_sin_f32_e64 v152, -v146
    v_add_f32 v146, v146, v143
    v_cos_f32 v149, v146
    v_sin_f32_e64 v153, -v146
    v_add_f32 v146, v146, v143
    v_cos_f32 v150, v146
    v_sin_f32_e64 v154, -v146
    v_add_f32 v146, v146, v143
    v_cos_f32 v151, v146
    v_sin_f32_e64 v155, -v146
    v_cvt_pk_bf16_f32 v92, v148, v149
    v_cvt_pk_bf16_f32 v93, v150, v151
    v_cvt_pk_bf16_f32 v94, v152, v153
    v_cvt_pk_bf16_f32 v95, v154, v155
    v_and_b32 v146, 1, v0
    v_lshlrev_b32 v146, 15, v146
    v_or_b32 v146, 0x3f00, v146
    v_cmp_gt_u32 vcc, 16, v0
    v_cndmask_b32 v128, 0, v146, vcc
    v_mov_b32 v129, 0
    v_mov_b32 v130, 0
    v_mov_b32 v131, 0
    v_and_b32 v146, 1, v0
    v_lshlrev_b32 v146, 15, v146
    v_or_b32 v146, 0x3f00, v146
    v_cmp_gt_u32 vcc, 16, v0
    v_cndmask_b32 v132, 0, v146, vcc
    v_mov_b32 v133, 0
    v_mov_b32 v134, 0
    v_mov_b32 v135, 0
    s_waitcnt vmcnt(0)
    s_barrier
    s_mul_i32 s53, s47, 20480
    s_and_b32 s82, s65, 3
    s_mul_i32 s82, s82, 0
    s_and_b32 s48, s64, 7
    s_mul_i32 s48, s48, 0
    s_add_u32 s82, s82, s48
    s_add_u32 s67, s82, 3
    s_cmp_ge_u32 s67, 12
    s_cselect_b32 s48, 12, 0
    s_sub_u32 s67, s67, s48
    s_lshl_b32 s67, s67, 12
    s_add_u32 s49, s67, s6
    s_add_u32 m0, s53, 80896
    s_add_u32 s48, s49, 0
    buffer_load_dwordx4 v5, s[20:23], s48 offen sc1 lds
    s_add_u32 m0, s53, 81920
    s_add_u32 s48, s49, 49152
    buffer_load_dwordx4 v5, s[20:23], s48 offen sc1 lds
    s_add_u32 m0, s53, 82944
    s_add_u32 s48, s49, 983040
    buffer_load_dwordx4 v5, s[20:23], s48 offen sc1 lds
    s_add_u32 m0, s53, 83968
    s_add_u32 s48, s49, 1032192
    buffer_load_dwordx4 v5, s[20:23], s48 offen sc1 lds
    s_add_u32 m0, s53, 84992
    s_add_u32 s48, s67, s75
    buffer_load_dwordx4 v5, s[20:23], s48 offen sc1 lds
    s_lshl_b32 s48, s47, 2
    s_add_u32 s48, s48, 149520
    v_mov_b32 v12, s48
    v_mov_b32 v13, 1
    s_waitcnt vmcnt(0)
    ds_write_b32 v12, v13
    v_lshlrev_b32 v11, 7, v0
    s_branch L_dft_l6
L_dft_l2:
    s_waitcnt vmcnt(0)
    s_barrier
    s_mul_i32 s53, s47, 20480
    s_and_b32 s82, s65, 3
    s_mul_i32 s82, s82, 0
    s_and_b32 s48, s64, 7
    s_mul_i32 s48, s48, 0
    s_add_u32 s82, s82, s48
    s_add_u32 s67, s82, 3
    s_cmp_ge_u32 s67, 12
    s_cselect_b32 s48, 12, 0
    s_sub_u32 s67, s67, s48
    s_lshl_b32 s67, s67, 12
    s_add_u32 s49, s67, s6
    s_add_u32 m0, s53, 80896
    s_add_u32 s48, s49, 0
    buffer_load_dwordx4 v5, s[20:23], s48 offen sc1 lds
    s_add_u32 m0, s53, 81920
    s_add_u32 s48, s49, 49152
    buffer_load_dwordx4 v5, s[20:23], s48 offen sc1 lds
    s_add_u32 m0, s53, 82944
    s_add_u32 s48, s49, 983040
    buffer_load_dwordx4 v5, s[20:23], s48 offen sc1 lds
    s_add_u32 m0, s53, 83968
    s_add_u32 s48, s49, 1032192
    buffer_load_dwordx4 v5, s[20:23], s48 offen sc1 lds
    s_add_u32 m0, s53, 84992
    s_add_u32 s48, s67, s75
    buffer_load_dwordx4 v5, s[20:23], s48 offen sc1 lds
L_dft_l5:
    v_lshlrev_b32 v11, 7, v0
    s_cmp_lg_u32 s47, 0
    s_cbranch_scc1 L_nofup_124
    s_mov_b32 s48, 0xe000
    buffer_load_dword v16, v11, s[20:23], s48 offen sc1
L_nofup_124:
    s_lshr_b32 s83, s47, 1
    s_lshl_b32 s83, s83, 5
    s_and_b32 s67, s47, 1
    s_add_u32 s83, s83, s67
    v_lshrrev_b32 v146, 4, v0
    v_lshl_add_u32 v147, v146, 3, s83
    v_cmp_eq_u32 vcc, 0, v147
    v_cvt_f32_u32 v147, v147
    v_cndmask_b32 v145, 1.0, 0.5, vcc
    s_lshr_b32 s83, s65, 1
    s_and_b32 s67, s65, 1
    s_mul_i32 s67, s67, 20
    s_add_u32 s83, s83, s67
    s_add_u32 s83, s83, 16
    s_lshl_b32 s83, s83, 4
    s_lshl_b32 s67, s65, 5
    v_and_b32 v146, 15, v0
    v_add_u32 v148, s67, v146
    v_cvt_f32_u32 v148, v148
    v_mul_f32 v149, v147, v148
    v_mul_f32 v149, 0x3acccccd, v149
    v_fract_f32 v136, v149
    v_mul_f32 v149, 0x3dcccccd, v148
    v_fract_f32 v139, v149
    v_mul_f32 v142, 0x3b4ccccd, v148
    v_add_u32 v148, s67, v146
    v_add_u32 v148, 16, v148
    v_cvt_f32_u32 v148, v148
    v_mul_f32 v149, v147, v148
    v_mul_f32 v149, 0x3acccccd, v149
    v_fract_f32 v137, v149
    v_mul_f32 v149, 0x3dcccccd, v148
    v_fract_f32 v140, v149
    v_mul_f32 v143, 0x3b4ccccd, v148
    v_add_u32 v148, s83, v146
    v_cvt_f32_u32 v148, v148
    v_mul_f32 v149, v147, v148
    v_mul_f32 v149, 0x3acccccd, v149
    v_fract_f32 v138, v149
    v_mul_f32 v149, 0x3dcccccd, v148
    v_fract_f32 v141, v149
    v_mul_f32 v144, 0x3b4ccccd, v148
    v_mov_b32 v146, v136
    v_cos_f32 v148, v146
    v_sin_f32_e64 v152, -v146
    v_add_f32 v146, v146, v142
    v_cos_f32 v149, v146
    v_sin_f32_e64 v153, -v146
    v_add_f32 v146, v146, v142
    v_cos_f32 v150, v146
    v_sin_f32_e64 v154, -v146
    v_add_f32 v146, v146, v142
    v_cos_f32 v151, v146
    v_sin_f32_e64 v155, -v146
    v_mul_f32 v148, v145, v148
    v_cvt_pk_bf16_f32 v64, v148, v149
    v_cvt_pk_bf16_f32 v65, v150, v151
    v_cvt_pk_bf16_f32 v66, v152, v153
    v_cvt_pk_bf16_f32 v67, v154, v155
    v_mov_b32 v146, v137
    v_cos_f32 v148, v146
    v_sin_f32_e64 v152, -v146
    v_add_f32 v146, v146, v143
    v_cos_f32 v149, v146
    v_sin_f32_e64 v153, -v146
    v_add_f32 v146, v146, v143
    v_cos_f32 v150, v146
    v_sin_f32_e64 v154, -v146
    v_add_f32 v146, v146, v143
    v_cos_f32 v151, v146
    v_sin_f32_e64 v155, -v146
    v_mul_f32 v148, v145, v148
    v_cvt_pk_bf16_f32 v68, v148, v149
    v_cvt_pk_bf16_f32 v69, v150, v151
    v_cvt_pk_bf16_f32 v70, v152, v153
    v_cvt_pk_bf16_f32 v71, v154, v155
    v_mov_b32 v146, v138
    v_cos_f32 v148, v146
    v_sin_f32_e64 v152, -v146
    v_add_f32 v146, v146, v144
    v_cos_f32 v149, v146
    v_sin_f32_e64 v153, -v146
    v_add_f32 v146, v146, v144
    v_cos_f32 v150, v146
    v_sin_f32_e64 v154, -v146
    v_add_f32 v146, v146, v144
    v_cos_f32 v151, v146
    v_sin_f32_e64 v155, -v146
    v_mul_f32 v148, v145, v148
    v_cvt_pk_bf16_f32 v72, v148, v149
    v_cvt_pk_bf16_f32 v73, v150, v151
    v_cvt_pk_bf16_f32 v74, v152, v153
    v_cvt_pk_bf16_f32 v75, v154, v155
    v_fma_f32 v146, 1.0, v139, v136
    v_cos_f32 v148, v146
    v_sin_f32_e64 v152, -v146
    v_add_f32 v146, v146, v142
    v_cos_f32 v149, v146
    v_sin_f32_e64 v153, -v146
    v_add_f32 v146, v146, v142
    v_cos_f32 v150, v146
    v_sin_f32_e64 v154, -v146
    v_add_f32 v146, v146, v142
    v_cos_f32 v151, v146
    v_sin_f32_e64 v155, -v146
    v_cvt_pk_bf16_f32 v76, v148, v149
    v_cvt_pk_bf16_f32 v77, v150, v151
    v_cvt_pk_bf16_f32 v78, v152, v153
    v_cvt_pk_bf16_f32 v79, v154, v155
    s_lshl_b32 s48, s47, 2
    s_add_u32 s48, s48, 149520
    v_mov_b32 v12, s48
    v_mov_b32 v13, 1
    s_waitcnt vmcnt(0)
    ds_write_b32 v12, v13
    v_fma_f32 v146, 1.0, v140, v137
    v_cos_f32 v148, v146
    v_sin_f32_e64 v152, -v146
    v_add_f32 v146, v146, v143
    v_cos_f32 v149, v146
    v_sin_f32_e64 v153, -v146
    v_add_f32 v146, v146, v143
    v_cos_f32 v150, v146
    v_sin_f32_e64 v154, -v146
    v_add_f32 v146, v146, v143
    v_cos_f32 v151, v146
    v_sin_f32_e64 v155, -v146
    v_cvt_pk_bf16_f32 v80, v148, v149
    v_cvt_pk_bf16_f32 v81, v150, v151
    v_cvt_pk_bf16_f32 v82, v152, v153
    v_cvt_pk_bf16_f32 v83, v154, v155
    v_fma_f32 v146, 1.0, v141, v138
    v_cos_f32 v148, v146
    v_sin_f32_e64 v152, -v146
    v_add_f32 v146, v146, v144
    v_cos_f32 v149, v146
    v_sin_f32_e64 v153, -v146
    v_add_f32 v146, v146, v144
    v_cos_f32 v150, v146
    v_sin_f32_e64 v154, -v146
    v_add_f32 v146, v146, v144
    v_cos_f32 v151, v146
    v_sin_f32_e64 v155, -v146
    v_cvt_pk_bf16_f32 v84, v148, v149
    v_cvt_pk_bf16_f32 v85, v150, v151
    v_cvt_pk_bf16_f32 v86, v152, v153
    v_cvt_pk_bf16_f32 v87, v154, v155
    v_fma_f32 v146, 2.0, v139, v136
    v_cos_f32 v148, v146
    v_sin_f32_e64 v152, -v146
    v_add_f32 v146, v146, v142
    v_cos_f32 v149, v146
    v_sin_f32_e64 v153, -v146
    v_add_f32 v146, v146, v142
    v_cos_f32 v150, v146
    v_sin_f32_e64 v154, -v146
    v_add_f32 v146, v146, v142
    v_cos_f32 v151, v146
    v_sin_f32_e64 v155, -v146
    v_cvt_pk_bf16_f32 v88, v148, v149
    v_cvt_pk_bf16_f32 v89, v150, v151
    v_cvt_pk_bf16_f32 v90, v152, v153
    v_cvt_pk_bf16_f32 v91, v154, v155
    v_fma_f32 v146, 2.0, v140, v137
    v_cos_f32 v148, v146
    v_sin_f32_e64 v152, -v146
    v_add_f32 v146, v146, v143
    v_cos_f32 v149, v146
    v_sin_f32_e64 v153, -v146
    v_add_f32 v146, v146, v143
    v_cos_f32 v150, v146
    v_sin_f32_e64 v154, -v146
    v_add_f32 v146, v146, v143
    v_cos_f32 v151, v146
    v_sin_f32_e64 v155, -v146
    v_cvt_pk_bf16_f32 v92, v148, v149
    v_cvt_pk_bf16_f32 v93, v150, v151
    v_cvt_pk_bf16_f32 v94, v152, v153
    v_cvt_pk_bf16_f32 v95, v154, v155
    v_and_b32 v146, 1, v0
    v_lshlrev_b32 v146, 15, v146
    v_or_b32 v146, 0x3f00, v146
    v_cmp_gt_u32 vcc, 16, v0
    v_cndmask_b32 v128, 0, v146, vcc
    v_mov_b32 v129, 0
    v_mov_b32 v130, 0
    v_mov_b32 v131, 0
    v_and_b32 v146, 1, v0
    v_lshlrev_b32 v146, 15, v146
    v_or_b32 v146, 0x3f00, v146
    v_cmp_gt_u32 vcc, 16, v0
    v_cndmask_b32 v132, 0, v146, vcc
    v_mov_b32 v133, 0
    v_mov_b32 v134, 0
    v_mov_b32 v135, 0
L_dft_l6:
L_zpart:
    v_lshlrev_b32 v5, 4, v0
    v_lshrrev_b32 v12, 3, v0
    v_mul_u32_u24 v12, 86144, v12
    v_lshrrev_b32 v13, 2, v0
    v_lshrrev_b32 v14, 4, v0
    v_xor_b32 v13, v13, v14
    v_and_b32 v13, 1, v13
    v_lshl_add_u32 v12, v13, 6, v12
    v_and_b32 v13, 3, v0
    v_lshl_add_u32 v6, v13, 4, v12
    v_lshrrev_b32 v12, 5, v0
    v_lshlrev_b32 v12, 3, v12
    v_bfe_u32 v14, v0, 2, 2
    v_add_u32 v12, v12, v14
    v_lshlrev_b32 v12, 7, v12
    v_lshl_add_u32 v12, v13, 4, v12
    v_bfe_u32 v14, v0, 4, 1
    v_lshl_add_u32 v12, v14, 3, v12
    v_bfe_u32 v14, v0, 3, 1
    v_lshl_add_u32 v12, v14, 6, v12
    v_add_u32 v7, s70, v12
    v_xor_b32 v8, 64, v7
    v_mov_b32 v12, 149504
    s_cmp_lg_u32 s47, 0
    s_cbranch_scc1 L_lgo_125
    s_waitcnt vmcnt(0)
    v_cmp_ne_u32 vcc, s62, v16
    s_cbranch_vccnz L_rare_127
L_back_128:
    v_mov_b32 v13, 1
    ds_write_b32 v12, v13
    s_branch L_lgod_126
L_lgo_125:
    s_sleep 1
    ds_read_b32 v13, v12
    s_waitcnt lgkmcnt(0)
    v_cmp_ne_u32 vcc, 1, v13
    s_cbranch_vccnz L_lgo_125
L_lgod_126:
    s_setprio 3
    s_and_b32 s83, s65, 3
    s_mul_i32 s83, s83, 0
    s_add_u32 s83, s83, 0
    s_cmp_ge_u32 s83, 6
    s_cselect_b32 s48, 6, 0
    s_sub_u32 s83, s83, s48
    s_lshl_b32 s48, s83, 2
    s_add_u32 s48, s48, s47
    s_cmp_gt_u32 s48, 20
    s_cselect_b32 s48, 0x20000000, s68
    s_mul_i32 s83, s83, 16384
    s_add_u32 s83, s83, s48
    s_add_u32 m0, s70, 0
    s_add_u32 s49, s83, 0
    buffer_load_dwordx4 v6, s[20:23], s49 offen sc1 lds
    s_add_u32 m0, s70, 1024
    s_add_u32 s49, s83, 689152
    buffer_load_dwordx4 v6, s[20:23], s49 offen sc1 lds
    s_add_u32 m0, s70, 2048
    s_add_u32 s49, s83, 1378304
    buffer_load_dwordx4 v6, s[20:23], s49 offen sc1 lds
    s_add_u32 m0, s70, 3072
    s_add_u32 s49, s83, 2067456
    buffer_load_dwordx4 v6, s[20:23], s49 offen sc1 lds
    s_and_b32 s83, s65, 3
    s_mul_i32 s83, s83, 0
    s_add_u32 s83, s83, 1
    s_cmp_ge_u32 s83, 6
    s_cselect_b32 s48, 6, 0
    s_sub_u32 s83, s83, s48
    s_lshl_b32 s48, s83, 2
    s_add_u32 s48, s48, s47
    s_cmp_gt_u32 s48, 20
    s_cselect_b32 s48, 0x20000000, s68
    s_mul_i32 s83, s83, 16384
    s_add_u32 s83, s83, s48
    s_add_u32 m0, s70, 4096
    s_add_u32 s49, s83, 0
    buffer_load_dwordx4 v6, s[20:23], s49 offen sc1 lds
    s_add_u32 m0, s70, 5120
    s_add_u32 s49, s83, 689152
    buffer_load_dwordx4 v6, s[20:23], s49 offen sc1 lds
    s_add_u32 m0, s70, 6144
    s_add_u32 s49, s83, 1378304
    buffer_load_dwordx4 v6, s[20:23], s49 offen sc1 lds
    s_add_u32 m0, s70, 7168
    s_add_u32 s49, s83, 2067456
    buffer_load_dwordx4 v6, s[20:23], s49 offen sc1 lds
    s_and_b32 s83, s65, 3
    s_mul_i32 s83, s83, 0
    s_add_u32 s83, s83, 2
    s_cmp_ge_u32 s83, 6
    s_cselect_b32 s48, 6, 0
    s_sub_u32 s83, s83, s48
    s_lshl_b32 s48, s83, 2
    s_add_u32 s48, s48, s47
    s_cmp_gt_u32 s48, 20
    s_cselect_b32 s48, 0x20000000, s68
    s_mul_i32 s83, s83, 16384
    s_add_u32 s83, s83, s48
    s_add_u32 m0, s70, 8192
    s_add_u32 s49, s83, 0
    buffer_load_dwordx4 v6, s[20:23], s49 offen sc1 lds
    s_add_u32 m0, s70, 9216
    s_add_u32 s49, s83, 689152
    buffer_load_dwordx4 v6, s[20:23], s49 offen sc1 lds
    s_add_u32 m0, s70, 10240
    s_add_u32 s49, s83, 1378304
    buffer_load_dwordx4 v6, s[20:23], s49 offen sc1 lds
    s_add_u32 m0, s70, 11264
    s_add_u32 s49, s83, 2067456
    buffer_load_dwordx4 v6, s[20:23], s49 offen sc1 lds
    s_and_b32 s83, s65, 3
    s_mul_i32 s83, s83, 0
    s_add_u32 s83, s83, 3
    s_cmp_ge_u32 s83, 6
    s_cselect_b32 s48, 6, 0
    s_sub_u32 s83, s83, s48
    s_lshl_b32 s48, s83, 2
    s_add_u32 s48, s48, s47
    s_cmp_gt_u32 s48, 20
    s_cselect_b32 s48, 0x20000000, s68
    s_mul_i32 s83, s83, 16384
    s_add_u32 s83, s83, s48
    s_add_u32 m0, s70, 12288
    s_add_u32 s49, s83, 0
    buffer_load_dwordx4 v6, s[20:23], s49 offen sc1 lds
    s_add_u32 m0, s70, 13312
    s_add_u32 s49, s83, 689152
    buffer_load_dwordx4 v6, s[20:23], s49 offen sc1 lds
    s_add_u32 m0, s70, 14336
    s_add_u32 s49, s83, 1378304
    buffer_load_dwordx4 v6, s[20:23], s49 offen sc1 lds
    s_add_u32 m0, s70, 15360
    s_add_u32 s49, s83, 2067456
    buffer_load_dwordx4 v6, s[20:23], s49 offen sc1 lds
    s_waitcnt vmcnt(12)
    ds_read_b64_tr_b16 v[16:17], v7 offset:0
    ds_read_b64_tr_b16 v[18:19], v7 offset:512
    ds_read_b64_tr_b16 v[20:21], v7 offset:2048
    ds_read_b64_tr_b16 v[22:23], v7 offset:2560
    ds_read_b64_tr_b16 v[24:25], v8 offset:0
    ds_read_b64_tr_b16 v[26:27], v8 offset:512
    ds_read_b64_tr_b16 v[28:29], v8 offset:2048
    ds_read_b64_tr_b16 v[30:31], v8 offset:2560
    s_waitcnt lgkmcnt(4)
    v_mfma_f32_16x16x32_bf16 v[32:35], v[16:19], v[160:163], 0
    v_mfma_f32_16x16x32_bf16 v[36:39], v[16:19], v[176:179], 0
    v_mfma_f32_16x16x32_bf16 v[40:43], v[16:19], v[168:171], 0
    v_mfma_f32_16x16x32_bf16 v[44:47], v[16:19], v[184:187], 0
    v_mfma_f32_16x16x32_bf16 v[32:35], v[20:23], v[164:167], v[32:35]
    v_mfma_f32_16x16x32_bf16 v[36:39], v[20:23], v[180:183], v[36:39]
    v_mfma_f32_16x16x32_bf16 v[40:43], v[20:23], v[172:175], v[40:43]
    v_mfma_f32_16x16x32_bf16 v[44:47], v[20:23], v[188:191], v[44:47]
    s_waitcnt lgkmcnt(0)
    v_mfma_f32_16x16x32_bf16 v[48:51], v[24:27], v[224:227], 0
    v_mfma_f32_16x16x32_bf16 v[52:55], v[24:27], v[240:243], 0
    v_mfma_f32_16x16x32_bf16 v[56:59], v[24:27], v[232:235], 0
    v_mfma_f32_16x16x32_bf16 v[60:63], v[24:27], v[248:251], 0
    v_mfma_f32_16x16x32_bf16 v[48:51], v[28:31], v[228:231], v[48:51]
    v_cvt_pk_bf16_f32 v32, v32, v33
    v_cvt_pk_bf16_f32 v33, v34, v35
    v_mfma_f32_16x16x32_bf16 v[52:55], v[28:31], v[244:247], v[52:55]
    v_cvt_pk_bf16_f32 v34, v36, v37
    v_cvt_pk_bf16_f32 v35, v38, v39
    v_mfma_f32_16x16x32_bf16 v[56:59], v[28:31], v[236:239], v[56:59]
    v_cvt_pk_bf16_f32 v40, v40, v41
    v_cvt_pk_bf16_f32 v41, v42, v43
    v_mfma_f32_16x16x32_bf16 v[60:63], v[28:31], v[252:255], v[60:63]
    v_cvt_pk_bf16_f32 v42, v44, v45
    v_cvt_pk_bf16_f32 v43, v46, v47
    s_and_b32 s83, s65, 3
    s_mul_i32 s83, s83, 0
    s_add_u32 s83, s83, 4
    s_cmp_ge_u32 s83, 6
    s_cselect_b32 s48, 6, 0
    s_sub_u32 s83, s83, s48
    s_lshl_b32 s48, s83, 2
    s_add_u32 s48, s48, s47
    s_cmp_gt_u32 s48, 20
    s_cselect_b32 s48, 0x20000000, s68
    s_mul_i32 s83, s83, 16384
    s_add_u32 s83, s83, s48
    s_add_u32 m0, s70, 0
    s_add_u32 s49, s83, 0
    buffer_load_dwordx4 v6, s[20:23], s49 offen sc1 lds
    s_add_u32 m0, s70, 1024
    s_add_u32 s49, s83, 689152
    buffer_load_dwordx4 v6, s[20:23], s49 offen sc1 lds
    s_add_u32 m0, s70, 2048
    s_add_u32 s49, s83, 1378304
    buffer_load_dwordx4 v6, s[20:23], s49 offen sc1 lds
    s_add_u32 m0, s70, 3072
    s_add_u32 s49, s83, 2067456
    buffer_load_dwordx4 v6, s[20:23], s49 offen sc1 lds
    s_waitcnt vmcnt(12)
    ds_read_b64_tr_b16 v[16:17], v7 offset:4096
    ds_read_b64_tr_b16 v[18:19], v7 offset:4608
    ds_read_b64_tr_b16 v[20:21], v7 offset:6144
    ds_read_b64_tr_b16 v[22:23], v7 offset:6656
    ds_read_b64_tr_b16 v[24:25], v8 offset:4096
    ds_read_b64_tr_b16 v[26:27], v8 offset:4608
    ds_read_b64_tr_b16 v[28:29], v8 offset:6144
    ds_read_b64_tr_b16 v[30:31], v8 offset:6656
    v_mfma_f32_16x16x32_bf16 v[136:139], v[64:67], v[32:35], 0
    v_mfma_f32_16x16x32_bf16 v[192:195], v[68:71], v[32:35], 0
    v_cvt_pk_bf16_f32 v48, v48, v49
    v_cvt_pk_bf16_f32 v49, v50, v51
    v_mfma_f32_16x16x32_bf16 v[208:211], v[72:75], v[32:35], 0
    v_cvt_pk_bf16_f32 v50, v52, v53
    v_cvt_pk_bf16_f32 v51, v54, v55
    v_mfma_f32_16x16x32_bf16 v[140:143], v[64:67], v[40:43], 0
    v_cvt_pk_bf16_f32 v56, v56, v57
    v_cvt_pk_bf16_f32 v57, v58, v59
    v_mfma_f32_16x16x32_bf16 v[196:199], v[68:71], v[40:43], 0
    v_cvt_pk_bf16_f32 v58, v60, v61
    v_cvt_pk_bf16_f32 v59, v62, v63
    v_mfma_f32_16x16x32_bf16 v[212:215], v[72:75], v[40:43], 0
    s_nop 0
    v_mfma_f32_16x16x32_bf16 v[144:147], v[64:67], v[48:51], 0
    v_mfma_f32_16x16x32_bf16 v[200:203], v[68:71], v[48:51], 0
    v_mfma_f32_16x16x32_bf16 v[216:219], v[72:75], v[48:51], 0
    v_mfma_f32_16x16x32_bf16 v[148:151], v[64:67], v[56:59], 0
    v_mfma_f32_16x16x32_bf16 v[204:207], v[68:71], v[56:59], 0
    v_mfma_f32_16x16x32_bf16 v[220:223], v[72:75], v[56:59], 0
    s_waitcnt lgkmcnt(4)
    v_mfma_f32_16x16x32_bf16 v[32:35], v[16:19], v[160:163], 0
    v_mfma_f32_16x16x32_bf16 v[36:39], v[16:19], v[176:179], 0
    v_mfma_f32_16x16x32_bf16 v[40:43], v[16:19], v[168:171], 0
    v_mfma_f32_16x16x32_bf16 v[44:47], v[16:19], v[184:187], 0
    v_mfma_f32_16x16x32_bf16 v[32:35], v[20:23], v[164:167], v[32:35]
    v_mfma_f32_16x16x32_bf16 v[36:39], v[20:23], v[180:183], v[36:39]
    v_mfma_f32_16x16x32_bf16 v[40:43], v[20:23], v[172:175], v[40:43]
    v_mfma_f32_16x16x32_bf16 v[44:47], v[20:23], v[188:191], v[44:47]
    s_waitcnt lgkmcnt(0)
    v_mfma_f32_16x16x32_bf16 v[48:51], v[24:27], v[224:227], 0
    v_mfma_f32_16x16x32_bf16 v[52:55], v[24:27], v[240:243], 0
    v_mfma_f32_16x16x32_bf16 v[56:59], v[24:27], v[232:235], 0
    v_mfma_f32_16x16x32_bf16 v[60:63], v[24:27], v[248:251], 0
    v_mfma_f32_16x16x32_bf16 v[48:51], v[28:31], v[228:231], v[48:51]
    v_cvt_pk_bf16_f32 v32, v32, v33
    v_cvt_pk_bf16_f32 v33, v34, v35
    v_mfma_f32_16x16x32_bf16 v[52:55], v[28:31], v[244:247], v[52:55]
    v_cvt_pk_bf16_f32 v34, v36, v37
    v_cvt_pk_bf16_f32 v35, v38, v39
    v_mfma_f32_16x16x32_bf16 v[56:59], v[28:31], v[236:239], v[56:59]
    v_cvt_pk_bf16_f32 v40, v40, v41
    v_cvt_pk_bf16_f32 v41, v42, v43
    v_mfma_f32_16x16x32_bf16 v[60:63], v[28:31], v[252:255], v[60:63]
    v_cvt_pk_bf16_f32 v42, v44, v45
    v_cvt_pk_bf16_f32 v43, v46, v47
    s_cmp_lg_u32 s47, 0
    s_cbranch_scc1 L_nou5_132
    s_and_b32 s83, s65, 3
    s_mul_i32 s83, s83, 0
    s_add_u32 s83, s83, 5
    s_cmp_ge_u32 s83, 6
    s_cselect_b32 s48, 6, 0
    s_sub_u32 s83, s83, s48
    s_lshl_b32 s48, s83, 2
    s_add_u32 s48, s48, s47
    s_cmp_gt_u32 s48, 20
    s_cselect_b32 s48, 0x20000000, s68
    s_mul_i32 s83, s83, 16384
    s_add_u32 s83, s83, s48
    s_add_u32 m0, s70, 4096
    s_add_u32 s49, s83, 0
    buffer_load_dwordx4 v6, s[20:23], s49 offen sc1 lds
    s_add_u32 m0, s70, 5120
    s_add_u32 s49, s83, 689152
    buffer_load_dwordx4 v6, s[20:23], s49 offen sc1 lds
    s_add_u32 m0, s70, 6144
    s_add_u32 s49, s83, 1378304
    buffer_load_dwordx4 v6, s[20:23], s49 offen sc1 lds
    s_add_u32 m0, s70, 7168
    s_add_u32 s49, s83, 2067456
    buffer_load_dwordx4 v6, s[20:23], s49 offen sc1 lds
L_nou5_132:
    s_waitcnt vmcnt(8)
    ds_read_b64_tr_b16 v[16:17], v7 offset:8192
    ds_read_b64_tr_b16 v[18:19], v7 offset:8704
    ds_read_b64_tr_b16 v[20:21], v7 offset:10240
    ds_read_b64_tr_b16 v[22:23], v7 offset:10752
    ds_read_b64_tr_b16 v[24:25], v8 offset:8192
    ds_read_b64_tr_b16 v[26:27], v8 offset:8704
    ds_read_b64_tr_b16 v[28:29], v8 offset:10240
    ds_read_b64_tr_b16 v[30:31], v8 offset:10752
    v_mfma_f32_16x16x32_bf16 v[136:139], v[76:79], v[32:35], v[136:139]
    v_mfma_f32_16x16x32_bf16 v[192:195], v[80:83], v[32:35], v[192:195]
    v_cvt_pk_bf16_f32 v48, v48, v49
    v_cvt_pk_bf16_f32 v49, v50, v51
    v_mfma_f32_16x16x32_bf16 v[208:211], v[84:87], v[32:35], v[208:211]
    v_cvt_pk_bf16_f32 v50, v52, v53
    v_cvt_pk_bf16_f32 v51, v54, v55
    v_mfma_f32_16x16x32_bf16 v[140:143], v[76:79], v[40:43], v[140:143]
    v_cvt_pk_bf16_f32 v56, v56, v57
    v_cvt_pk_bf16_f32 v57, v58, v59
    v_mfma_f32_16x16x32_bf16 v[196:199], v[80:83], v[40:43], v[196:199]
    v_cvt_pk_bf16_f32 v58, v60, v61
    v_cvt_pk_bf16_f32 v59, v62, v63
    v_mfma_f32_16x16x32_bf16 v[212:215], v[84:87], v[40:43], v[212:215]
    s_nop 0
    v_mfma_f32_16x16x32_bf16 v[144:147], v[76:79], v[48:51], v[144:147]
    v_mfma_f32_16x16x32_bf16 v[200:203], v[80:83], v[48:51], v[200:203]
    v_mfma_f32_16x16x32_bf16 v[216:219], v[84:87], v[48:51], v[216:219]
    v_mfma_f32_16x16x32_bf16 v[148:151], v[76:79], v[56:59], v[148:151]
    v_mfma_f32_16x16x32_bf16 v[204:207], v[80:83], v[56:59], v[204:207]
    v_mfma_f32_16x16x32_bf16 v[220:223], v[84:87], v[56:59], v[220:223]
    s_setprio 0
    s_waitcnt lgkmcnt(4)
    v_mfma_f32_16x16x32_bf16 v[32:35], v[16:19], v[160:163], 0
    v_mfma_f32_16x16x32_bf16 v[36:39], v[16:19], v[176:179], 0
    v_mfma_f32_16x16x32_bf16 v[40:43], v[16:19], v[168:171], 0
    v_mfma_f32_16x16x32_bf16 v[44:47], v[16:19], v[184:187], 0
    v_mfma_f32_16x16x32_bf16 v[32:35], v[20:23], v[164:167], v[32:35]
    v_mfma_f32_16x16x32_bf16 v[36:39], v[20:23], v[180:183], v[36:39]
    v_mfma_f32_16x16x32_bf16 v[40:43], v[20:23], v[172:175], v[40:43]
    v_mfma_f32_16x16x32_bf16 v[44:47], v[20:23], v[188:191], v[44:47]
    s_waitcnt lgkmcnt(0)
    v_mfma_f32_16x16x32_bf16 v[48:51], v[24:27], v[224:227], 0
    v_mfma_f32_16x16x32_bf16 v[52:55], v[24:27], v[240:243], 0
    v_mfma_f32_16x16x32_bf16 v[56:59], v[24:27], v[232:235], 0
    v_mfma_f32_16x16x32_bf16 v[60:63], v[24:27], v[248:251], 0
    v_mfma_f32_16x16x32_bf16 v[48:51], v[28:31], v[228:231], v[48:51]
    v_cvt_pk_bf16_f32 v32, v32, v33
    v_cvt_pk_bf16_f32 v33, v34, v35
    v_mfma_f32_16x16x32_bf16 v[52:55], v[28:31], v[244:247], v[52:55]
    v_cvt_pk_bf16_f32 v34, v36, v37
    v_cvt_pk_bf16_f32 v35, v38, v39
    v_mfma_f32_16x16x32_bf16 v[56:59], v[28:31], v[236:239], v[56:59]
    v_cvt_pk_bf16_f32 v40, v40, v41
    v_cvt_pk_bf16_f32 v41, v42, v43
    v_mfma_f32_16x16x32_bf16 v[60:63], v[28:31], v[252:255], v[60:63]
    v_cvt_pk_bf16_f32 v42, v44, v45
    v_cvt_pk_bf16_f32 v43, v46, v47
    s_waitcnt vmcnt(4)
    ds_read_b64_tr_b16 v[16:17], v7 offset:12288
    ds_read_b64_tr_b16 v[18:19], v7 offset:12800
    ds_read_b64_tr_b16 v[20:21], v7 offset:14336
    ds_read_b64_tr_b16 v[22:23], v7 offset:14848
    ds_read_b64_tr_b16 v[24:25], v8 offset:12288
    ds_read_b64_tr_b16 v[26:27], v8 offset:12800
    ds_read_b64_tr_b16 v[28:29], v8 offset:14336
    ds_read_b64_tr_b16 v[30:31], v8 offset:14848
    v_mfma_f32_16x16x32_bf16 v[136:139], v[88:91], v[32:35], v[136:139]
    v_mfma_f32_16x16x32_bf16 v[192:195], v[92:95], v[32:35], v[192:195]
    v_cvt_pk_bf16_f32 v48, v48, v49
    v_cvt_pk_bf16_f32 v49, v50, v51
    v_mfma_f32_16x16x32_bf16 v[208:211], v[96:99], v[32:35], v[208:211]
    v_cvt_pk_bf16_f32 v50, v52, v53
    v_cvt_pk_bf16_f32 v51, v54, v55
    v_mfma_f32_16x16x32_bf16 v[140:143], v[88:91], v[40:43], v[140:143]
    v_cvt_pk_bf16_f32 v56, v56, v57
    v_cvt_pk_bf16_f32 v57, v58, v59
    v_mfma_f32_16x16x32_bf16 v[196:199], v[92:95], v[40:43], v[196:199]
    v_cvt_pk_bf16_f32 v58, v60, v61
    v_cvt_pk_bf16_f32 v59, v62, v63
    v_mfma_f32_16x16x32_bf16 v[212:215], v[96:99], v[40:43], v[212:215]
    s_nop 0
    v_mfma_f32_16x16x32_bf16 v[144:147], v[88:91], v[48:51], v[144:147]
    v_mfma_f32_16x16x32_bf16 v[200:203], v[92:95], v[48:51], v[200:203]
    v_mfma_f32_16x16x32_bf16 v[216:219], v[96:99], v[48:51], v[216:219]
    v_mfma_f32_16x16x32_bf16 v[148:151], v[88:91], v[56:59], v[148:151]
    v_mfma_f32_16x16x32_bf16 v[204:207], v[92:95], v[56:59], v[204:207]
    v_mfma_f32_16x16x32_bf16 v[220:223], v[96:99], v[56:59], v[220:223]
    s_waitcnt lgkmcnt(4)
    v_mfma_f32_16x16x32_bf16 v[32:35], v[16:19], v[160:163], 0
    v_mfma_f32_16x16x32_bf16 v[36:39], v[16:19], v[176:179], 0
    v_mfma_f32_16x16x32_bf16 v[40:43], v[16:19], v[168:171], 0
    v_mfma_f32_16x16x32_bf16 v[44:47], v[16:19], v[184:187], 0
    v_mfma_f32_16x16x32_bf16 v[32:35], v[20:23], v[164:167], v[32:35]
    v_mfma_f32_16x16x32_bf16 v[36:39], v[20:23], v[180:183], v[36:39]
    v_mfma_f32_16x16x32_bf16 v[40:43], v[20:23], v[172:175], v[40:43]
    v_mfma_f32_16x16x32_bf16 v[44:47], v[20:23], v[188:191], v[44:47]
    s_waitcnt lgkmcnt(0)
    v_mfma_f32_16x16x32_bf16 v[48:51], v[24:27], v[224:227], 0
    v_mfma_f32_16x16x32_bf16 v[52:55], v[24:27], v[240:243], 0
    v_mfma_f32_16x16x32_bf16 v[56:59], v[24:27], v[232:235], 0
    v_mfma_f32_16x16x32_bf16 v[60:63], v[24:27], v[248:251], 0
    v_mfma_f32_16x16x32_bf16 v[48:51], v[28:31], v[228:231], v[48:51]
    v_cvt_pk_bf16_f32 v32, v32, v33
    v_cvt_pk_bf16_f32 v33, v34, v35
    v_mfma_f32_16x16x32_bf16 v[52:55], v[28:31], v[244:247], v[52:55]
    v_cvt_pk_bf16_f32 v34, v36, v37
    v_cvt_pk_bf16_f32 v35, v38, v39
    v_mfma_f32_16x16x32_bf16 v[56:59], v[28:31], v[236:239], v[56:59]
    v_cvt_pk_bf16_f32 v40, v40, v41
    v_cvt_pk_bf16_f32 v41, v42, v43
    v_mfma_f32_16x16x32_bf16 v[60:63], v[28:31], v[252:255], v[60:63]
    v_cvt_pk_bf16_f32 v42, v44, v45
    v_cvt_pk_bf16_f32 v43, v46, v47
    s_waitcnt vmcnt(0)
    ds_read_b64_tr_b16 v[16:17], v7 offset:0
    ds_read_b64_tr_b16 v[18:19], v7 offset:512
    ds_read_b64_tr_b16 v[20:21], v7 offset:2048
    ds_read_b64_tr_b16 v[22:23], v7 offset:2560
    ds_read_b64_tr_b16 v[24:25], v8 offset:0
    ds_read_b64_tr_b16 v[26:27], v8 offset:512
    ds_read_b64_tr_b16 v[28:29], v8 offset:2048
    ds_read_b64_tr_b16 v[30:31], v8 offset:2560
    v_mfma_f32_16x16x32_bf16 v[136:139], v[100:103], v[32:35], v[136:139]
    v_mfma_f32_16x16x32_bf16 v[192:195], v[104:107], v[32:35], v[192:195]
    v_cvt_pk_bf16_f32 v48, v48, v49
    v_cvt_pk_bf16_f32 v49, v50, v51
    v_mfma_f32_16x16x32_bf16 v[208:211], v[108:111], v[32:35], v[208:211]
    v_cvt_pk_bf16_f32 v50, v52, v53
    v_cvt_pk_bf16_f32 v51, v54, v55
    v_mfma_f32_16x16x32_bf16 v[140:143], v[100:103], v[40:43], v[140:143]
    v_cvt_pk_bf16_f32 v56, v56, v57
    v_cvt_pk_bf16_f32 v57, v58, v59
    v_mfma_f32_16x16x32_bf16 v[196:199], v[104:107], v[40:43], v[196:199]
    v_cvt_pk_bf16_f32 v58, v60, v61
    v_cvt_pk_bf16_f32 v59, v62, v63
    v_mfma_f32_16x16x32_bf16 v[212:215], v[108:111], v[40:43], v[212:215]
    s_nop 0
    v_mfma_f32_16x16x32_bf16 v[144:147], v[100:103], v[48:51], v[144:147]
    v_mfma_f32_16x16x32_bf16 v[200:203], v[104:107], v[48:51], v[200:203]
    v_mfma_f32_16x16x32_bf16 v[216:219], v[108:111], v[48:51], v[216:219]
    v_mfma_f32_16x16x32_bf16 v[148:151], v[100:103], v[56:59], v[148:151]
    v_mfma_f32_16x16x32_bf16 v[204:207], v[104:107], v[56:59], v[204:207]
    v_mfma_f32_16x16x32_bf16 v[220:223], v[108:111], v[56:59], v[220:223]
    s_waitcnt lgkmcnt(4)
    v_mfma_f32_16x16x32_bf16 v[32:35], v[16:19], v[160:163], 0
    v_mfma_f32_16x16x32_bf16 v[36:39], v[16:19], v[176:179], 0
    v_mfma_f32_16x16x32_bf16 v[40:43], v[16:19], v[168:171], 0
    v_mfma_f32_16x16x32_bf16 v[44:47], v[16:19], v[184:187], 0
    v_mfma_f32_16x16x32_bf16 v[32:35], v[20:23], v[164:167], v[32:35]
    v_mfma_f32_16x16x32_bf16 v[36:39], v[20:23], v[180:183], v[36:39]
    v_mfma_f32_16x16x32_bf16 v[40:43], v[20:23], v[172:175], v[40:43]
    v_mfma_f32_16x16x32_bf16 v[44:47], v[20:23], v[188:191], v[44:47]
    s_waitcnt lgkmcnt(0)
    v_mfma_f32_16x16x32_bf16 v[48:51], v[24:27], v[224:227], 0
    v_mfma_f32_16x16x32_bf16 v[52:55], v[24:27], v[240:243], 0
    v_mfma_f32_16x16x32_bf16 v[56:59], v[24:27], v[232:235], 0
    v_mfma_f32_16x16x32_bf16 v[60:63], v[24:27], v[248:251], 0
    v_mfma_f32_16x16x32_bf16 v[48:51], v[28:31], v[228:231], v[48:51]
    v_cvt_pk_bf16_f32 v32, v32, v33
    v_cvt_pk_bf16_f32 v33, v34, v35
    v_mfma_f32_16x16x32_bf16 v[52:55], v[28:31], v[244:247], v[52:55]
    v_cvt_pk_bf16_f32 v34, v36, v37
    v_cvt_pk_bf16_f32 v35, v38, v39
    v_mfma_f32_16x16x32_bf16 v[56:59], v[28:31], v[236:239], v[56:59]
    v_cvt_pk_bf16_f32 v40, v40, v41
    v_cvt_pk_bf16_f32 v41, v42, v43
    v_mfma_f32_16x16x32_bf16 v[60:63], v[28:31], v[252:255], v[60:63]
    v_cvt_pk_bf16_f32 v42, v44, v45
    v_cvt_pk_bf16_f32 v43, v46, v47
    s_cmp_lg_u32 s47, 0
    s_cbranch_scc1 L_nor5_133
    s_waitcnt vmcnt(0)
    ds_read_b64_tr_b16 v[16:17], v7 offset:4096
    ds_read_b64_tr_b16 v[18:19], v7 offset:4608
    ds_read_b64_tr_b16 v[20:21], v7 offset:6144
    ds_read_b64_tr_b16 v[22:23], v7 offset:6656
    ds_read_b64_tr_b16 v[24:25], v8 offset:4096
    ds_read_b64_tr_b16 v[26:27], v8 offset:4608
    ds_read_b64_tr_b16 v[28:29], v8 offset:6144
    ds_read_b64_tr_b16 v[30:31], v8 offset:6656
L_nor5_133:
    v_mfma_f32_16x16x32_bf16 v[136:139], v[112:115], v[32:35], v[136:139]
    v_mfma_f32_16x16x32_bf16 v[192:195], v[116:119], v[32:35], v[192:195]
    v_cvt_pk_bf16_f32 v48, v48, v49
    v_cvt_pk_bf16_f32 v49, v50, v51
    v_mfma_f32_16x16x32_bf16 v[208:211], v[120:123], v[32:35], v[208:211]
    v_cvt_pk_bf16_f32 v50, v52, v53
    v_cvt_pk_bf16_f32 v51, v54, v55
    v_mfma_f32_16x16x32_bf16 v[140:143], v[112:115], v[40:43], v[140:143]
    v_cvt_pk_bf16_f32 v56, v56, v57
    v_cvt_pk_bf16_f32 v57, v58, v59
    v_mfma_f32_16x16x32_bf16 v[196:199], v[116:119], v[40:43], v[196:199]
    v_cvt_pk_bf16_f32 v58, v60, v61
    v_cvt_pk_bf16_f32 v59, v62, v63
    v_mfma_f32_16x16x32_bf16 v[212:215], v[120:123], v[40:43], v[212:215]
    s_nop 0
    v_mfma_f32_16x16x32_bf16 v[144:147], v[112:115], v[48:51], v[144:147]
    v_mfma_f32_16x16x32_bf16 v[200:203], v[116:119], v[48:51], v[200:203]
    v_mfma_f32_16x16x32_bf16 v[216:219], v[120:123], v[48:51], v[216:219]
    v_mfma_f32_16x16x32_bf16 v[148:151], v[112:115], v[56:59], v[148:151]
    v_mfma_f32_16x16x32_bf16 v[204:207], v[116:119], v[56:59], v[204:207]
    v_mfma_f32_16x16x32_bf16 v[220:223], v[120:123], v[56:59], v[220:223]
    s_cmp_lg_u32 s47, 0
    s_cbranch_scc1 L_noz5_131
    s_waitcnt lgkmcnt(4)
    v_mfma_f32_16x16x32_bf16 v[32:35], v[16:19], v[160:163], 0
    v_mfma_f32_16x16x32_bf16 v[36:39], v[16:19], v[176:179], 0
    v_mfma_f32_16x16x32_bf16 v[40:43], v[16:19], v[168:171], 0
    v_mfma_f32_16x16x32_bf16 v[44:47], v[16:19], v[184:187], 0
    v_mfma_f32_16x16x32_bf16 v[32:35], v[20:23], v[164:167], v[32:35]
    v_mfma_f32_16x16x32_bf16 v[36:39], v[20:23], v[180:183], v[36:39]
    v_mfma_f32_16x16x32_bf16 v[40:43], v[20:23], v[172:175], v[40:43]
    v_mfma_f32_16x16x32_bf16 v[44:47], v[20:23], v[188:191], v[44:47]
    s_waitcnt lgkmcnt(0)
    v_mfma_f32_16x16x32_bf16 v[48:51], v[24:27], v[224:227], 0
    v_mfma_f32_16x16x32_bf16 v[52:55], v[24:27], v[240:243], 0
    v_mfma_f32_16x16x32_bf16 v[56:59], v[24:27], v[232:235], 0
    v_mfma_f32_16x16x32_bf16 v[60:63], v[24:27], v[248:251], 0
    v_mfma_f32_16x16x32_bf16 v[48:51], v[28:31], v[228:231], v[48:51]
    v_cvt_pk_bf16_f32 v32, v32, v33
    v_cvt_pk_bf16_f32 v33, v34, v35
    v_mfma_f32_16x16x32_bf16 v[52:55], v[28:31], v[244:247], v[52:55]
    v_cvt_pk_bf16_f32 v34, v36, v37
    v_cvt_pk_bf16_f32 v35, v38, v39
    v_mfma_f32_16x16x32_bf16 v[56:59], v[28:31], v[236:239], v[56:59]
    v_cvt_pk_bf16_f32 v40, v40, v41
    v_cvt_pk_bf16_f32 v41, v42, v43
    v_mfma_f32_16x16x32_bf16 v[60:63], v[28:31], v[252:255], v[60:63]
    v_cvt_pk_bf16_f32 v42, v44, v45
    v_cvt_pk_bf16_f32 v43, v46, v47
    s_nop 1
    v_mfma_f32_16x16x32_bf16 v[136:139], v[124:127], v[32:35], v[136:139]
    v_mfma_f32_16x16x32_bf16 v[192:195], v[128:131], v[32:35], v[192:195]
    v_cvt_pk_bf16_f32 v48, v48, v49
    v_cvt_pk_bf16_f32 v49, v50, v51
    v_mfma_f32_16x16x32_bf16 v[208:211], v[132:135], v[32:35], v[208:211]
    v_cvt_pk_bf16_f32 v50, v52, v53
    v_cvt_pk_bf16_f32 v51, v54, v55
    v_mfma_f32_16x16x32_bf16 v[140:143], v[124:127], v[40:43], v[140:143]
    v_cvt_pk_bf16_f32 v56, v56, v57
    v_cvt_pk_bf16_f32 v57, v58, v59
    v_mfma_f32_16x16x32_bf16 v[196:199], v[128:131], v[40:43], v[196:199]
    v_cvt_pk_bf16_f32 v58, v60, v61
    v_cvt_pk_bf16_f32 v59, v62, v63
    v_mfma_f32_16x16x32_bf16 v[212:215], v[132:135], v[40:43], v[212:215]
    s_nop 0
    v_mfma_f32_16x16x32_bf16 v[144:147], v[124:127], v[48:51], v[144:147]
    v_mfma_f32_16x16x32_bf16 v[200:203], v[128:131], v[48:51], v[200:203]
    v_mfma_f32_16x16x32_bf16 v[216:219], v[132:135], v[48:51], v[216:219]
    v_mfma_f32_16x16x32_bf16 v[148:151], v[124:127], v[56:59], v[148:151]
    v_mfma_f32_16x16x32_bf16 v[204:207], v[128:131], v[56:59], v[204:207]
    v_mfma_f32_16x16x32_bf16 v[220:223], v[132:135], v[56:59], v[220:223]
L_noz5_131:
    v_add_u32 v12, s70, v5
    ds_write_b128 v12, v[136:139] offset:0
    ds_write_b128 v12, v[192:195] offset:4096
    ds_write_b128 v12, v[208:211] offset:8192
    ds_write_b128 v12, v[140:143] offset:1024
    ds_write_b128 v12, v[196:199] offset:5120
    ds_write_b128 v12, v[212:215] offset:9216
    ds_write_b128 v12, v[144:147] offset:2048
    ds_write_b128 v12, v[200:203] offset:6144
    ds_write_b128 v12, v[216:219] offset:10240
    s_nop 1
    ds_write_b128 v12, v[148:151] offset:3072
    ds_write_b128 v12, v[204:207] offset:7168
    ds_write_b128 v12, v[220:223] offset:11264
    v_mov_b32 v12, 149504
    v_mov_b32 v13, 1
    s_waitcnt lgkmcnt(0)
    s_barrier
L_fin:
L_end:
    s_endpgm
L_rare_11:
    s_mov_b32 s63, 0
L_poll_13:
    s_mov_b64 exec, vcc
    s_sleep 1
    s_mov_b32 s48, 0x1000
    buffer_load_dword v34, v15, s[20:23], s48 offen sc1
    s_add_u32 s63, s63, 1
    s_cmp_ge_u32 s63, 40000
    s_waitcnt vmcnt(0)
    s_cbranch_scc1 L_polld_14
    v_cmp_ne_u32 vcc, s62, v34
    s_cbranch_vccnz L_poll_13
L_polld_14:
    s_mov_b64 exec, -1
    s_branch L_back_12
L_rare_15:
    s_mov_b32 s63, 0
L_poll_17:
    s_mov_b64 exec, vcc
    s_sleep 1
    s_mov_b32 s48, 0x50000
    buffer_load_dword v35, v10, s[20:23], s48 offen sc1
    s_add_u32 s63, s63, 1
    s_cmp_ge_u32 s63, 40000
    s_waitcnt vmcnt(0)
    s_cbranch_scc1 L_polld_18
    v_cmp_ne_u32 vcc, s62, v35
    s_cbranch_vccnz L_poll_17
L_polld_18:
    s_mov_b64 exec, -1
    s_branch L_back_16
L_rare_23:
    s_cmp_eq_u32 s57, 1
    s_cbranch_scc1 L_csm_25
    v_mfma_f32_16x16x32_bf16 v[240:243], v[32:35], v[2:5], 0
    v_mfma_f32_16x16x32_bf16 v[244:247], v[36:39], v[2:5], 0
    v_mfma_f32_16x16x32_bf16 v[248:251], v[40:43], v[2:5], 0
    v_mfma_f32_16x16x32_bf16 v[252:255], v[44:47], v[2:5], 0
    s_branch L_csm_26
L_csm_25:
    v_mfma_f32_16x16x32_bf16 v[240:243], v[48:51], v[2:5], 0
    v_mfma_f32_16x16x32_bf16 v[244:247], v[52:55], v[2:5], 0
    v_mfma_f32_16x16x32_bf16 v[248:251], v[56:59], v[2:5], 0
    v_mfma_f32_16x16x32_bf16 v[252:255], v[60:63], v[2:5], 0
L_csm_26:
    s_branch L_back_24
L_rare_27:
    v_mov_b32 v6, s62
    v_mov_b32 v7, 0
    s_mov_b64 exec, 1
    buffer_store_dword v6, v7, s[20:23], s59 offen sc1
    s_mov_b64 exec, -1
    s_branch L_back_28
L_rare_29:
    s_cmp_eq_u32 s57, 1
    s_cbranch_scc1 L_csm_31
    v_mfma_f32_16x16x32_bf16 v[240:243], v[80:83], v[2:5], v[240:243]
    v_mfma_f32_16x16x32_bf16 v[244:247], v[84:87], v[2:5], v[244:247]
    v_mfma_f32_16x16x32_bf16 v[248:251], v[88:91], v[2:5], v[248:251]
    v_mfma_f32_16x16x32_bf16 v[252:255], v[92:95], v[2:5], v[252:255]
    s_branch L_csm_32
L_csm_31:
    v_mfma_f32_16x16x32_bf16 v[240:243], v[96:99], v[2:5], v[240:243]
    v_mfma_f32_16x16x32_bf16 v[244:247], v[100:103], v[2:5], v[244:247]
    v_mfma_f32_16x16x32_bf16 v[248:251], v[104:107], v[2:5], v[248:251]
    v_mfma_f32_16x16x32_bf16 v[252:255], v[108:111], v[2:5], v[252:255]
L_csm_32:
    s_branch L_back_30
L_rare_33:
    s_mov_b32 exec_lo, 0x00010001
    s_mov_b32 exec_hi, 0x00010001
    buffer_store_dwordx4 v[240:243], v14, s[20:23], s60 offen offset:0 sc1
    buffer_store_dwordx4 v[244:247], v14, s[20:23], s60 offen offset:64 sc1
    buffer_store_dwordx4 v[248:251], v14, s[20:23], s60 offen offset:128 sc1
    buffer_store_dwordx4 v[252:255], v14, s[20:23], s60 offen offset:192 sc1
    s_mov_b64 exec, -1
    s_branch L_back_34
L_rare_35:
    s_cmp_eq_u32 s57, 1
    s_cbranch_scc1 L_csm_37
    v_mfma_f32_16x16x32_bf16 v[240:243], v[32:35], v[2:5], 0
    v_mfma_f32_16x16x32_bf16 v[244:247], v[36:39], v[2:5], 0
    v_mfma_f32_16x16x32_bf16 v[248:251], v[40:43], v[2:5], 0
    v_mfma_f32_16x16x32_bf16 v[252:255], v[44:47], v[2:5], 0
    s_branch L_csm_38
L_csm_37:
    v_mfma_f32_16x16x32_bf16 v[240:243], v[48:51], v[2:5], 0
    v_mfma_f32_16x16x32_bf16 v[244:247], v[52:55], v[2:5], 0
    v_mfma_f32_16x16x32_bf16 v[248:251], v[56:59], v[2:5], 0
    v_mfma_f32_16x16x32_bf16 v[252:255], v[60:63], v[2:5], 0
L_csm_38:
    s_branch L_back_36
L_rare_39:
    s_cmp_eq_u32 s57, 1
    s_cbranch_scc1 L_csm_41
    v_mfma_f32_16x16x32_bf16 v[240:243], v[80:83], v[2:5], v[240:243]
    v_mfma_f32_16x16x32_bf16 v[244:247], v[84:87], v[2:5], v[244:247]
    v_mfma_f32_16x16x32_bf16 v[248:251], v[88:91], v[2:5], v[248:251]
    v_mfma_f32_16x16x32_bf16 v[252:255], v[92:95], v[2:5], v[252:255]
    s_branch L_csm_42
L_csm_41:
    v_mfma_f32_16x16x32_bf16 v[240:243], v[96:99], v[2:5], v[240:243]
    v_mfma_f32_16x16x32_bf16 v[244:247], v[100:103], v[2:5], v[244:247]
    v_mfma_f32_16x16x32_bf16 v[248:251], v[104:107], v[2:5], v[248:251]
    v_mfma_f32_16x16x32_bf16 v[252:255], v[108:111], v[2:5], v[252:255]
L_csm_42:
    s_branch L_back_40
L_rare_43:
    s_mov_b32 exec_lo, 0x00010001
    s_mov_b32 exec_hi, 0x00010001
    buffer_store_dwordx4 v[240:243], v14, s[20:23], s60 offen offset:0 sc1
    buffer_store_dwordx4 v[244:247], v14, s[20:23], s60 offen offset:64 sc1
    buffer_store_dwordx4 v[248:251], v14, s[20:23], s60 offen offset:128 sc1
    buffer_store_dwordx4 v[252:255], v14, s[20:23], s60 offen offset:192 sc1
    s_mov_b64 exec, -1
    s_branch L_back_44
L_rare_45:
    s_cmp_eq_u32 s57, 1
    s_cbranch_scc1 L_csm_47
    v_mfma_f32_16x16x32_bf16 v[240:243], v[32:35], v[2:5], 0
    v_mfma_f32_16x16x32_bf16 v[244:247], v[36:39], v[2:5], 0
    v_mfma_f32_16x16x32_bf16 v[248:251], v[40:43], v[2:5], 0
    v_mfma_f32_16x16x32_bf16 v[252:255], v[44:47], v[2:5], 0
    s_branch L_csm_48
L_csm_47:
    v_mfma_f32_16x16x32_bf16 v[240:243], v[48:51], v[2:5], 0
    v_mfma_f32_16x16x32_bf16 v[244:247], v[52:55], v[2:5], 0
    v_mfma_f32_16x16x32_bf16 v[248:251], v[56:59], v[2:5], 0
    v_mfma_f32_16x16x32_bf16 v[252:255], v[60:63], v[2:5], 0
L_csm_48:
    s_branch L_back_46
L_rare_49:
    s_waitcnt vmcnt(0)
    s_branch L_back_50
L_rare_51:
    s_lshl_b32 s48, s2, 7
    s_add_u32 s48, s48, 0x5000
    v_mov_b32 v6, s62
    v_mov_b32 v7, 0
    s_mov_b64 exec, 1
    buffer_store_dword v6, v7, s[20:23], s48 offen sc1
    s_mov_b64 exec, -1
    s_branch L_back_52
L_rare_53:
    s_cmp_eq_u32 s57, 1
    s_cbranch_scc1 L_csm_55
    v_mfma_f32_16x16x32_bf16 v[240:243], v[80:83], v[2:5], v[240:243]
    v_mfma_f32_16x16x32_bf16 v[244:247], v[84:87], v[2:5], v[244:247]
    v_mfma_f32_16x16x32_bf16 v[248:251], v[88:91], v[2:5], v[248:251]
    v_mfma_f32_16x16x32_bf16 v[252:255], v[92:95], v[2:5], v[252:255]
    s_branch L_csm_56
L_csm_55:
    v_mfma_f32_16x16x32_bf16 v[240:243], v[96:99], v[2:5], v[240:243]
    v_mfma_f32_16x16x32_bf16 v[244:247], v[100:103], v[2:5], v[244:247]
    v_mfma_f32_16x16x32_bf16 v[248:251], v[104:107], v[2:5], v[248:251]
    v_mfma_f32_16x16x32_bf16 v[252:255], v[108:111], v[2:5], v[252:255]
L_csm_56:
    s_branch L_back_54
L_rare_57:
    s_mov_b32 exec_lo, 0x00010001
    s_mov_b32 exec_hi, 0x00010001
    buffer_store_dwordx4 v[240:243], v14, s[20:23], s60 offen offset:0 sc1
    buffer_store_dwordx4 v[244:247], v14, s[20:23], s60 offen offset:64 sc1
    buffer_store_dwordx4 v[248:251], v14, s[20:23], s60 offen offset:128 sc1
    buffer_store_dwordx4 v[252:255], v14, s[20:23], s60 offen offset:192 sc1
    s_mov_b64 exec, -1
    s_branch L_back_58
L_rare_59:
    s_waitcnt vmcnt(0)
    s_branch L_back_60
L_rare_61:
    s_lshl_b32 s48, s2, 7
    s_add_u32 s48, s48, 0x5000
    v_mov_b32 v6, s62
    v_mov_b32 v7, 0
    s_mov_b64 exec, 1
    buffer_store_dword v6, v7, s[20:23], s48 offen sc1
    s_mov_b64 exec, -1
    s_branch L_back_62
L_rare_63:
    s_waitcnt vmcnt(0)
    s_branch L_back_64
L_rare_65:
    s_lshl_b32 s48, s2, 7
    s_add_u32 s48, s48, 0x5000
    v_mov_b32 v6, s62
    v_mov_b32 v7, 0
    s_mov_b64 exec, 1
    buffer_store_dword v6, v7, s[20:23], s48 offen sc1
    s_mov_b64 exec, -1
    s_branch L_back_66
L_rare_68:
    s_mov_b32 s63, 0
L_poll_70:
    s_mov_b64 exec, vcc
    s_sleep 1
    s_mov_b32 s48, 0x1000
    buffer_load_dword v46, v15, s[20:23], s48 offen sc1
    s_add_u32 s63, s63, 1
    s_cmp_ge_u32 s63, 40000
    s_waitcnt vmcnt(0)
    s_cbranch_scc1 L_polld_71
    v_cmp_ne_u32 vcc, s62, v46
    s_cbranch_vccnz L_poll_70
L_polld_71:
    s_mov_b64 exec, -1
    s_branch L_back_69
L_rare_73:
    s_mov_b32 s63, 0
L_poll_75:
    s_mov_b64 exec, vcc
    s_sleep 1
    s_mov_b32 s48, 0xc000
    buffer_load_dword v48, v11, s[20:23], s48 offen sc1
    s_add_u32 s63, s63, 1
    s_cmp_ge_u32 s63, 40000
    s_waitcnt vmcnt(0)
    s_cbranch_scc1 L_polld_76
    v_cmp_ne_u32 vcc, s62, v48
    s_cbranch_vccnz L_poll_75
L_polld_76:
    s_mov_b64 exec, -1
    s_branch L_back_74
L_rare_83:
    s_mov_b32 s63, 0
L_poll_85:
    s_mov_b64 exec, vcc
    s_sleep 1
    s_mov_b32 s48, 0x10000
    buffer_load_dword v7, v3, s[20:23], s48 offen sc1
    s_add_u32 s63, s63, 1
    s_cmp_ge_u32 s63, 40000
    s_waitcnt vmcnt(0)
    s_cbranch_scc1 L_polld_86
    v_cmp_ne_u32 vcc, s62, v7
    s_cbranch_vccnz L_poll_85
L_polld_86:
    s_mov_b64 exec, -1
    s_branch L_back_84
L_rare_120:
    s_mov_b32 s63, 0
L_poll_122:
    s_mov_b64 exec, vcc
    s_sleep 1
    s_mov_b32 s48, 0x50000
    buffer_load_dword v41, v10, s[20:23], s48 offen sc1
    s_add_u32 s63, s63, 1
    s_cmp_ge_u32 s63, 40000
    s_waitcnt vmcnt(0)
    s_cbranch_scc1 L_polld_123
    v_cmp_ne_u32 vcc, s62, v41
    s_cbranch_vccnz L_poll_122
L_polld_123:
    s_mov_b64 exec, -1
    s_branch L_back_121
L_rare_127:
    s_mov_b32 s63, 0
L_poll_129:
    s_mov_b64 exec, vcc
    s_sleep 1
    s_mov_b32 s48, 0xe000
    buffer_load_dword v16, v11, s[20:23], s48 offen sc1
    s_add_u32 s63, s63, 1
    s_cmp_ge_u32 s63, 40000
    s_waitcnt vmcnt(0)
    s_cbranch_scc1 L_polld_130
    v_cmp_ne_u32 vcc, s62, v16
    s_cbranch_vccnz L_poll_129
L_polld_130:
    s_mov_b64 exec, -1
    s_branch L_back_128
L_code_end:
.section .rodata,"a"
.p2align 6
.amdhsa_kernel parallel_sum__spectral_gfnet__glu_gated_reglu__prompt_kernel
  .amdhsa_next_free_vgpr 256
  .amdhsa_next_free_sgpr 102
  .amdhsa_accum_offset 256
  .amdhsa_group_segment_fixed_size 0
  .amdhsa_kernarg_size 80
  .amdhsa_user_sgpr_count 2
  .amdhsa_user_sgpr_kernarg_segment_ptr 1
  .amdhsa_system_sgpr_workgroup_id_x 1
  .amdhsa_float_denorm_mode_32 3
.end_amdhsa_kernel
.section .rodata,"a"
.p2align 8
.set CA_0, 0x3f80
.set CA_1, 0x3f80
.set CA_2, 0x3f80
.set CA_3, 0x3f80
.set CA_4, 0x3f80
.set CA_5, 0x3f80
.set CA_6, 0x3f80
.set CA_7, 0x3f7f
.set CA_8, 0x3f7f
.set CA_9, 0x3f7f
.set CA_10, 0x3f7f
.set CA_11, 0x3f7f
.set CA_12, 0x3f7e
.set CA_13, 0x3f7e
.set CA_14, 0x3f7e
.set CA_15, 0x3f7d
.set CA_16, 0x3f7d
.set CA_17, 0x3f7c
.set CA_18, 0x3f7c
.set CA_19, 0x3f7c
.set CA_20, 0x3f7b
.set CA_21, 0x3f7b
.set CA_22, 0x3f7a
.set CA_23, 0x3f7a
.set CA_24, 0x3f79
.set CA_25, 0x3f78
.set CA_26, 0x3f78
.set CA_27, 0x3f77
.set CA_28, 0x3f76
.set CA_29, 0x3f76
.set CA_30, 0x3f75
.set CA_31, 0x3f74
.set CA_32, 0x3f73
.set CA_33, 0x3f73
.set CA_34, 0x3f72
.set CA_35, 0x3f71
.set CA_36, 0x3f70
.set CA_37, 0x3f6f
.set CA_38, 0x3f6e
.set CA_39, 0x3f6d
.set CA_40, 0x3f6d
.set CA_41, 0x3f6c
.set CA_42, 0x3f6b
.set CA_43, 0x3f6a
.set CA_44, 0x3f68
.set CA_45, 0x3f67
.set CA_46, 0x3f66
.set CA_47, 0x3f65
.set CA_48, 0x3f64
.set CA_49, 0x3f63
.set CA_50, 0x3f62
.set CA_51, 0x3f61
.set CA_52, 0x3f5f
.set CA_53, 0x3f5e
.set CA_54, 0x3f5d
.set CA_55, 0x3f5c
.set CA_56, 0x3f5a
.set CA_57, 0x3f59
.set CA_58, 0x3f58
.set CA_59, 0x3f56
.set CA_60, 0x3f55
.set CA_61, 0x3f53
.set CA_62, 0x3f52
.set CA_63, 0x3f51
.set CA_64, 0x3f4f
.set CA_65, 0x3f4e
.set CA_66, 0x3f4c
.set CA_67, 0x3f4b
.set CA_68, 0x3f49
.set CA_69, 0x3f47
.set CA_70, 0x3f46
.set CA_71, 0x3f44
.set CA_72, 0x3f43
.set CA_73, 0x3f41
.set CA_74, 0x3f3f
.set CA_75, 0x3f3e
.set CA_76, 0x3f3c
.set CA_77, 0x3f3a
.set CA_78, 0x3f39
.set CA_79, 0x3f37
.set CA_80, 0x3f35
.set CA_81, 0x3f33
.set CA_82, 0x3f31
.set CA_83, 0x3f30
.set CA_84, 0x3f2e
.set CA_85, 0x3f2c
.set CA_86, 0x3f2a
.set CA_87, 0x3f28
.set CA_88, 0x3f26
.set CA_89, 0x3f24
.set CA_90, 0x3f22
.set CA_91, 0x3f20
.set CA_92, 0x3f1e
.set CA_93, 0x3f1d
.set CA_94, 0x3f1b
.set CA_95, 0x3f18
.set CA_96, 0x3f16
.set CA_97, 0x3f14
.set CA_98, 0x3f12
.set CA_99, 0x3f10
.set CA_100, 0x3f0e
.set CA_101, 0x3f0c
.set CA_102, 0x3f0a
.set CA_103, 0x3f08
.set CA_104, 0x3f06
.set CA_105, 0x3f04
.set CA_106, 0x3f01
.set CA_107, 0x3eff
.set CA_108, 0x3efa
.set CA_109, 0x3ef6
.set CA_110, 0x3ef1
.set CA_111, 0x3eed
.set CA_112, 0x3ee8
.set CA_113, 0x3ee4
.set CA_114, 0x3edf
.set CA_115, 0x3edb
.set CA_116, 0x3ed6
.set CA_117, 0x3ed2
.set CA_118, 0x3ecd
.set CA_119, 0x3ec9
.set CA_120, 0x3ec4
.set CA_121, 0x3ebf
.set CA_122, 0x3ebb
.set CA_123, 0x3eb6
.set CA_124, 0x3eb1
.set CA_125, 0x3eac
.set CA_126, 0x3ea8
.set CA_127, 0x3ea3
.set CA_128, 0x3e9e
.set CA_129, 0x3e99
.set CA_130, 0x3e95
.set CA_131, 0x3e90
.set CA_132, 0x3e8b
.set CA_133, 0x3e86
.set CA_134, 0x3e81
.set CA_135, 0x3e79
.set CA_136, 0x3e6f
.set CA_137, 0x3e65
.set CA_138, 0x3e5b
.set CA_139, 0x3e52
.set CA_140, 0x3e48
.set CA_141, 0x3e3e
.set CA_142, 0x3e34
.set CA_143, 0x3e2a
.set CA_144, 0x3e20
.set CA_145, 0x3e16
.set CA_146, 0x3e0c
.set CA_147, 0x3e02
.set CA_148, 0x3df1
.set CA_149, 0x3ddd
.set CA_150, 0x3dc9
.set CA_151, 0x3db5
.set CA_152, 0x3da1
.set CA_153, 0x3d8d
.set CA_154, 0x3d71
.set CA_155, 0x3d49
.set CA_156, 0x3d21
.set CA_157, 0x3cf1
.set CA_158, 0x3ca1
.set CA_159, 0x3c21
.set CA_160, 0x0
.set CA_161, 0xbc21
.set CA_162, 0xbca1
.set CA_163, 0xbcf1
.set CA_164, 0xbd21
.set CA_165, 0xbd49
.set CA_166, 0xbd71
.set CA_167, 0xbd8d
.set CA_168, 0xbda1
.set CA_169, 0xbdb5
.set CA_170, 0xbdc9
.set CA_171, 0xbddd
.set CA_172, 0xbdf1
.set CA_173, 0xbe02
.set CA_174, 0xbe0c
.set CA_175, 0xbe16
.set CA_176, 0xbe20
.set CA_177, 0xbe2a
.set CA_178, 0xbe34
.set CA_179, 0xbe3e
.set CA_180, 0xbe48
.set CA_181, 0xbe52
.set CA_182, 0xbe5b
.set CA_183, 0xbe65
.set CA_184, 0xbe6f
.set CA_185, 0xbe79
.set CA_186, 0xbe81
.set CA_187, 0xbe86
.set CA_188, 0xbe8b
.set CA_189, 0xbe90
.set CA_190, 0xbe95
.set CA_191, 0xbe99
.set CA_192, 0xbe9e
.set CA_193, 0xbea3
.set CA_194, 0xbea8
.set CA_195, 0xbeac
.set CA_196, 0xbeb1
.set CA_197, 0xbeb6
.set CA_198, 0xbebb
.set CA_199, 0xbebf
.set CA_200, 0xbec4
.set CA_201, 0xbec9
.set CA_202, 0xbecd
.set CA_203, 0xbed2
.set CA_204, 0xbed6
.set CA_205, 0xbedb
.set CA_206, 0xbedf
.set CA_207, 0xbee4
.set CA_208, 0xbee8
.set CA_209, 0xbeed
.set CA_210, 0xbef1
.set CA_211, 0xbef6
.set CA_212, 0xbefa
.set CA_213, 0xbeff
.set CA_214, 0xbf01
.set CA_215, 0xbf04
.set CA_216, 0xbf06
.set CA_217, 0xbf08
.set CA_218, 0xbf0a
.set CA_219, 0xbf0c
.set CA_220, 0xbf0e
.set CA_221, 0xbf10
.set CA_222, 0xbf12
.set CA_223, 0xbf14
.set CA_224, 0xbf16
.set CA_225, 0xbf18
.set CA_226, 0xbf1b
.set CA_227, 0xbf1d
.set CA_228, 0xbf1e
.set CA_229, 0xbf20
.set CA_230, 0xbf22
.set CA_231, 0xbf24
.set CA_232, 0xbf26
.set CA_233, 0xbf28
.set CA_234, 0xbf2a
.set CA_235, 0xbf2c
.set CA_236, 0xbf2e
.set CA_237, 0xbf30
.set CA_238, 0xbf31
.set CA_239, 0xbf33
.set CA_240, 0xbf35
.set CA_241, 0xbf37
.set CA_242, 0xbf39
.set CA_243, 0xbf3a
.set CA_244, 0xbf3c
.set CA_245, 0xbf3e
.set CA_246, 0xbf3f
.set CA_247, 0xbf41
.set CA_248, 0xbf43
.set CA_249, 0xbf44
.set CA_250, 0xbf46
.set CA_251, 0xbf47
.set CA_252, 0xbf49
.set CA_253, 0xbf4b
.set CA_254, 0xbf4c
.set CA_255, 0xbf4e
.set CA_256, 0xbf4f
.set CA_257, 0xbf51
.set CA_258, 0xbf52
.set CA_259, 0xbf53
.set CA_260, 0xbf55
.set CA_261, 0xbf56
.set CA_262, 0xbf58
.set CA_263, 0xbf59
.set CA_264, 0xbf5a
.set CA_265, 0xbf5c
.set CA_266, 0xbf5d
.set CA_267, 0xbf5e
.set CA_268, 0xbf5f
.set CA_269, 0xbf61
.set CA_270, 0xbf62
.set CA_271, 0xbf63
.set CA_272, 0xbf64
.set CA_273, 0xbf65
.set CA_274, 0xbf66
.set CA_275, 0xbf67
.set CA_276, 0xbf68
.set CA_277, 0xbf6a
.set CA_278, 0xbf6b
.set CA_279, 0xbf6c
.set CA_280, 0xbf6d
.set CA_281, 0xbf6d
.set CA_282, 0xbf6e
.set CA_283, 0xbf6f
.set CA_284, 0xbf70
.set CA_285, 0xbf71
.set CA_286, 0xbf72
.set CA_287, 0xbf73
.set CA_288, 0xbf73
.set CA_289, 0xbf74
.set CA_290, 0xbf75
.set CA_291, 0xbf76
.set CA_292, 0xbf76
.set CA_293, 0xbf77
.set CA_294, 0xbf78
.set CA_295, 0xbf78
.set CA_296, 0xbf79
.set CA_297, 0xbf7a
.set CA_298, 0xbf7a
.set CA_299, 0xbf7b
.set CA_300, 0xbf7b
.set CA_301, 0xbf7c
.set CA_302, 0xbf7c
.set CA_303, 0xbf7c
.set CA_304, 0xbf7d
.set CA_305, 0xbf7d
.set CA_306, 0xbf7e
.set CA_307, 0xbf7e
.set CA_308, 0xbf7e
.set CA_309, 0xbf7f
.set CA_310, 0xbf7f
.set CA_311, 0xbf7f
.set CA_312, 0xbf7f
.set CA_313, 0xbf7f
.set CA_314, 0xbf80
.set CA_315, 0xbf80
.set CA_316, 0xbf80
.set CA_317, 0xbf80
.set CA_318, 0xbf80
.set CA_319, 0xbf80
.set CA_320, 0xbf80
.set CA_321, 0xbf80
.set CA_322, 0xbf80
.set CA_323, 0xbf80
.set CA_324, 0xbf80
.set CA_325, 0xbf80
.set CA_326, 0xbf80
.set CA_327, 0xbf7f
.set CA_328, 0xbf7f
.set CA_329, 0xbf7f
.set CA_330, 0xbf7f
.set CA_331, 0xbf7f
.set CA_332, 0xbf7e
.set CA_333, 0xbf7e
.set CA_334, 0xbf7e
.set CA_335, 0xbf7d
.set CA_336, 0xbf7d
.set CA_337, 0xbf7c
.set CA_338, 0xbf7c
.set CA_339, 0xbf7c
.set CA_340, 0xbf7b
.set CA_341, 0xbf7b
.set CA_342, 0xbf7a
.set CA_343, 0xbf7a
.set CA_344, 0xbf79
.set CA_345, 0xbf78
.set CA_346, 0xbf78
.set CA_347, 0xbf77
.set CA_348, 0xbf76
.set CA_349, 0xbf76
.set CA_350, 0xbf75
.set CA_351, 0xbf74
.set CA_352, 0xbf73
.set CA_353, 0xbf73
.set CA_354, 0xbf72
.set CA_355, 0xbf71
.set CA_356, 0xbf70
.set CA_357, 0xbf6f
.set CA_358, 0xbf6e
.set CA_359, 0xbf6d
.set CA_360, 0xbf6d
.set CA_361, 0xbf6c
.set CA_362, 0xbf6b
.set CA_363, 0xbf6a
.set CA_364, 0xbf68
.set CA_365, 0xbf67
.set CA_366, 0xbf66
.set CA_367, 0xbf65
.set CA_368, 0xbf64
.set CA_369, 0xbf63
.set CA_370, 0xbf62
.set CA_371, 0xbf61
.set CA_372, 0xbf5f
.set CA_373, 0xbf5e
.set CA_374, 0xbf5d
.set CA_375, 0xbf5c
.set CA_376, 0xbf5a
.set CA_377, 0xbf59
.set CA_378, 0xbf58
.set CA_379, 0xbf56
.set CA_380, 0xbf55
.set CA_381, 0xbf53
.set CA_382, 0xbf52
.set CA_383, 0xbf51
.set CA_384, 0xbf4f
.set CA_385, 0xbf4e
.set CA_386, 0xbf4c
.set CA_387, 0xbf4b
.set CA_388, 0xbf49
.set CA_389, 0xbf47
.set CA_390, 0xbf46
.set CA_391, 0xbf44
.set CA_392, 0xbf43
.set CA_393, 0xbf41
.set CA_394, 0xbf3f
.set CA_395, 0xbf3e
.set CA_396, 0xbf3c
.set CA_397, 0xbf3a
.set CA_398, 0xbf39
.set CA_399, 0xbf37
.set CA_400, 0xbf35
.set CA_401, 0xbf33
.set CA_402, 0xbf31
.set CA_403, 0xbf30
.set CA_404, 0xbf2e
.set CA_405, 0xbf2c
.set CA_406, 0xbf2a
.set CA_407, 0xbf28
.set CA_408, 0xbf26
.set CA_409, 0xbf24
.set CA_410, 0xbf22
.set CA_411, 0xbf20
.set CA_412, 0xbf1e
.set CA_413, 0xbf1d
.set CA_414, 0xbf1b
.set CA_415, 0xbf18
.set CA_416, 0xbf16
.set CA_417, 0xbf14
.set CA_418, 0xbf12
.set CA_419, 0xbf10
.set CA_420, 0xbf0e
.set CA_421, 0xbf0c
.set CA_422, 0xbf0a
.set CA_423, 0xbf08
.set CA_424, 0xbf06
.set CA_425, 0xbf04
.set CA_426, 0xbf01
.set CA_427, 0xbeff
.set CA_428, 0xbefa
.set CA_429, 0xbef6
.set CA_430, 0xbef1
.set CA_431, 0xbeed
.set CA_432, 0xbee8
.set CA_433, 0xbee4
.set CA_434, 0xbedf
.set CA_435, 0xbedb
.set CA_436, 0xbed6
.set CA_437, 0xbed2
.set CA_438, 0xbecd
.set CA_439, 0xbec9
.set CA_440, 0xbec4
.set CA_441, 0xbebf
.set CA_442, 0xbebb
.set CA_443, 0xbeb6
.set CA_444, 0xbeb1
.set CA_445, 0xbeac
.set CA_446, 0xbea8
.set CA_447, 0xbea3
.set CA_448, 0xbe9e
.set CA_449, 0xbe99
.set CA_450, 0xbe95
.set CA_451, 0xbe90
.set CA_452, 0xbe8b
.set CA_453, 0xbe86
.set CA_454, 0xbe81
.set CA_455, 0xbe79
.set CA_456, 0xbe6f
.set CA_457, 0xbe65
.set CA_458, 0xbe5b
.set CA_459, 0xbe52
.set CA_460, 0xbe48
.set CA_461, 0xbe3e
.set CA_462, 0xbe34
.set CA_463, 0xbe2a
.set CA_464, 0xbe20
.set CA_465, 0xbe16
.set CA_466, 0xbe0c
.set CA_467, 0xbe02
.set CA_468, 0xbdf1
.set CA_469, 0xbddd
.set CA_470, 0xbdc9
.set CA_471, 0xbdb5
.set CA_472, 0xbda1
.set CA_473, 0xbd8d
.set CA_474, 0xbd71
.set CA_475, 0xbd49
.set CA_476, 0xbd21
.set CA_477, 0xbcf1
.set CA_478, 0xbca1
.set CA_479, 0xbc21
.set CA_480, 0x0
.set CA_481, 0x3c21
.set CA_482, 0x3ca1
.set CA_483, 0x3cf1
.set CA_484, 0x3d21
.set CA_485, 0x3d49
.set CA_486, 0x3d71
.set CA_487, 0x3d8d
.set CA_488, 0x3da1
.set CA_489, 0x3db5
.set CA_490, 0x3dc9
.set CA_491, 0x3ddd
.set CA_492, 0x3df1
.set CA_493, 0x3e02
.set CA_494, 0x3e0c
.set CA_495, 0x3e16
.set CA_496, 0x3e20
.set CA_497, 0x3e2a
.set CA_498, 0x3e34
.set CA_499, 0x3e3e
.set CA_500, 0x3e48
.set CA_501, 0x3e52
.set CA_502, 0x3e5b
.set CA_503, 0x3e65
.set CA_504, 0x3e6f
.set CA_505, 0x3e79
.set CA_506, 0x3e81
.set CA_507, 0x3e86
.set CA_508, 0x3e8b
.set CA_509, 0x3e90
.set CA_510, 0x3e95
.set CA_511, 0x3e99
.set CA_512, 0x3e9e
.set CA_513, 0x3ea3
.set CA_514, 0x3ea8
.set CA_515, 0x3eac
.set CA_516, 0x3eb1
.set CA_517, 0x3eb6
.set CA_518, 0x3ebb
.set CA_519, 0x3ebf
.set CA_520, 0x3ec4
.set CA_521, 0x3ec9
.set CA_522, 0x3ecd
.set CA_523, 0x3ed2
.set CA_524, 0x3ed6
.set CA_525, 0x3edb
.set CA_526, 0x3edf
.set CA_527, 0x3ee4
.set CA_528, 0x3ee8
.set CA_529, 0x3eed
.set CA_530, 0x3ef1
.set CA_531, 0x3ef6
.set CA_532, 0x3efa
.set CA_533, 0x3eff
.set CA_534, 0x3f01
.set CA_535, 0x3f04
.set CA_536, 0x3f06
.set CA_537, 0x3f08
.set CA_538, 0x3f0a
.set CA_539, 0x3f0c
.set CA_540, 0x3f0e
.set CA_541, 0x3f10
.set CA_542, 0x3f12
.set CA_543, 0x3f14
.set CA_544, 0x3f16
.set CA_545, 0x3f18
.set CA_546, 0x3f1b
.set CA_547, 0x3f1d
.set CA_548, 0x3f1e
.set CA_549, 0x3f20
.set CA_550, 0x3f22
.set CA_551, 0x3f24
.set CA_552, 0x3f26
.set CA_553, 0x3f28
.set CA_554, 0x3f2a
.set CA_555, 0x3f2c
.set CA_556, 0x3f2e
.set CA_557, 0x3f30
.set CA_558, 0x3f31
.set CA_559, 0x3f33
.set CA_560, 0x3f35
.set CA_561, 0x3f37
.set CA_562, 0x3f39
.set CA_563, 0x3f3a
.set CA_564, 0x3f3c
.set CA_565, 0x3f3e
.set CA_566, 0x3f3f
.set CA_567, 0x3f41
.set CA_568, 0x3f43
.set CA_569, 0x3f44
.set CA_570, 0x3f46
.set CA_571, 0x3f47
.set CA_572, 0x3f49
.set CA_573, 0x3f4b
.set CA_574, 0x3f4c
.set CA_575, 0x3f4e
.set CA_576, 0x3f4f
.set CA_577, 0x3f51
.set CA_578, 0x3f52
.set CA_579, 0x3f53
.set CA_580, 0x3f55
.set CA_581, 0x3f56
.set CA_582, 0x3f58
.set CA_583, 0x3f59
.set CA_584, 0x3f5a
.set CA_585, 0x3f5c
.set CA_586, 0x3f5d
.set CA_587, 0x3f5e
.set CA_588, 0x3f5f
.set CA_589, 0x3f61
.set CA_590, 0x3f62
.set CA_591, 0x3f63
.set CA_592, 0x3f64
.set CA_593, 0x3f65
.set CA_594, 0x3f66
.set CA_595, 0x3f67
.set CA_596, 0x3f68
.set CA_597, 0x3f6a
.set CA_598, 0x3f6b
.set CA_599, 0x3f6c
.set CA_600, 0x3f6d
.set CA_601, 0x3f6d
.set CA_602, 0x3f6e
.set CA_603, 0x3f6f
.set CA_604, 0x3f70
.set CA_605, 0x3f71
.set CA_606, 0x3f72
.set CA_607, 0x3f73
.set CA_608, 0x3f73
.set CA_609, 0x3f74
.set CA_610, 0x3f75
.set CA_611, 0x3f76
.set CA_612, 0x3f76
.set CA_613, 0x3f77
.set CA_614, 0x3f78
.set CA_615, 0x3f78
.set CA_616, 0x3f79
.set CA_617, 0x3f7a
.set CA_618, 0x3f7a
.set CA_619, 0x3f7b
.set CA_620, 0x3f7b
.set CA_621, 0x3f7c
.set CA_622, 0x3f7c
.set CA_623, 0x3f7c
.set CA_624, 0x3f7d
.set CA_625, 0x3f7d
.set CA_626, 0x3f7e
.set CA_627, 0x3f7e
.set CA_628, 0x3f7e
.set CA_629, 0x3f7f
.set CA_630, 0x3f7f
.set CA_631, 0x3f7f
.set CA_632, 0x3f7f
.set CA_633, 0x3f7f
.set CA_634, 0x3f80
.set CA_635, 0x3f80
.set CA_636, 0x3f80
.set CA_637, 0x3f80
.set CA_638, 0x3f80
.set CA_639, 0x3f80
.set CB_640, 0
.set CB_641, 0x354d
.set CB_642, 0xb54d
.altmacro
.macro ea8 a,b,c,d,e,f,g,h
.short CA_\a,CA_\b,CA_\c,CA_\d,CA_\e,CA_\f,CA_\g,CA_\h
.endm
.macro eb8 a,b,c,d,e,f,g,h
.short CB_\a,CB_\b,CB_\c,CB_\d,CB_\e,CB_\f,CB_\g,CB_\h
.endm
dft_tables:
.set tks, 0
.rept 20
.set tm, 0
.rept 5
.set tl, 0
.rept 64
.set tj, 32*tm + 16*((tl>>4)&1) + 2*(tl&7) + 0
.set to, 160*((tl>>3)&1)
.if (tm - 0) < 4
.set tj, 32*(0 + ((tm - 0)&2) + ((tl>>4)&1)) + 2*(tl&15) + 0
.set to, 160*((tm - 0)&1)
.endif
.set tn, 16*tks + 8*(tl>>5)
.if (tj == 0) && (to == 160)
.set tj, 320
.set to, 0
.endif
ea8 %(((tn+0)*tj+to)%640),%(((tn+1)*tj+to)%640),%(((tn+2)*tj+to)%640),%(((tn+3)*tj+to)%640),%(((tn+4)*tj+to)%640),%(((tn+5)*tj+to)%640),%(((tn+6)*tj+to)%640),%(((tn+7)*tj+to)%640)
.set tl, tl+1
.endr
.set tm, tm+1
.endr
.set tks, tks+1
.endr
.set tks, 0
.rept 20
.set tm, 5
.rept 5
.set tl, 0
.rept 64
.set tj, 32*tm + 16*((tl>>4)&1) + 2*(tl&7) + 0
.set to, 160*((tl>>3)&1)
.if (tm - 5) < 4
.set tj, 32*(5 + ((tm - 5)&2) + ((tl>>4)&1)) + 2*(tl&15) + 0
.set to, 160*((tm - 5)&1)
.endif
.set tn, 16*tks + 8*(tl>>5)
.if (tj == 0) && (to == 160)
.set tj, 320
.set to, 0
.endif
ea8 %(((tn+0)*tj+to)%640),%(((tn+1)*tj+to)%640),%(((tn+2)*tj+to)%640),%(((tn+3)*tj+to)%640),%(((tn+4)*tj+to)%640),%(((tn+5)*tj+to)%640),%(((tn+6)*tj+to)%640),%(((tn+7)*tj+to)%640)
.set tl, tl+1
.endr
.set tm, tm+1
.endr
.set tks, tks+1
.endr
.set tks, 0
.rept 20
.set tm, 0
.rept 5
.set tl, 0
.rept 64
.set tj, 32*tm + 16*((tl>>4)&1) + 2*(tl&7) + 1
.set to, 160*((tl>>3)&1)
.if (tm - 0) < 4
.set tj, 32*(0 + ((tm - 0)&2) + ((tl>>4)&1)) + 2*(tl&15) + 1
.set to, 160*((tm - 0)&1)
.endif
.set tn, 16*tks + 8*(tl>>5)
.if (tj == 0) && (to == 160)
.set tj, 320
.set to, 0
.endif
ea8 %(((tn+0)*tj+to)%640),%(((tn+1)*tj+to)%640),%(((tn+2)*tj+to)%640),%(((tn+3)*tj+to)%640),%(((tn+4)*tj+to)%640),%(((tn+5)*tj+to)%640),%(((tn+6)*tj+to)%640),%(((tn+7)*tj+to)%640)
.set tl, tl+1
.endr
.set tm, tm+1
.endr
.set tks, tks+1
.endr
.set tks, 0
.rept 20
.set tm, 5
.rept 5
.set tl, 0
.rept 64
.set tj, 32*tm + 16*((tl>>4)&1) + 2*(tl&7) + 1
.set to, 160*((tl>>3)&1)
.if (tm - 5) < 4
.set tj, 32*(5 + ((tm - 5)&2) + ((tl>>4)&1)) + 2*(tl&15) + 1
.set to, 160*((tm - 5)&1)
.endif
.set tn, 16*tks + 8*(tl>>5)
.if (tj == 0) && (to == 160)
.set tj, 320
.set to, 0
.endif
ea8 %(((tn+0)*tj+to)%640),%(((tn+1)*tj+to)%640),%(((tn+2)*tj+to)%640),%(((tn+3)*tj+to)%640),%(((tn+4)*tj+to)%640),%(((tn+5)*tj+to)%640),%(((tn+6)*tj+to)%640),%(((tn+7)*tj+to)%640)
.set tl, tl+1
.endr
.set tm, tm+1
.endr
.set tks, tks+1
.endr
.noaltmacro
.quad 0x3f803f803f803f80,0x3f803f803f803f80,0xbe4800003f7b3f80,0x3e480000bf7bbf80
.quad 0xbf6dbf803f6d3f80,0xbf6dbf803f6d3f80,0x3f0e00003f553f80,0xbf0e0000bf55bf80
.quad 0x3f353f803f353f80,0x3f353f803f353f80,0xbf5500003f0e3f80,0x3f550000bf0ebf80
.quad 0xbec4bf803ec43f80,0xbec4bf803ec43f80,0x3f7b00003e483f80,0xbf7b0000be48bf80
.quad 0x3f8000003f80,0x3f8000003f80,0xbf7b0000be483f80,0x3f7b00003e48bf80
.quad 0x3ec4bf80bec43f80,0x3ec4bf80bec43f80,0x3f550000bf0e3f80,0xbf5500003f0ebf80
.quad 0xbf353f80bf353f80,0xbf353f80bf353f80,0xbf0e0000bf553f80,0x3f0e00003f55bf80
.quad 0x3f6dbf80bf6d3f80,0x3f6dbf80bf6d3f80,0x3e480000bf7b3f80,0xbe4800003f7bbf80
.quad 0x3f803f803f803f80,0x3f803f803f803f80,0xbf0ebec43f553f6d,0x3f0e3ec4bf55bf6d
.quad 0xbec4bf353ec43f35,0xbec4bf353ec43f35,0x3f7b3f6dbe483ec4,0xbf7bbf6d3e48bec4
.quad 0xbf350000bf350000,0xbf350000bf350000,0xbe48bf6dbf7bbec4,0x3e483f6d3f7b3ec4
.quad 0x3f6d3f35bf6dbf35,0x3f6d3f35bf6dbf35,0xbf553ec4bf0ebf6d,0x3f55bec43f0e3f6d
.quad 0xbf800000bf80,0xbf800000bf80,0x3f553ec43f0ebf6d,0xbf55bec4bf0e3f6d
.quad 0xbf6d3f353f6dbf35,0xbf6d3f353f6dbf35,0x3e48bf6d3f7bbec4,0xbe483f6dbf7b3ec4
.quad 0x3f3500003f350000,0x3f3500003f350000,0xbf7b3f6d3e483ec4,0x3f7bbf6dbe48bec4
.quad 0x3ec4bf35bec43f35,0x3ec4bf35bec43f35,0x3f0ebec4bf553f6d,0xbf0e3ec43f55bf6d
.quad 0x3f803f803f803f80,0x3f803f803f803f80,0xbf55bf353f0e3f35,0x3f553f35bf0ebf35
.quad 0x3ec40000bec40000,0x3ec40000bec40000,0x3e483f35bf7bbf35,0xbe48bf353f7b3f35
.quad 0xbf35bf80bf35bf80,0xbf35bf80bf35bf80,0x3f7b3f353e48bf35,0xbf7bbf35be483f35
.quad 0xbf6d00003f6d0000,0xbf6d00003f6d0000,0x3f0ebf353f553f35,0xbf0e3f35bf55bf35
.quad 0x3f8000003f80,0x3f8000003f80,0xbf0ebf35bf553f35,0x3f0e3f353f55bf35
.quad 0x3f6d0000bf6d0000,0x3f6d0000bf6d0000,0xbf7b3f35be48bf35,0x3f7bbf353e483f35
.quad 0x3f35bf803f35bf80,0x3f35bf803f35bf80,0xbe483f353f7bbf35,0x3e48bf35bf7b3f35
.quad 0xbec400003ec40000,0xbec400003ec40000,0x3f55bf35bf0e3f35,0xbf553f353f0ebf35
.quad 0x3f803f803f803f80,0x3f803f803f803f80,0xbf7bbf6d3e483ec4,0x3f7b3f6dbe48bec4
.quad 0x3f6d3f35bf6dbf35,0x3f6d3f35bf6dbf35,0xbf55bec4bf0ebf6d,0x3f553ec43f0e3f6d
.quad 0x3f3500003f350000,0x3f3500003f350000,0xbf0e3ec43f553f6d,0x3f0ebec4bf55bf6d
.quad 0x3ec4bf35bec43f35,0x3ec4bf35bec43f35,0xbe483f6dbf7bbec4,0x3e48bf6d3f7b3ec4
.quad 0xbf800000bf80,0xbf800000bf80,0x3e483f6d3f7bbec4,0xbe48bf6dbf7b3ec4
.quad 0xbec4bf353ec43f35,0xbec4bf353ec43f35,0x3f0e3ec4bf553f6d,0xbf0ebec43f55bf6d
.quad 0xbf350000bf350000,0xbf350000bf350000,0x3f55bec43f0ebf6d,0xbf553ec4bf0e3f6d
.quad 0xbf6d3f353f6dbf35,0xbf6d3f353f6dbf35,0x3f7bbf6dbe483ec4,0xbf7b3f6d3e48bec4
.quad 0x3f803f803f803f80,0x3f803f803f803f80,0xbe95bdc93f753f7f,0x3e953dc9bf75bf7f
.quad 0xbf55bf7b3f553f7b,0xbf55bf7b3f553f7b,0x3f463e953f223f75,0xbf46be95bf22bf75
.quad 0x3ec43f6d3ec43f6d,0x3ec43f6d3ec43f6d,0xbf7fbef13dc93f62,0x3f7f3ef1bdc9bf62
.quad 0x3e48bf55be483f55,0x3e48bf55be483f55,0x3f623f22bef13f46,0xbf62bf223ef1bf46
.quad 0xbf353f35bf353f35,0xbf353f35bf353f35,0xbef1bf46bf623f22,0x3ef13f463f62bf22
.quad 0x3f7bbf0ebf7b3f0e,0x3f7bbf0ebf7b3f0e,0xbdc93f62bf7f3ef1,0x3dc9bf623f7fbef1
.quad 0xbf6d3ec4bf6d3ec4,0xbf6d3ec4bf6d3ec4,0x3f22bf75bf463e95,0xbf223f753f46be95
.quad 0x3f0ebe48bf0e3e48,0x3f0ebe48bf0e3e48,0xbf753f7fbe953dc9,0x3f75bf7f3e95bdc9
.quad 0x3f803f803f803f80,0x3f803f803f803f80,0xbf22bef13f463f62,0x3f223ef1bf46bf62
.quad 0xbe48bf0e3e483f0e,0xbe48bf0e3e483f0e,0x3f623f7fbef13dc9,0xbf62bf7f3ef1bdc9
.quad 0xbf6dbec4bf6dbec4,0xbf6dbec4bf6dbec4,0x3e95bf22bf75bf46,0xbe953f223f753f46
.quad 0x3f0e3f7bbf0ebf7b,0x3f0e3f7bbf0ebf7b,0xbf7fbe953dc9bf75,0x3f7f3e95bdc93f75
.quad 0x3f35bf353f35bf35,0x3f35bf353f35bf35,0x3dc93f753f7fbe95,0xbdc9bf75bf7f3e95
.quad 0xbf55be483f553e48,0xbf55be483f553e48,0x3f75bf463e953f22,0xbf753f46be95bf22
.quad 0xbec43f6dbec43f6d,0xbec43f6dbec43f6d,0xbef1bdc9bf623f7f,0x3ef13dc93f62bf7f
.quad 0x3f7bbf55bf7b3f55,0x3f7bbf55bf7b3f55,0xbf463f62bf223ef1,0x3f46bf623f22bef1
.quad 0x3f803f803f803f80,0x3f803f803f803f80,0xbf62bf463ef13f22,0x3f623f46bef1bf22
.quad 0x3f0e3e48bf0ebe48,0x3f0e3e48bf0ebe48,0xbdc93ef1bf7fbf62,0x3dc9bef13f7f3f62
.quad 0xbec4bf6dbec4bf6d,0xbec4bf6dbec4bf6d,0x3f463f753f22be95,0xbf46bf75bf223e95
.quad 0xbf7bbf0e3f7b3f0e,0xbf7bbf0e3f7b3f0e,0x3f75bdc93e953f7f,0xbf753dc9be95bf7f
.quad 0xbf353f35bf353f35,0xbf353f35bf353f35,0x3e95bf7fbf75bdc9,0xbe953f7f3f753dc9
.quad 0x3e483f55be48bf55,0x3e483f55be48bf55,0xbf22be953f46bf75,0x3f223e95bf463f75
.quad 0x3f6dbec43f6dbec4,0x3f6dbec43f6dbec4,0xbf7f3f623dc93ef1,0x3f7fbf62bdc9bef1
.quad 0x3f55bf7bbf553f7b,0x3f55bf7bbf553f7b,0xbef13f22bf623f46,0x3ef1bf223f62bf46
.quad 0x3f803f803f803f80,0x3f803f803f803f80,0xbf7fbf753dc93e95,0x3f7f3f75bdc9be95
.quad 0x3f7b3f55bf7bbf55,0x3f7b3f55bf7bbf55,0xbf75bf22be95bf46,0x3f753f223e953f46
.quad 0x3f6d3ec43f6d3ec4,0x3f6d3ec43f6d3ec4,0xbf62bdc93ef13f7f,0x3f623dc9bef1bf7f
.quad 0x3f55be48bf553e48,0x3f55be48bf553e48,0xbf463ef1bf22bf62,0x3f46bef13f223f62
.quad 0x3f35bf353f35bf35,0x3f35bf353f35bf35,0xbf223f623f463ef1,0x3f22bf62bf46bef1
.quad 0x3f0ebf7bbf0e3f7b,0x3f0ebf7bbf0e3f7b,0xbef13f7fbf623dc9,0x3ef1bf7f3f62bdc9
.quad 0x3ec4bf6d3ec4bf6d,0x3ec4bf6d3ec4bf6d,0xbe953f463f75bf22,0x3e95bf46bf753f22
.quad 0x3e48bf0ebe483f0e,0x3e48bf0ebe483f0e,0xbdc93e95bf7f3f75,0x3dc9be953f7fbf75
.quad 0xbf803f80bf803f80,0xbf803f80bf803f80,0x3e480000bf7b3f80,0xbe4800003f7bbf80
.quad 0x3f6dbf80bf6d3f80,0x3f6dbf80bf6d3f80,0xbf0e0000bf553f80,0x3f0e00003f55bf80
.quad 0xbf353f80bf353f80,0xbf353f80bf353f80,0x3f550000bf0e3f80,0xbf5500003f0ebf80
.quad 0x3ec4bf80bec43f80,0x3ec4bf80bec43f80,0xbf7b0000be483f80,0x3f7b00003e48bf80
.quad 0x3f8000003f80,0x3f8000003f80,0x3f7b00003e483f80,0xbf7b0000be48bf80
.quad 0xbec4bf803ec43f80,0xbec4bf803ec43f80,0xbf5500003f0e3f80,0x3f550000bf0ebf80
.quad 0x3f353f803f353f80,0x3f353f803f353f80,0x3f0e00003f553f80,0xbf0e0000bf55bf80
.quad 0xbf6dbf803f6d3f80,0xbf6dbf803f6d3f80,0xbe4800003f7b3f80,0x3e480000bf7bbf80
.quad 0xbf803f80bf803f80,0xbf803f80bf803f80,0x3f0ebec4bf553f6d,0xbf0e3ec43f55bf6d
.quad 0x3ec4bf35bec43f35,0x3ec4bf35bec43f35,0xbf7b3f6d3e483ec4,0x3f7bbf6dbe48bec4
.quad 0x3f3500003f350000,0x3f3500003f350000,0x3e48bf6d3f7bbec4,0xbe483f6dbf7b3ec4
.quad 0xbf6d3f353f6dbf35,0xbf6d3f353f6dbf35,0x3f553ec43f0ebf6d,0xbf55bec4bf0e3f6d
.quad 0xbf800000bf80,0xbf800000bf80,0xbf553ec4bf0ebf6d,0x3f55bec43f0e3f6d
.quad 0x3f6d3f35bf6dbf35,0x3f6d3f35bf6dbf35,0xbe48bf6dbf7bbec4,0x3e483f6d3f7b3ec4
.quad 0xbf350000bf350000,0xbf350000bf350000,0x3f7b3f6dbe483ec4,0xbf7bbf6d3e48bec4
.quad 0xbec4bf353ec43f35,0xbec4bf353ec43f35,0xbf0ebec43f553f6d,0x3f0e3ec4bf55bf6d
.quad 0xbf803f80bf803f80,0xbf803f80bf803f80,0x3f55bf35bf0e3f35,0xbf553f353f0ebf35
.quad 0xbec400003ec40000,0xbec400003ec40000,0xbe483f353f7bbf35,0x3e48bf35bf7b3f35
.quad 0x3f35bf803f35bf80,0x3f35bf803f35bf80,0xbf7b3f35be48bf35,0x3f7bbf353e483f35
.quad 0x3f6d0000bf6d0000,0x3f6d0000bf6d0000,0xbf0ebf35bf553f35,0x3f0e3f353f55bf35
.quad 0x3f8000003f80,0x3f8000003f80,0x3f0ebf353f553f35,0xbf0e3f35bf55bf35
.quad 0xbf6d00003f6d0000,0xbf6d00003f6d0000,0x3f7b3f353e48bf35,0xbf7bbf35be483f35
.quad 0xbf35bf80bf35bf80,0xbf35bf80bf35bf80,0x3e483f35bf7bbf35,0xbe48bf353f7b3f35
.quad 0x3ec40000bec40000,0x3ec40000bec40000,0xbf55bf353f0e3f35,0x3f553f35bf0ebf35
.quad 0xbf803f80bf803f80,0xbf803f80bf803f80,0x3f7bbf6dbe483ec4,0xbf7b3f6d3e48bec4
.quad 0xbf6d3f353f6dbf35,0xbf6d3f353f6dbf35,0x3f55bec43f0ebf6d,0xbf553ec4bf0e3f6d
.quad 0xbf350000bf350000,0xbf350000bf350000,0x3f0e3ec4bf553f6d,0xbf0ebec43f55bf6d
.quad 0xbec4bf353ec43f35,0xbec4bf353ec43f35,0x3e483f6d3f7bbec4,0xbe48bf6dbf7b3ec4
.quad 0xbf800000bf80,0xbf800000bf80,0xbe483f6dbf7bbec4,0x3e48bf6d3f7b3ec4
.quad 0x3ec4bf35bec43f35,0x3ec4bf35bec43f35,0xbf0e3ec43f553f6d,0x3f0ebec4bf55bf6d
.quad 0x3f3500003f350000,0x3f3500003f350000,0xbf55bec4bf0ebf6d,0x3f553ec43f0e3f6d
.quad 0x3f6d3f35bf6dbf35,0x3f6d3f35bf6dbf35,0xbf7bbf6d3e483ec4,0x3f7b3f6dbe48bec4
.quad 0x0,0x0,0x3f75bf7f3e95bdc9,0xbf753f7fbe953dc9
.quad 0xbf0e3e483f0ebe48,0xbf0e3e483f0ebe48,0xbf223f753f46be95,0x3f22bf75bf463e95
.quad 0x3f6dbec43f6dbec4,0x3f6dbec43f6dbec4,0x3dc9bf623f7fbef1,0xbdc93f62bf7f3ef1
.quad 0xbf7b3f0e3f7bbf0e,0xbf7b3f0e3f7bbf0e,0x3ef13f463f62bf22,0xbef1bf46bf623f22
.quad 0x3f35bf353f35bf35,0x3f35bf353f35bf35,0xbf62bf223ef1bf46,0x3f623f22bef13f46
.quad 0xbe483f553e48bf55,0xbe483f553e48bf55,0x3f7f3ef1bdc9bf62,0xbf7fbef13dc93f62
.quad 0xbec4bf6dbec4bf6d,0xbec4bf6dbec4bf6d,0xbf46be95bf22bf75,0x3f463e953f223f75
.quad 0x3f553f7bbf55bf7b,0x3f553f7bbf55bf7b,0x3e953dc9bf75bf7f,0xbe95bdc93f753f7f
.quad 0x0,0x0,0x3f46bf623f22bef1,0xbf463f62bf223ef1
.quad 0xbf7b3f553f7bbf55,0xbf7b3f553f7bbf55,0x3ef13dc93f62bf7f,0xbef1bdc9bf623f7f
.quad 0x3ec4bf6d3ec4bf6d,0x3ec4bf6d3ec4bf6d,0xbf753f46be95bf22,0x3f75bf463e953f22
.quad 0x3f553e48bf55be48,0x3f553e48bf55be48,0xbdc9bf75bf7f3e95,0x3dc93f753f7fbe95
.quad 0xbf353f35bf353f35,0xbf353f35bf353f35,0x3f7f3e95bdc93f75,0xbf7fbe953dc9bf75
.quad 0xbf0ebf7b3f0e3f7b,0xbf0ebf7b3f0e3f7b,0xbe953f223f753f46,0x3e95bf22bf75bf46
.quad 0x3f6d3ec43f6d3ec4,0x3f6d3ec43f6d3ec4,0xbf62bf7f3ef1bdc9,0x3f623f7fbef13dc9
.quad 0x3e483f0ebe48bf0e,0x3e483f0ebe48bf0e,0x3f223ef1bf46bf62,0xbf22bef13f463f62
.quad 0x0,0x0,0x3ef1bf223f62bf46,0xbef13f22bf623f46
.quad 0xbf553f7b3f55bf7b,0xbf553f7b3f55bf7b,0x3f7fbf62bdc9bef1,0xbf7f3f623dc93ef1
.quad 0xbf6d3ec4bf6d3ec4,0xbf6d3ec4bf6d3ec4,0x3f223e95bf463f75,0xbf22be953f46bf75
.quad 0xbe48bf553e483f55,0xbe48bf553e483f55,0xbe953f7f3f753dc9,0x3e95bf7fbf75bdc9
.quad 0x3f35bf353f35bf35,0x3f35bf353f35bf35,0xbf753dc9be95bf7f,0x3f75bdc93e953f7f
.quad 0x3f7b3f0ebf7bbf0e,0x3f7b3f0ebf7bbf0e,0xbf46bf75bf223e95,0x3f463f753f22be95
.quad 0x3ec43f6d3ec43f6d,0x3ec43f6d3ec43f6d,0x3dc9bef13f7f3f62,0xbdc93ef1bf7fbf62
.quad 0xbf0ebe483f0e3e48,0xbf0ebe483f0e3e48,0x3f623f46bef1bf22,0xbf62bf463ef13f22
.quad 0x0,0x0,0x3dc9be953f7fbf75,0xbdc93e95bf7f3f75
.quad 0xbe483f0e3e48bf0e,0xbe483f0e3e48bf0e,0x3e95bf46bf753f22,0xbe953f463f75bf22
.quad 0xbec43f6dbec43f6d,0xbec43f6dbec43f6d,0x3ef1bf7f3f62bdc9,0xbef13f7fbf623dc9
.quad 0xbf0e3f7b3f0ebf7b,0xbf0e3f7b3f0ebf7b,0x3f22bf62bf46bef1,0xbf223f623f463ef1
.quad 0xbf353f35bf353f35,0xbf353f35bf353f35,0x3f46bef13f223f62,0xbf463ef1bf22bf62
.quad 0xbf553e483f55be48,0xbf553e483f55be48,0x3f623dc9bef1bf7f,0xbf62bdc93ef13f7f
.quad 0xbf6dbec4bf6dbec4,0xbf6dbec4bf6dbec4,0x3f753f223e953f46,0xbf75bf22be95bf46
.quad 0xbf7bbf553f7b3f55,0xbf7bbf553f7b3f55,0x3f7f3f75bdc9be95,0xbf7fbf753dc93e95
.quad 0x0,0x0,0xbf7bbf80be480000,0x3f7b3f803e480000
.quad 0x3ec40000bec40000,0x3ec40000bec40000,0x3f553f80bf0e0000,0xbf55bf803f0e0000
.quad 0xbf350000bf350000,0xbf350000bf350000,0xbf0ebf80bf550000,0x3f0e3f803f550000
.quad 0x3f6d0000bf6d0000,0x3f6d0000bf6d0000,0x3e483f80bf7b0000,0xbe48bf803f7b0000
.quad 0xbf800000bf800000,0xbf800000bf800000,0x3e48bf80bf7b0000,0xbe483f803f7b0000
.quad 0x3f6d0000bf6d0000,0x3f6d0000bf6d0000,0xbf0e3f80bf550000,0x3f0ebf803f550000
.quad 0xbf350000bf350000,0xbf350000bf350000,0x3f55bf80bf0e0000,0xbf553f803f0e0000
.quad 0x3ec40000bec40000,0x3ec40000bec40000,0xbf7b3f80be480000,0x3f7bbf803e480000
.quad 0x0,0x0,0xbf55bf6dbf0ebec4,0x3f553f6d3f0e3ec4
.quad 0x3f6d3f35bf6dbf35,0x3f6d3f35bf6dbf35,0xbe483ec4bf7bbf6d,0x3e48bec43f7b3f6d
.quad 0xbf35bf80bf35bf80,0xbf35bf80bf35bf80,0x3f7b3ec4be48bf6d,0xbf7bbec43e483f6d
.quad 0xbec43f353ec4bf35,0xbec43f353ec4bf35,0xbf0ebf6d3f55bec4,0x3f0e3f6dbf553ec4
.quad 0x3f8000003f800000,0x3f8000003f800000,0xbf0e3f6d3f553ec4,0x3f0ebf6dbf55bec4
.quad 0xbec4bf353ec43f35,0xbec4bf353ec43f35,0x3f7bbec4be483f6d,0xbf7b3ec43e48bf6d
.quad 0xbf353f80bf353f80,0xbf353f80bf353f80,0xbe48bec4bf7b3f6d,0x3e483ec43f7bbf6d
.quad 0x3f6dbf35bf6d3f35,0x3f6dbf35bf6d3f35,0xbf553f6dbf0e3ec4,0x3f55bf6d3f0ebec4
.quad 0x0,0x0,0xbf0ebf35bf55bf35,0x3f0e3f353f553f35
.quad 0x3f6d3f80bf6dbf80,0x3f6d3f80bf6dbf80,0xbf7bbf35be48bf35,0x3f7b3f353e483f35
.quad 0x3f3500003f350000,0x3f3500003f350000,0xbe483f353f7b3f35,0x3e48bf35bf7bbf35
.quad 0xbec4bf803ec43f80,0xbec4bf803ec43f80,0x3f553f35bf0e3f35,0xbf55bf353f0ebf35
.quad 0xbf800000bf800000,0xbf800000bf800000,0x3f55bf35bf0ebf35,0xbf553f353f0e3f35
.quad 0xbec43f803ec4bf80,0xbec43f803ec4bf80,0xbe48bf353f7bbf35,0x3e483f35bf7b3f35
.quad 0x3f3500003f350000,0x3f3500003f350000,0xbf7b3f35be483f35,0x3f7bbf353e48bf35
.quad 0x3f6dbf80bf6d3f80,0x3f6dbf80bf6d3f80,0xbf0e3f35bf553f35,0x3f0ebf353f55bf35
.quad 0x0,0x0,0xbe48bec4bf7bbf6d,0x3e483ec43f7b3f6d
.quad 0x3ec43f35bec4bf35,0x3ec43f35bec4bf35,0xbf0ebf6d3f553ec4,0x3f0e3f6dbf55bec4
.quad 0x3f353f803f353f80,0x3f353f803f353f80,0xbf55bf6dbf0e3ec4,0x3f553f6d3f0ebec4
.quad 0x3f6d3f35bf6dbf35,0x3f6d3f35bf6dbf35,0xbf7bbec43e48bf6d,0x3f7b3ec4be483f6d
.quad 0x3f8000003f800000,0x3f8000003f800000,0xbf7b3ec43e483f6d,0x3f7bbec4be48bf6d
.quad 0x3f6dbf35bf6d3f35,0x3f6dbf35bf6d3f35,0xbf553f6dbf0ebec4,0x3f55bf6d3f0e3ec4
.quad 0x3f35bf803f35bf80,0x3f35bf803f35bf80,0xbf0e3f6d3f55bec4,0x3f0ebf6dbf553ec4
.quad 0x3ec4bf35bec43f35,0x3ec4bf35bec43f35,0xbe483ec4bf7b3f6d,0x3e48bec43f7bbf6d
.quad 0x0,0x0,0xbf75bf7fbe95bdc9,0x3f753f7f3e953dc9
.quad 0x3f0e3e48bf0ebe48,0x3f0e3e48bf0ebe48,0x3f223f75bf46be95,0xbf22bf753f463e95
.quad 0xbf6dbec4bf6dbec4,0xbf6dbec4bf6dbec4,0xbdc9bf62bf7fbef1,0x3dc93f623f7f3ef1
.quad 0x3f7b3f0ebf7bbf0e,0x3f7b3f0ebf7bbf0e,0xbef13f46bf62bf22,0x3ef1bf463f623f22
.quad 0xbf35bf35bf35bf35,0xbf35bf35bf35bf35,0x3f62bf22bef1bf46,0xbf623f223ef13f46
.quad 0x3e483f55be48bf55,0x3e483f55be48bf55,0xbf7f3ef13dc9bf62,0x3f7fbef1bdc93f62
.quad 0x3ec4bf6d3ec4bf6d,0x3ec4bf6d3ec4bf6d,0x3f46be953f22bf75,0xbf463e95bf223f75
.quad 0xbf553f7b3f55bf7b,0xbf553f7b3f55bf7b,0xbe953dc93f75bf7f,0x3e95bdc9bf753f7f
.quad 0x0,0x0,0xbf46bf62bf22bef1,0x3f463f623f223ef1
.quad 0x3f7b3f55bf7bbf55,0x3f7b3f55bf7bbf55,0xbef13dc9bf62bf7f,0x3ef1bdc93f623f7f
.quad 0xbec4bf6dbec4bf6d,0xbec4bf6dbec4bf6d,0x3f753f463e95bf22,0xbf75bf46be953f22
.quad 0xbf553e483f55be48,0xbf553e483f55be48,0x3dc9bf753f7f3e95,0xbdc93f75bf7fbe95
.quad 0x3f353f353f353f35,0x3f353f353f353f35,0xbf7f3e953dc93f75,0x3f7fbe95bdc9bf75
.quad 0x3f0ebf7bbf0e3f7b,0x3f0ebf7bbf0e3f7b,0x3e953f22bf753f46,0xbe95bf223f75bf46
.quad 0xbf6d3ec4bf6d3ec4,0xbf6d3ec4bf6d3ec4,0x3f62bf7fbef1bdc9,0xbf623f7f3ef13dc9
.quad 0xbe483f0e3e48bf0e,0xbe483f0e3e48bf0e,0xbf223ef13f46bf62,0x3f22bef1bf463f62
.quad 0x0,0x0,0xbef1bf22bf62bf46,0x3ef13f223f623f46
.quad 0x3f553f7bbf55bf7b,0x3f553f7bbf55bf7b,0xbf7fbf623dc9bef1,0x3f7f3f62bdc93ef1
.quad 0x3f6d3ec43f6d3ec4,0x3f6d3ec43f6d3ec4,0xbf223e953f463f75,0x3f22be95bf46bf75
.quad 0x3e48bf55be483f55,0x3e48bf55be483f55,0x3e953f7fbf753dc9,0xbe95bf7f3f75bdc9
.quad 0xbf35bf35bf35bf35,0xbf35bf35bf35bf35,0x3f753dc93e95bf7f,0xbf75bdc9be953f7f
.quad 0xbf7b3f0e3f7bbf0e,0xbf7b3f0e3f7bbf0e,0x3f46bf753f223e95,0xbf463f75bf22be95
.quad 0xbec43f6dbec43f6d,0xbec43f6dbec43f6d,0xbdc9bef1bf7f3f62,0x3dc93ef13f7fbf62
.quad 0x3f0ebe48bf0e3e48,0x3f0ebe48bf0e3e48,0xbf623f463ef1bf22,0x3f62bf46bef13f22
.quad 0x0,0x0,0xbdc9be95bf7fbf75,0x3dc93e953f7f3f75
.quad 0x3e483f0ebe48bf0e,0x3e483f0ebe48bf0e,0xbe95bf463f753f22,0x3e953f46bf75bf22
.quad 0x3ec43f6d3ec43f6d,0x3ec43f6d3ec43f6d,0xbef1bf7fbf62bdc9,0x3ef13f7f3f623dc9
.quad 0x3f0e3f7bbf0ebf7b,0x3f0e3f7bbf0ebf7b,0xbf22bf623f46bef1,0x3f223f62bf463ef1
.quad 0x3f353f353f353f35,0x3f353f353f353f35,0xbf46bef1bf223f62,0x3f463ef13f22bf62
.quad 0x3f553e48bf55be48,0x3f553e48bf55be48,0xbf623dc93ef1bf7f,0x3f62bdc9bef13f7f
.quad 0x3f6dbec43f6dbec4,0x3f6dbec43f6dbec4,0xbf753f22be953f46,0x3f75bf223e95bf46
.quad 0x3f7bbf55bf7b3f55,0x3f7bbf55bf7b3f55,0xbf7f3f753dc9be95,0x3f7fbf75bdc93e95
.quad 0x0,0x0,0x3f7bbf803e480000,0xbf7b3f80be480000
.quad 0xbec400003ec40000,0xbec400003ec40000,0xbf553f803f0e0000,0x3f55bf80bf0e0000
.quad 0x3f3500003f350000,0x3f3500003f350000,0x3f0ebf803f550000,0xbf0e3f80bf550000
.quad 0xbf6d00003f6d0000,0xbf6d00003f6d0000,0xbe483f803f7b0000,0x3e48bf80bf7b0000
.quad 0x3f8000003f800000,0x3f8000003f800000,0xbe48bf803f7b0000,0x3e483f80bf7b0000
.quad 0xbf6d00003f6d0000,0xbf6d00003f6d0000,0x3f0e3f803f550000,0xbf0ebf80bf550000
.quad 0x3f3500003f350000,0x3f3500003f350000,0xbf55bf803f0e0000,0x3f553f80bf0e0000
.quad 0xbec400003ec40000,0xbec400003ec40000,0x3f7b3f803e480000,0xbf7bbf80be480000
.quad 0x0,0x0,0x3f55bf6d3f0ebec4,0xbf553f6dbf0e3ec4
.quad 0xbf6d3f353f6dbf35,0xbf6d3f353f6dbf35,0x3e483ec43f7bbf6d,0xbe48bec4bf7b3f6d
.quad 0x3f35bf803f35bf80,0x3f35bf803f35bf80,0xbf7b3ec43e48bf6d,0x3f7bbec4be483f6d
.quad 0x3ec43f35bec4bf35,0x3ec43f35bec4bf35,0x3f0ebf6dbf55bec4,0xbf0e3f6d3f553ec4
.quad 0xbf800000bf800000,0xbf800000bf800000,0x3f0e3f6dbf553ec4,0xbf0ebf6d3f55bec4
.quad 0x3ec4bf35bec43f35,0x3ec4bf35bec43f35,0xbf7bbec43e483f6d,0x3f7b3ec4be48bf6d
.quad 0x3f353f803f353f80,0x3f353f803f353f80,0x3e48bec43f7b3f6d,0xbe483ec4bf7bbf6d
.quad 0xbf6dbf353f6d3f35,0xbf6dbf353f6d3f35,0x3f553f6d3f0e3ec4,0xbf55bf6dbf0ebec4
.quad 0x0,0x0,0x3f0ebf353f55bf35,0xbf0e3f35bf553f35
.quad 0xbf6d3f803f6dbf80,0xbf6d3f803f6dbf80,0x3f7bbf353e48bf35,0xbf7b3f35be483f35
.quad 0xbf350000bf350000,0xbf350000bf350000,0x3e483f35bf7b3f35,0xbe48bf353f7bbf35
.quad 0x3ec4bf80bec43f80,0x3ec4bf80bec43f80,0xbf553f353f0e3f35,0x3f55bf35bf0ebf35
.quad 0x3f8000003f800000,0x3f8000003f800000,0xbf55bf353f0ebf35,0x3f553f35bf0e3f35
.quad 0x3ec43f80bec4bf80,0x3ec43f80bec4bf80,0x3e48bf35bf7bbf35,0xbe483f353f7b3f35
.quad 0xbf350000bf350000,0xbf350000bf350000,0x3f7b3f353e483f35,0xbf7bbf35be48bf35
.quad 0xbf6dbf803f6d3f80,0xbf6dbf803f6d3f80,0x3f0e3f353f553f35,0xbf0ebf35bf55bf35
.quad 0x0,0x0,0x3e48bec43f7bbf6d,0xbe483ec4bf7b3f6d
.quad 0xbec43f353ec4bf35,0xbec43f353ec4bf35,0x3f0ebf6dbf553ec4,0xbf0e3f6d3f55bec4
.quad 0xbf353f80bf353f80,0xbf353f80bf353f80,0x3f55bf6d3f0e3ec4,0xbf553f6dbf0ebec4
.quad 0xbf6d3f353f6dbf35,0xbf6d3f353f6dbf35,0x3f7bbec4be48bf6d,0xbf7b3ec43e483f6d
.quad 0xbf800000bf800000,0xbf800000bf800000,0x3f7b3ec4be483f6d,0xbf7bbec43e48bf6d
.quad 0xbf6dbf353f6d3f35,0xbf6dbf353f6d3f35,0x3f553f6d3f0ebec4,0xbf55bf6dbf0e3ec4
.quad 0xbf35bf80bf35bf80,0xbf35bf80bf35bf80,0x3f0e3f6dbf55bec4,0xbf0ebf6d3f553ec4
.quad 0xbec4bf353ec43f35,0xbec4bf353ec43f35,0x3e483ec43f7b3f6d,0xbe48bec4bf7bbf6d
.quad 0x3f80bf803f80bf80,0x3f80bf803f80bf80,0xbe953dc93f75bf7f,0x3e95bdc9bf753f7f
.quad 0xbf553f7b3f55bf7b,0xbf553f7b3f55bf7b,0x3f46be953f22bf75,0xbf463e95bf223f75
.quad 0x3ec4bf6d3ec4bf6d,0x3ec4bf6d3ec4bf6d,0xbf7f3ef13dc9bf62,0x3f7fbef1bdc93f62
.quad 0x3e483f55be48bf55,0x3e483f55be48bf55,0x3f62bf22bef1bf46,0xbf623f223ef13f46
.quad 0xbf35bf35bf35bf35,0xbf35bf35bf35bf35,0xbef13f46bf62bf22,0x3ef1bf463f623f22
.quad 0x3f7b3f0ebf7bbf0e,0x3f7b3f0ebf7bbf0e,0xbdc9bf62bf7fbef1,0x3dc93f623f7f3ef1
.quad 0xbf6dbec4bf6dbec4,0xbf6dbec4bf6dbec4,0x3f223f75bf46be95,0xbf22bf753f463e95
.quad 0x3f0e3e48bf0ebe48,0x3f0e3e48bf0ebe48,0xbf75bf7fbe95bdc9,0x3f753f7f3e953dc9
.quad 0x3f80bf803f80bf80,0x3f80bf803f80bf80,0xbf223ef13f46bf62,0x3f22bef1bf463f62
.quad 0xbe483f0e3e48bf0e,0xbe483f0e3e48bf0e,0x3f62bf7fbef1bdc9,0xbf623f7f3ef13dc9
.quad 0xbf6d3ec4bf6d3ec4,0xbf6d3ec4bf6d3ec4,0x3e953f22bf753f46,0xbe95bf223f75bf46
.quad 0x3f0ebf7bbf0e3f7b,0x3f0ebf7bbf0e3f7b,0xbf7f3e953dc93f75,0x3f7fbe95bdc9bf75
.quad 0x3f353f353f353f35,0x3f353f353f353f35,0x3dc9bf753f7f3e95,0xbdc93f75bf7fbe95
.quad 0xbf553e483f55be48,0xbf553e483f55be48,0x3f753f463e95bf22,0xbf75bf46be953f22
.quad 0xbec4bf6dbec4bf6d,0xbec4bf6dbec4bf6d,0xbef13dc9bf62bf7f,0x3ef1bdc93f623f7f
.quad 0x3f7b3f55bf7bbf55,0x3f7b3f55bf7bbf55,0xbf46bf62bf22bef1,0x3f463f623f223ef1
.quad 0x3f80bf803f80bf80,0x3f80bf803f80bf80,0xbf623f463ef1bf22,0x3f62bf46bef13f22
.quad 0x3f0ebe48bf0e3e48,0x3f0ebe48bf0e3e48,0xbdc9bef1bf7f3f62,0x3dc93ef13f7fbf62
.quad 0xbec43f6dbec43f6d,0xbec43f6dbec43f6d,0x3f46bf753f223e95,0xbf463f75bf22be95
.quad 0xbf7b3f0e3f7bbf0e,0xbf7b3f0e3f7bbf0e,0x3f753dc93e95bf7f,0xbf75bdc9be953f7f
.quad 0xbf35bf35bf35bf35,0xbf35bf35bf35bf35,0x3e953f7fbf753dc9,0xbe95bf7f3f75bdc9
.quad 0x3e48bf55be483f55,0x3e48bf55be483f55,0xbf223e953f463f75,0x3f22be95bf46bf75
.quad 0x3f6d3ec43f6d3ec4,0x3f6d3ec43f6d3ec4,0xbf7fbf623dc9bef1,0x3f7f3f62bdc93ef1
.quad 0x3f553f7bbf55bf7b,0x3f553f7bbf55bf7b,0xbef1bf22bf62bf46,0x3ef13f223f623f46
.quad 0x3f80bf803f80bf80,0x3f80bf803f80bf80,0xbf7f3f753dc9be95,0x3f7fbf75bdc93e95
.quad 0x3f7bbf55bf7b3f55,0x3f7bbf55bf7b3f55,0xbf753f22be953f46,0x3f75bf223e95bf46
.quad 0x3f6dbec43f6dbec4,0x3f6dbec43f6dbec4,0xbf623dc93ef1bf7f,0x3f62bdc9bef13f7f
.quad 0x3f553e48bf55be48,0x3f553e48bf55be48,0xbf46bef1bf223f62,0x3f463ef13f22bf62
.quad 0x3f353f353f353f35,0x3f353f353f353f35,0xbf22bf623f46bef1,0x3f223f62bf463ef1
.quad 0x3f0e3f7bbf0ebf7b,0x3f0e3f7bbf0ebf7b,0xbef1bf7fbf62bdc9,0x3ef13f7f3f623dc9
.quad 0x3ec43f6d3ec43f6d,0x3ec43f6d3ec43f6d,0xbe95bf463f753f22,0x3e953f46bf75bf22
.quad 0x3e483f0ebe48bf0e,0x3e483f0ebe48bf0e,0xbdc9be95bf7fbf75,0x3dc93e953f7f3f75
```
